```python
import torch

def _softmax(x, axis=-1):
    return torch.softmax(x, dim=axis)
def _gelu(x):
    return torch.nn.functional.gelu(x, approximate="tanh")
def _silu(x):
    return torch.nn.functional.silu(x)
def _sigmoid(x):
    return torch.sigmoid(x)
def _layernorm(x, axis=-1, eps=1e-5):
    m = x.mean(dim=axis, keepdim=True)
    v = x.var(dim=axis, keepdim=True, unbiased=False)
    return (x - m) / torch.sqrt(v + eps)
def _scatter_add(tgt, idx, src, axis=0):
    return tgt.clone().index_add_(axis, idx, src)
def _segment_sum(src, seg, n):
    out = torch.zeros((n,) + src.shape[1:], dtype=src.dtype)
    return out.index_add_(0, seg, src)
def _pad(x, pw):
    flat = tuple(v for pair in reversed(pw) for v in pair)
    return torch.nn.functional.pad(x, flat)

kernel_name = 'gated_mix__compressed_kv_cla__linear_attn_block__prompt'

def setup_inputs():

    _w = (lambda a: (lambda t: t.to(torch.bfloat16) if t.is_floating_point() else t)(torch.as_tensor(a)))
    def _A_setup():
        B, H, Sq, Sk, D, M = 1, 16, 2048, 2048, 256, 448
        Dc = 4 * D
        return {
            "x": _w((lambda *s: torch.randn(*s, dtype=torch.bfloat16) * 0.05)(B, Sq, M)),
            "c_kv": _w((lambda *s: torch.randn(*s, dtype=torch.bfloat16) * 1.6)(B, Sk, Dc)),
            "w_q": _w((lambda *s: torch.randn(*s, dtype=torch.bfloat16) * 3.2)(M, H, D) * (M ** -0.5)),
            "w_uk": _w((lambda *s: torch.randn(*s, dtype=torch.bfloat16) * 3.2)(Dc, H, D) * (Dc ** -0.5)),
            "w_uv": _w((lambda *s: torch.randn(*s, dtype=torch.bfloat16) * 1.6)(Dc, H, D) * (Dc ** -0.5)),
            "w_o": _w((lambda *s: torch.randn(*s, dtype=torch.bfloat16) * 1.6)(H, D, M) * ((H * D) ** -0.5)),
        }
    _A_in = _A_setup()

    def _B_setup():
        B, S, D = 1, 2048, 448
        return {
            "x": _w((lambda *s: torch.randn(*s, dtype=torch.bfloat16) * 0.05)(B, S, D)),
            "wqkv": _w((lambda *s: torch.randn(*s, dtype=torch.bfloat16) * 1.6)(D, 3 * D)),
            "wo": _w((lambda *s: torch.randn(*s, dtype=torch.bfloat16) * 1.6)(D, D)),
        }
    _B_in = _B_setup()

    return {
        "A_x": _A_in["x"],
        "A_c_kv": _A_in["c_kv"],
        "A_w_q": _A_in["w_q"],
        "A_w_uk": _A_in["w_uk"],
        "A_w_uv": _A_in["w_uv"],
        "A_w_o": _A_in["w_o"],
        "B_x": _B_in["x"],
        "B_wqkv": _B_in["wqkv"],
        "B_wo": _B_in["wo"],
        "gate_w": _w((lambda *s: torch.randn(*s, dtype=torch.bfloat16) * 0.05)(448) * 16.0),
    }

def reference(A_x, A_c_kv, A_w_q, A_w_uk, A_w_uv, A_w_o, B_x, B_wqkv, B_wo, gate_w):
    def _A_ref(x, c_kv, w_q, w_uk, w_uv, w_o):
        B, Sq, M = x.shape[0], x.shape[1], x.shape[2]
        Sk = c_kv.shape[1]
        H, D = w_q.shape[1], w_q.shape[2]
        q = torch.einsum("bqm,mhd->bhqd", x, w_q)
        k = torch.einsum("bkc,chd->bhkd", c_kv, w_uk)
        v = torch.einsum("bkc,chd->bhkd", c_kv, w_uv)
        scores = torch.einsum("bhqd,bhkd->bhqk", q, k) * (D ** -0.5)
        off = Sk - Sq
        qi = torch.arange(Sq)[:, None]
        kj = torch.arange(Sk)[None, :]
        cmask = kj <= (qi + off)
        scores = torch.where(cmask[None, None], scores, -1e9)
        p = _softmax(scores, axis=-1)
        ctx = torch.einsum("bhqk,bhkd->bhqd", p, v)
        return torch.einsum("bhqd,hdm->bqm", ctx, w_o)

    def _B_ref(x, wqkv, wo):
        B, S, D = x.shape
        H = 16; Dh = D // H
        qkv = (lambda x, *d: x.permute(*d))((x @ wqkv).reshape(B, S, 3, H, Dh), 2, 0, 3, 1, 4)
        q, k, v = qkv[0], qkv[1], qkv[2]
        phi = lambda t: torch.where(t > 0, t + 1, torch.exp(t)) + 1e-6
        pq, pk = phi(q), phi(k)
        kv = torch.einsum("bhsd,bhse->bhde", pk, v)
        z = torch.einsum("bhsd->bhd", pk)
        num = torch.einsum("bhqd,bhde->bhqe", pq, kv)
        den = torch.einsum("bhqd,bhd->bhq", pq, z)[..., None] + 1e-6
        o = num / den
        return (lambda x, *d: x.permute(*d))(o, 0, 2, 1, 3).reshape(B, S, D) @ wo

    x = A_x
    g = _sigmoid((x * gate_w).sum(-1, keepdims=True))
    a = _A_ref(x, A_c_kv, A_w_q, A_w_uk, A_w_uv, A_w_o)
    b = _B_ref(x, B_wqkv, B_wo)
    return g * a + (1 - g) * b
```

```asm
; @launch kernel=gated_mix__compressed_kv_cla__linear_attn_block__prompt_kernel grid=(256,1,1) block=(256,1,1) lds=163840
.amdgcn_target "amdgcn-amd-amdhsa--gfx950"

.macro MVA d, a, b
 v_mfma_f32_16x16x32_bf16 v[\d:\d+3], a[\a:\a+3], a[\b:\b+3], v[\d:\d+3]
.endm
.macro MVZ d, a, b
 v_mfma_f32_16x16x32_bf16 v[\d:\d+3], a[\a:\a+3], a[\b:\b+3], 0
.endm
.macro MAA d, a, b
 v_mfma_f32_16x16x32_bf16 a[\d:\d+3], a[\a:\a+3], a[\b:\b+3], a[\d:\d+3]
.endm
.macro MAZ d, a, b
 v_mfma_f32_16x16x32_bf16 a[\d:\d+3], a[\a:\a+3], a[\b:\b+3], 0
.endm
.macro RA d, v, o
 ds_read_b128 a[\d:\d+3], v\v offset:\o
.endm
.macro RT d, v, o
 ds_read_b64_tr_b16 a[\d:\d+1], v\v offset:\o
.endm
.macro DMA v, r, s, o
 buffer_load_dwordx4 v\v, s[\r:\r+3], s\s offen offset:\o lds
.endm
.macro CV d, a, b
 v_cvt_pk_bf16_f32 v\d, v\a, v\b
.endm
.macro ST4 d, v, r, s, o
 buffer_store_dwordx4 v[\d:\d+3], v\v, s[\r:\r+3], s\s offen offset:\o
.endm

.macro QK d, a, b, c
 v_mfma_f32_32x32x16_bf16 v[\d:\d+15], a[\a:\a+3], a[\b:\b+3], v[\c:\c+15]
.endm
.macro QZ d, a, b
 v_mfma_f32_32x32x16_bf16 v[\d:\d+15], a[\a:\a+3], a[\b:\b+3], 0
.endm
.macro PV d, a, b
 v_mfma_f32_32x32x16_bf16 v[\d:\d+15], a[\a:\a+3], v[\b:\b+3], v[\d:\d+15]
.endm
.macro PZ d, a, b
 v_mfma_f32_32x32x16_bf16 v[\d:\d+15], a[\a:\a+3], v[\b:\b+3], 0
.endm

.macro MQ d, a, b, c
 v_mfma_f32_16x16x32_bf16 v[\d:\d+3], a[\a:\a+3], a[\b:\b+3], v[\c:\c+3]
.endm
.macro MP d, a, b
 v_mfma_f32_16x16x32_bf16 v[\d:\d+3], a[\a:\a+3], v[\b:\b+3], v[\d:\d+3]
.endm
.macro MPZ d, a, b
 v_mfma_f32_16x16x32_bf16 v[\d:\d+3], a[\a:\a+3], v[\b:\b+3], 0
.endm
.macro PKM d, s
 v_pk_mul_f32 v[\d:\d+1], v[\d:\d+1], v[\s:\s+1] op_sel_hi:[1,0]
.endm

.macro DMAS v, r, s, o
 buffer_load_dwordx4 v\v, s[\r:\r+3], s\s offen offset:\o sc1 lds
.endm

.macro DMAN v, r, s, o
 buffer_load_dwordx4 v\v, s[\r:\r+3], s\s offen offset:\o nt lds
.endm

.text
.p2align 8
.globl gated_mix__compressed_kv_cla__linear_attn_block__prompt_kernel
.type gated_mix__compressed_kv_cla__linear_attn_block__prompt_kernel,@function
gated_mix__compressed_kv_cla__linear_attn_block__prompt_kernel:
 s_cmp_ge_u32 s2, 256
 s_cbranch_scc1 P1_EXIT
 s_load_dwordx2 s[82:83], s[0:1], 88
 s_load_dwordx8 s[60:67], s[0:1], 0
 s_load_dwordx2 s[68:69], s[0:1], 32
 s_load_dwordx2 s[70:71], s[0:1], 56
 s_load_dwordx2 s[72:73], s[0:1], 72
 s_load_dwordx2 s[56:57], s[0:1], 96
 v_lshrrev_b32 v2, 6, v0
 v_and_b32 v1, 63, v0
 v_readfirstlane_b32 s4, v2
 s_cmp_lg_u32 s4, 0
 s_cbranch_scc1 P1_TKA
 s_getreg_b32 s50, hwreg(HW_REG_XCC_ID)
 s_and_b32 s50, s50, 7
 s_lshl_b32 s3, s50, 4
 v_mov_b32 v58, s3
 v_mov_b32 v59, 1
 s_mov_b64 exec, 1
 s_waitcnt lgkmcnt(0)
 global_atomic_add v59, v58, v59, s[82:83] offset:128 sc0 sc1
 s_mov_b64 exec, -1
P1_TKA:
 s_lshr_b32 s53, s4, 1
 s_and_b32 s54, s4, 1
 v_and_b32 v2, 15, v1
 v_lshrrev_b32 v3, 4, v1
 v_lshrrev_b32 v4, 3, v1
 v_and_b32 v5, 7, v1
 v_xor_b32 v5, v5, v3
 v_xor_b32 v6, 4, v5
 v_lshlrev_b32 v5, 4, v5
 v_lshlrev_b32 v6, 4, v6
 v_lshlrev_b32 v8, 11, v4
 v_add_u32 v20, v8, v5
 v_add_u32 v21, v8, v6
 v_add_u32 v21, 15360, v21
 v_add_u32 v22, v8, v5
 v_add_u32 v22, 30720, v22
 v_add_u32 v23, v8, v6
 v_add_u32 v23, 46080, v23
 v_lshrrev_b32 v8, 5, v1
 v_and_b32 v9, 31, v1
 s_lshl_b32 s3, s54, 3
 v_xor_b32 v9, s3, v9
 v_lshlrev_b32 v56, 1, v8
 v_xor_b32 v9, v9, v56
 v_xor_b32 v57, 4, v9
 v_lshlrev_b32 v9, 4, v9
 v_lshlrev_b32 v57, 4, v57
 v_lshlrev_b32 v8, 13, v8
 v_add_u32 v24, v8, v9
 v_add_u32 v25, v8, v57
 v_add_u32 v25, 15360, v25
 v_add_u32 v26, v8, v9
 v_add_u32 v26, 30720, v26
 v_add_u32 v27, v8, v57
 v_add_u32 v27, 46080, v27
 s_mov_b32 s10, 4194304
 s_mov_b32 s11, 0x20000
 s_mov_b32 s14, 8388608
 s_mov_b32 s15, 0x20000
 s_mov_b32 s18, 1835008
 s_mov_b32 s19, 0x20000
 s_mov_b32 s22, 3670016
 s_mov_b32 s23, 0x20000
 s_mov_b32 s26, 1204224
 s_mov_b32 s27, 0x20000
 s_mov_b32 s30, 268435456
 s_mov_b32 s31, 0x20000
 s_mov_b32 s34, 896
 s_mov_b32 s35, 0x20000
 s_getreg_b32 s52, hwreg(HW_REG_XCC_ID)
 s_and_b32 s52, s52, 7
 s_lshr_b32 s3, s2, 3
 s_lshl_b32 s3, s3, 2
 s_add_u32 s3, s3, s4
 s_lshl_b32 s36, s3, 15
 v_lshlrev_b32 v60, 11, v2
 v_min_u32 v61, 1, v3
 v_lshl_add_u32 v60, v61, 7, v60
 s_lshr_b32 s37, s3, 1
 s_lshl_b32 s37, s37, 13
 s_lshl_b32 s38, s52, 10
 s_add_u32 s37, s37, s38
 v_and_b32 v61, 7, v1
 v_lshlrev_b32 v61, 7, v61
 v_min_u32 v62, 1, v4
 v_lshl_add_u32 v61, v62, 19, v61
 s_waitcnt lgkmcnt(0)
 s_bitcmp1_b32 s3, 0
 s_cselect_b32 s12, s66, s68
 s_cselect_b32 s13, s67, s69
 s_mov_b32 s8, s62
 s_mov_b32 s9, s63
 buffer_load_dword v63, v60, s[8:11], s36 offen
 buffer_load_dword v63, v61, s[12:15], s37 offen
 s_cmp_lg_u32 s4, 0
 s_cbranch_scc1 P1_TK2
 s_waitcnt vmcnt(2)
P1_TK0:
 v_readfirstlane_b32 s51, v59
 s_nop 0
 s_cmp_lt_u32 s51, 32
 s_cbranch_scc1 P1_TK1
 s_add_u32 s50, s50, 1
 s_and_b32 s50, s50, 7
 s_lshl_b32 s3, s50, 4
 v_mov_b32 v58, s3
 v_mov_b32 v59, 1
 s_mov_b64 exec, 1
 global_atomic_add v59, v58, v59, s[82:83] offset:128 sc0 sc1
 s_mov_b64 exec, -1
 s_waitcnt vmcnt(0)
 s_branch P1_TK0
P1_TK1:
 s_lshl_b32 s51, s51, 3
 s_add_u32 s51, s51, s50
 v_mov_b32 v58, 0
 v_mov_b32 v59, s51
 ds_write_b32 v58, v59 offset:65532
P1_TK2:
 v_mov_b32 v58, 0
 s_waitcnt lgkmcnt(0)
 s_barrier
 ds_read_b32 v59, v58 offset:65532
 s_waitcnt lgkmcnt(0)
 v_readfirstlane_b32 s2, v59
 s_barrier
 s_and_b32 s5, s2, 7
 s_lshr_b32 s6, s2, 3
 s_lshl_b32 s41, s6, 2
 s_add_u32 s41, s41, s4
 s_and_b32 s7, s6, 7
 s_lshr_b32 s45, s6, 3
 s_and_b32 s3, s45, 1
 s_lshl_b32 s43, s5, 1
 s_add_u32 s43, s43, s3
 s_lshr_b32 s44, s45, 1
 s_lshl_b32 s3, s7, 2
 s_lshl_b32 s58, s53, 1
 s_add_u32 s3, s3, s58
 s_add_u32 s59, s3, 14
 s_cmp_lt_u32 s3, 16
 s_cselect_b32 s48, s3, s59
 s_lshr_b32 s3, s3, 1
 s_add_u32 s58, s3, 16
 s_add_u32 s59, s3, 38
 s_cmp_lt_u32 s3, 8
 s_cselect_b32 s74, s58, s59
 s_add_u32 s58, s3, 24
 s_add_u32 s59, s3, 48
 s_cmp_lt_u32 s3, 6
 s_cselect_b32 s81, s58, s59
 s_add_u32 s3, s48, 1
 s_cmp_eq_u32 s54, 0
 s_cselect_b32 s36, s48, s74
 s_cselect_b32 s37, s3, s81
 s_lshl_b32 s36, s36, 16
 s_lshl_b32 s37, s37, 16
 s_lshl_b32 s38, s43, 9
 s_lshl_b32 s3, s4, 16
 s_add_u32 s38, s38, s3
 s_lshl_b32 s40, s4, 13
 s_lshl_b32 s42, s4, 12
 s_cmp_eq_u32 s44, 0
 s_waitcnt lgkmcnt(0)
 s_cselect_b32 s12, s66, s68
 s_cselect_b32 s13, s67, s69
 s_mov_b32 s8, s62
 s_mov_b32 s9, s63
 s_add_u32 m0, s42, 0
 s_nop 0
 DMA 24, 12, 38, 0
 DMA 25, 12, 38, 1024
 DMA 26, 12, 38, 2048
 DMA 27, 12, 38, 3072
 s_add_u32 s38, s38, 262144
 s_add_u32 m0, s40, 65536
 s_nop 0
 DMA 20, 8, 36, 0
 DMA 21, 8, 36, 1024
 DMA 22, 8, 36, 2048
 DMA 23, 8, 36, 3072
 s_add_u32 s36, s36, 128
 s_add_u32 m0, s42, 16384
 s_nop 0
 DMA 24, 12, 38, 0
 DMA 25, 12, 38, 1024
 DMA 26, 12, 38, 2048
 DMA 27, 12, 38, 3072
 s_add_u32 s38, s38, 262144
 s_add_u32 m0, s40, 69632
 s_nop 0
 DMA 20, 8, 37, 0
 DMA 21, 8, 37, 1024
 DMA 22, 8, 37, 2048
 DMA 23, 8, 37, 3072
 s_add_u32 s37, s37, 128
 s_mov_b32 s16, s60
 s_mov_b32 s17, s61
 s_mov_b32 s20, s64
 s_mov_b32 s21, s65
 s_mov_b32 s24, s70
 s_mov_b32 s25, s71
 s_mov_b32 s32, s72
 s_mov_b32 s33, s73
 s_mov_b32 s28, s56
 s_mov_b32 s29, s57
 s_and_b32 s3, s6, 1
 s_lshl_b32 s46, s5, 1
 s_add_u32 s46, s46, s3
 s_lshr_b32 s47, s6, 1
 s_sub_u32 s3, 23, s47
 s_cmp_ge_u32 s47, 8
 s_cselect_b32 s47, s3, s47
 v_mul_u32_u24 v7, 896, v4
 v_add_u32 v28, v7, v5
 v_add_u32 v29, v7, v6
 v_add_u32 v29, 6144, v29
 v_add_u32 v30, v7, v5
 v_add_u32 v30, 12288, v30
 v_add_u32 v31, v7, v6
 v_add_u32 v31, 18432, v31
 s_add_u32 m0, s42, 32768
 s_nop 0
 DMA 24, 12, 38, 0
 DMA 25, 12, 38, 1024
 DMA 26, 12, 38, 2048
 DMA 27, 12, 38, 3072
 s_add_u32 s38, s38, 262144
 v_lshlrev_b32 v4, 1, v3
 v_xor_b32 v4, v4, v2
 v_mul_u32_u24 v7, 2688, v3
 v_min_u32 v5, 14, v4
 v_mul_u32_u24 v6, 52, v5
 v_lshrrev_b32 v6, 8, v6
 v_mul_u32_u24 v6, 816, v6
 v_lshl_add_u32 v6, v5, 4, v6
 v_add_u32 v6, v6, v7
 v_add_u32 v32, 0, v6
 v_add_u32 v33, 9728, v6
 v_xor_b32 v4, 8, v4
 v_min_u32 v5, 14, v4
 v_mul_u32_u24 v6, 52, v5
 v_lshrrev_b32 v6, 8, v6
 v_mul_u32_u24 v6, 816, v6
 v_lshl_add_u32 v6, v5, 4, v6
 v_add_u32 v6, v6, v7
 v_add_u32 v34, 19456, v6
 v_add_u32 v35, 29184, v6
 s_mul_i32 s76, s47, 114688
 s_mul_i32 s3, s4, 28672
 s_add_u32 s76, s76, s3
 s_mul_i32 s77, s46, 56
 s_and_b32 s77, s77, 0xfffffff0
 s_mul_i32 s3, s4, 43008
 s_add_u32 s77, s77, s3
 s_add_u32 m0, s40, 98304
 s_nop 0
 DMA 20, 8, 36, 0
 DMA 21, 8, 36, 1024
 DMA 22, 8, 36, 2048
 DMA 23, 8, 36, 3072
 s_add_u32 s36, s36, 128
 s_lshl_b32 s78, s46, 9
 s_lshl_b32 s3, s4, 16
 s_add_u32 s78, s78, s3
 v_lshlrev_b32 v50, 4, v3
 v_lshrrev_b32 v4, 1, v2
 v_xor_b32 v4, v4, v3
 v_lshlrev_b32 v4, 4, v4
 v_lshl_add_u32 v4, v2, 7, v4
 v_mov_b32 v40, v4
 v_xor_b32 v41, 64, v4
 s_lshl_b32 s62, s53, 14
 s_mov_b32 s60, 65536
 s_mov_b32 s61, 131072
 s_add_u32 s3, s62, 65536
 v_add_u32 v10, s3, v40
 v_add_u32 v11, s3, v41
 v_lshrrev_b32 v4, 2, v2
 v_and_b32 v5, 3, v1
 v_and_b32 v6, 1, v3
 v_lshlrev_b32 v6, 3, v6
 v_lshl_or_b32 v6, v4, 1, v6
 v_lshl_add_u32 v7, v3, 3, v4
 v_lshlrev_b32 v8, 9, v7
 v_and_b32 v9, 1, v5
 v_lshl_add_u32 v8, v9, 3, v8
 v_lshrrev_b32 v9, 1, v5
 v_xor_b32 v9, v9, v6
 s_lshl_b32 s3, s54, 4
 s_add_u32 s58, s3, 0
 v_xor_b32 v56, s58, v9
 v_lshl_add_u32 v12, v56, 4, v8
 s_add_u32 s58, s3, 2
 v_xor_b32 v56, s58, v9
 v_lshl_add_u32 v13, v56, 4, v8
 s_add_u32 s58, s3, 4
 v_xor_b32 v56, s58, v9
 v_lshl_add_u32 v14, v56, 4, v8
 s_add_u32 s58, s3, 6
 v_xor_b32 v56, s58, v9
 v_lshl_add_u32 v15, v56, 4, v8
 s_add_u32 s58, s3, 8
 v_xor_b32 v56, s58, v9
 v_lshl_add_u32 v16, v56, 4, v8
 s_add_u32 s58, s3, 10
 v_xor_b32 v56, s58, v9
 v_lshl_add_u32 v17, v56, 4, v8
 s_add_u32 s58, s3, 12
 v_xor_b32 v56, s58, v9
 v_lshl_add_u32 v18, v56, 4, v8
 s_add_u32 s58, s3, 14
 v_xor_b32 v56, s58, v9
 v_lshl_add_u32 v19, v56, 4, v8
 s_add_u32 m0, s42, 49152
 s_nop 0
 DMA 24, 12, 38, 0
 DMA 25, 12, 38, 1024
 DMA 26, 12, 38, 2048
 DMA 27, 12, 38, 3072
 s_add_u32 s38, s38, 262144
 s_mul_i32 s3, s4, 12
 s_add_u32 s58, s3, 0
 v_xor_b32 v56, s58, v9
 v_lshl_add_u32 v42, v56, 4, v8
 s_add_u32 s58, s3, 2
 v_xor_b32 v56, s58, v9
 v_lshl_add_u32 v43, v56, 4, v8
 s_add_u32 s58, s3, 4
 v_xor_b32 v56, s58, v9
 v_lshl_add_u32 v44, v56, 4, v8
 s_add_u32 s58, s3, 6
 v_xor_b32 v56, s58, v9
 v_lshl_add_u32 v45, v56, 4, v8
 s_add_u32 s58, s3, 8
 v_xor_b32 v56, s58, v9
 v_lshl_add_u32 v46, v56, 4, v8
 s_add_u32 s58, s3, 10
 v_xor_b32 v56, s58, v9
 v_lshl_add_u32 v47, v56, 4, v8
 s_and_b32 s59, s46, 1
 v_lshlrev_b32 v8, 8, v7
 v_add_u32 v8, 114688, v8
 s_cmp_lt_u32 s4, 2
 s_cbranch_scc1 P1_BWDONE
 s_cmp_eq_u32 s4, 3
 s_cbranch_scc1 P1_BW3
 s_add_u32 s58, s59, 0
 v_add_u32 v56, s58, v5
 v_and_b32 v57, 1, v56
 v_lshrrev_b32 v56, 1, v56
 v_xor_b32 v56, v56, v6
 v_lshl_add_u32 v56, v56, 4, v8
 v_lshl_add_u32 v46, v57, 3, v56
 s_add_u32 s58, s59, 4
 v_add_u32 v56, s58, v5
 v_and_b32 v57, 1, v56
 v_lshrrev_b32 v56, 1, v56
 v_xor_b32 v56, v56, v6
 v_lshl_add_u32 v56, v56, 4, v8
 v_lshl_add_u32 v47, v57, 3, v56
 s_branch P1_BWDONE
P1_EXIT:
 s_endpgm
P1_BW3:
 s_add_u32 s58, s59, 10
 v_add_u32 v56, s58, v5
 v_and_b32 v57, 1, v56
 v_lshrrev_b32 v56, 1, v56
 v_xor_b32 v56, v56, v6
 v_lshl_add_u32 v56, v56, 4, v8
 v_lshl_add_u32 v42, v57, 3, v56
 s_add_u32 s58, s59, 14
 v_add_u32 v56, s58, v5
 v_and_b32 v57, 1, v56
 v_lshrrev_b32 v56, 1, v56
 v_xor_b32 v56, v56, v6
 v_lshl_add_u32 v56, v56, 4, v8
 v_lshl_add_u32 v43, v57, 3, v56
 s_add_u32 s58, s59, 20
 v_add_u32 v56, s58, v5
 v_and_b32 v57, 1, v56
 v_lshrrev_b32 v56, 1, v56
 v_xor_b32 v56, v56, v6
 v_lshl_add_u32 v56, v56, 4, v8
 v_lshl_add_u32 v44, v57, 3, v56
 s_add_u32 s58, s59, 24
 v_add_u32 v56, s58, v5
 v_and_b32 v57, 1, v56
 v_lshrrev_b32 v56, 1, v56
 v_xor_b32 v56, v56, v6
 v_lshl_add_u32 v56, v56, 4, v8
 v_lshl_add_u32 v45, v57, 3, v56
P1_BWDONE:
 v_lshlrev_b32 v52, 4, v1
 s_mul_i32 s3, s4, 6144
 s_add_u32 s3, s3, 98304
 v_add_u32 v51, s3, v52
 v_lshlrev_b32 v4, 5, v2
 v_add_u32 v53, 57344, v4
 s_mul_i32 s58, s43, 2163712
 s_lshl_b32 s3, s54, 13
 s_add_u32 s58, s58, s3
 s_lshl_b32 s3, s44, 14
 s_add_u32 s58, s58, s3
 s_mul_i32 s48, s48, 33792
 s_add_u32 s48, s48, s58
 s_mul_i32 s74, s74, 33792
 s_add_u32 s74, s74, s58
 s_mul_i32 s81, s81, 33792
 s_add_u32 s81, s81, s58
 s_mov_b32 s56, 0x3db8aa3b
 s_mov_b32 s57, 0x3db8aa3b
 s_mov_b32 s80, 0x358637bd
 s_mov_b32 s55, 0x3fb8aa3b
 s_lshl_b32 s3, s2, 2
 s_add_u32 s3, s3, s4
 s_mul_i32 s58, s3, 14
 v_min_u32 v7, 13, v1
 v_add_u32 v7, s58, v7
 v_lshlrev_b32 v7, 7, v7
 buffer_load_dword v38, v7, s[16:19], 0 offen
 s_mul_i32 s58, s3, 28
 v_min_u32 v7, 27, v1
 v_add_u32 v7, s58, v7
 v_lshlrev_b32 v7, 7, v7
 buffer_load_dword v38, v7, s[20:23], 0 offen
 s_getpc_b64 s[66:67]
CPF0:
 s_add_u32 s66, s66, (P1_LOOP0-CPF0)&0xffffffff
 s_addc_u32 s67, s67, ((P1_LOOP0-CPF0)>>32)&0xffffffff
 s_mul_i32 s3, s41, 8
 v_min_u32 v60, 7, v1
 v_add_u32 v60, s3, v60
 v_lshlrev_b32 v60, 7, v60
 v_min_u32 v60, P2_CODE_END-P1_LOOP0, v60
 v_mov_b32 v61, s67
 v_add_co_u32 v60, vcc, s66, v60
 s_nop 1
 v_addc_co_u32 v61, vcc, 0, v61, vcc
 global_load_dword v38, v[60:61], off
 s_mul_i32 s58, s47, 7
 s_add_u32 s58, s58, s4
 v_subrev_u32 v7, 19456, v34
 s_bitcmp1_b32 s58, 1
 s_cselect_b64 vcc, -1, 0
 v_cndmask_b32 v7, v32, v7, vcc
 s_mul_i32 s59, s46, 56
 s_and_b32 s59, s59, 0xfffffff0
 s_mul_i32 s3, s58, 10752
 s_add_u32 s59, s59, s3
 buffer_load_dwordx4 a[248:251], v7, s[24:27], s59 offen
 s_add_u32 s59, s59, 43008
 buffer_load_dwordx4 a[252:255], v7, s[24:27], s59 offen
 s_mul_i32 s77, s46, 114688
 s_add_u32 s77, s77, 75497472
 s_lshl_b32 s3, s58, 10
 s_add_u32 s63, s77, s3
 s_add_u32 s64, s63, 4096
 s_cmp_eq_u32 s4, 3
 s_cselect_b32 s64, 0x70000000, s64
 s_add_u32 s77, s77, s42
 v_mov_b32 v36, 1
 v_mov_b32 v39, 0
 v_mov_b32 v48, 0
 v_mov_b32 v49, 0
 s_cmp_lg_u32 s4, 0
 s_cbranch_scc1 P1_NOFLAG
 s_lshl_b32 s3, s2, 7
 s_add_u32 s3, s3, 78774272
 buffer_store_dwordx2 v[48:49], v39, s[28:31], s3 offen sc1
 s_add_u32 s3, s3, 32768
 buffer_store_dwordx2 v[48:49], v39, s[28:31], s3 offen sc1
 s_add_u32 s3, s3, 32768
 buffer_store_dwordx2 v[48:49], v39, s[28:31], s3 offen sc1
 buffer_store_dwordx2 v[48:49], v39, s[28:31], s3 offen offset:8 sc1
 s_add_u32 s3, s3, 32768
 buffer_store_dwordx2 v[48:49], v39, s[28:31], s3 offen sc1
 s_add_u32 s3, s3, 32768
P1_NOFLAG:
 s_mov_b32 s68, s82
 s_mov_b32 s69, s83
 s_mov_b32 s70, 256
 s_mov_b32 s71, 0x20000
 s_lshl_b32 s73, s5, 5
 s_add_u32 s73, s73, s6
 s_lshl_b32 s73, s73, 7
 s_add_u32 s73, s73, 78839808
 s_lshl_b32 s72, s46, 16
 s_lshl_b32 s3, s47, 12
 s_add_u32 s72, s72, s3
 s_add_u32 s72, s72, 77594624
 s_mul_i32 s39, s46, 2163712
 s_add_u32 s39, s39, s42
 s_sub_u32 s3, s6, 16
 s_cmp_lt_u32 s3, 14
 s_cselect_b32 s3, 1013760, 0
 s_add_u32 s39, s39, s3
 v_add_u32 v54, 0x4000, v52
 v_and_b32 v55, 31, v1
 v_lshlrev_b32 v55, 7, v55
 s_lshl_b32 s49, s5, 12
 s_add_u32 s49, s49, 78839808
 s_waitcnt vmcnt(25)
 s_barrier
 s_cmp_eq_u32 s44, 1
 s_cbranch_scc1 P1_AV
 RT 32, 12, 0
 RT 34, 12, 2048
 RA 0, 10, 0
 RA 4, 10, 2048
 RA 16, 10, 8192
 RA 20, 10, 10240
 RT 36, 13, 0
 RT 38, 13, 2048
 RT 40, 14, 0
 RT 42, 14, 2048
 RT 44, 15, 0
 RT 46, 15, 2048
 RT 48, 16, 0
 RT 50, 16, 2048
 RT 52, 17, 0
 RT 54, 17, 2048
 RT 56, 18, 0
 RT 58, 18, 2048
 RT 60, 19, 0
 RT 62, 19, 2048
 s_waitcnt lgkmcnt(0)
 MVZ 192, 32, 0
 s_waitcnt vmcnt(17) lgkmcnt(0)
 s_barrier
 MVZ 200, 32, 4
 RA 8, 10, 4096
 s_add_u32 m0, s40, 102400
 MVZ 64, 32, 16
 RA 12, 10, 6144
 DMA 20, 8, 37, 0
 MVZ 72, 32, 20
 RA 24, 10, 12288
 MVZ 76, 36, 20
 RA 28, 10, 14336
 DMA 21, 8, 37, 1024
 MVZ 68, 36, 16
 RT 96, 12, 16384
 MVZ 204, 36, 4
 RT 98, 12, 18432
 DMA 22, 8, 37, 2048
 MVZ 196, 36, 0
 RA 72, 11, 4096
 MVZ 208, 40, 0
 RA 76, 11, 6144
 DMA 23, 8, 37, 3072
 MVZ 216, 40, 4
 RA 88, 11, 12288
 s_add_u32 s37, s37, 128
 s_add_u32 m0, s42, 0
 MVZ 80, 40, 16
 RA 92, 11, 14336
 DMA 24, 12, 38, 0
 MVZ 88, 40, 20
 RT 100, 13, 16384
 MVZ 92, 44, 20
 RT 102, 13, 18432
 DMA 25, 12, 38, 1024
 MVZ 84, 44, 16
 RT 104, 14, 16384
 MVZ 220, 44, 4
 RT 106, 14, 18432
 DMA 26, 12, 38, 2048
 MVZ 212, 44, 0
 RT 108, 15, 16384
 MVZ 224, 48, 0
 RT 110, 15, 18432
 DMA 27, 12, 38, 3072
 MVZ 232, 48, 4
 RT 112, 16, 16384
 s_add_u32 m0, s40, s61
 MVZ 96, 48, 16
 RT 114, 16, 18432
 DMA 20, 8, 36, 0
 MVZ 104, 48, 20
 RT 116, 17, 16384
 MVZ 108, 52, 20
 RT 118, 17, 18432
 DMA 21, 8, 36, 1024
 MVZ 100, 52, 16
 RT 120, 18, 16384
 MVZ 236, 52, 4
 RT 122, 18, 18432
 DMA 22, 8, 36, 2048
 MVZ 228, 52, 0
 RT 124, 19, 16384
 MVZ 240, 56, 0
 RT 126, 19, 18432
 DMA 23, 8, 36, 3072
 MVZ 248, 56, 4
 MVZ 112, 56, 16
 s_add_u32 s38, s38, 262144
 MVZ 120, 56, 20
 s_mov_b32 s65, s60
 s_add_u32 s60, s60, 32768
 MVZ 124, 60, 20
 s_add_u32 s36, s36, 128
 s_cmp_eq_u32 s60, 163840
 s_cselect_b32 s60, 65536, s60
 MVZ 116, 60, 16
 s_add_u32 s3, s60, s62
 v_add_u32 v10, s3, v40
 MVZ 252, 60, 4
 MVZ 244, 60, 0
 s_waitcnt lgkmcnt(0)
 MAZ 128, 32, 8
 MAA 128, 96, 72
 MAZ 136, 96, 76
 MAA 136, 32, 12
 MVZ 128, 32, 24
 MVA 128, 96, 88
 s_waitcnt vmcnt(21) lgkmcnt(0)
 s_barrier
 MVZ 136, 96, 92
 MVA 136, 32, 28
 RT 32, 12, 32768
 s_add_u32 m0, s42, 16384
 MVZ 140, 36, 28
 DMA 24, 12, 38, 0
 MVA 140, 100, 92
 RT 34, 12, 34816
 MVZ 132, 100, 88
 MVA 132, 36, 24
 RA 64, 11, 0
 MAZ 140, 36, 12
 DMA 25, 12, 38, 1024
 MAA 140, 100, 76
 RA 68, 11, 2048
 MAZ 132, 100, 72
 MAA 132, 36, 8
 RT 36, 13, 32768
 MAZ 144, 40, 8
 DMA 26, 12, 38, 2048
 MAA 144, 104, 72
 RT 38, 13, 34816
 MAZ 152, 104, 76
 MAA 152, 40, 12
 RA 80, 11, 8192
 MVZ 144, 40, 24
 DMA 27, 12, 38, 3072
 MVA 144, 104, 88
 RA 84, 11, 10240
 MVZ 152, 104, 92
 MVA 152, 40, 28
 RT 40, 14, 32768
 s_add_u32 s3, s40, 4096
 s_add_u32 m0, s3, s61
 MVZ 156, 44, 28
 DMA 20, 8, 37, 0
 MVA 156, 108, 92
 RT 42, 14, 34816
 MVZ 148, 108, 88
 MVA 148, 44, 24
 RA 0, 10, 0
 MAZ 156, 44, 12
 DMA 21, 8, 37, 1024
 MAA 156, 108, 76
 RA 4, 10, 2048
 MAZ 148, 108, 72
 MAA 148, 44, 8
 RT 44, 15, 32768
 MAZ 160, 48, 8
 DMA 22, 8, 37, 2048
 MAA 160, 112, 72
 RT 46, 15, 34816
 MAZ 168, 112, 76
 MAA 168, 48, 12
 RA 16, 10, 8192
 MVZ 160, 48, 24
 DMA 23, 8, 37, 3072
 MVA 160, 112, 88
 RA 20, 10, 10240
 MVZ 168, 112, 92
 MVA 168, 48, 28
 RT 48, 16, 32768
 MVZ 172, 52, 28
 s_add_u32 s38, s38, 262144
 MVA 172, 116, 92
 RT 50, 16, 34816
 MVZ 164, 116, 88
 s_add_u32 s37, s37, 128
 MVA 164, 52, 24
 MAZ 172, 52, 12
 MAA 172, 116, 76
 MAZ 164, 116, 72
 MAA 164, 52, 8
 RT 52, 17, 32768
 MAZ 176, 56, 8
 MAA 176, 120, 72
 RT 54, 17, 34816
 MAZ 184, 120, 76
 MAA 184, 56, 12
 MVZ 176, 56, 24
 MVA 176, 120, 88
 MVZ 184, 120, 92
 MVA 184, 56, 28
 RT 56, 18, 32768
 MVZ 188, 60, 28
 MVA 188, 124, 92
 RT 58, 18, 34816
 MVZ 180, 124, 88
 MVA 180, 60, 24
 MAZ 188, 60, 12
 s_mov_b32 s61, s65
 MAA 188, 124, 76
 s_add_u32 s3, s60, s62
 v_add_u32 v11, s3, v41
 MAZ 180, 124, 72
 MAA 180, 60, 8
 RT 60, 19, 32768
 RT 62, 19, 34816
 s_waitcnt lgkmcnt(2)
 MVA 192, 96, 64
 MVA 192, 32, 0
 MVA 200, 32, 4
 MVA 200, 96, 68
 MVA 64, 96, 80
 MVA 64, 32, 16
 s_waitcnt vmcnt(16) lgkmcnt(0)
 s_barrier
 MVA 72, 32, 20
 MVA 72, 96, 84
 RT 96, 12, 49152
 s_add_u32 m0, s42, 32768
 MVA 76, 100, 84
 DMA 24, 12, 38, 0
 MVA 76, 36, 20
 RT 98, 12, 51200
 MVA 68, 36, 16
 MVA 68, 100, 80
 RA 8, 10, 4096
 MVA 204, 100, 68
 DMA 25, 12, 38, 1024
 MVA 204, 36, 4
 RA 12, 10, 6144
 MVA 196, 36, 0
 MVA 196, 100, 64
 RT 100, 13, 49152
 MVA 208, 104, 64
 DMA 26, 12, 38, 2048
 MVA 208, 40, 0
 RT 102, 13, 51200
 MVA 216, 40, 4
 MVA 216, 104, 68
 RA 24, 10, 12288
 MVA 80, 104, 80
 DMA 27, 12, 38, 3072
 MVA 80, 40, 16
 RA 28, 10, 14336
 MVA 88, 40, 20
 MVA 88, 104, 84
 RT 104, 14, 49152
 s_add_u32 m0, s40, s61
 MVA 92, 108, 84
 DMA 20, 8, 36, 0
 MVA 92, 44, 20
 RT 106, 14, 51200
 MVA 84, 44, 16
 MVA 84, 108, 80
 RA 72, 11, 4096
 MVA 220, 108, 68
 DMA 21, 8, 36, 1024
 MVA 220, 44, 4
 RA 76, 11, 6144
 MVA 212, 44, 0
 MVA 212, 108, 64
 RT 108, 15, 49152
 MVA 224, 112, 64
 DMA 22, 8, 36, 2048
 MVA 224, 48, 0
 RT 110, 15, 51200
 MVA 232, 48, 4
 MVA 232, 112, 68
 RA 88, 11, 12288
 MVA 96, 112, 80
 DMA 23, 8, 36, 3072
 MVA 96, 48, 16
 RA 92, 11, 14336
 MVA 104, 48, 20
 MVA 104, 112, 84
 RT 112, 16, 49152
 MVA 108, 116, 84
 s_add_u32 s38, s38, 262144
 MVA 108, 52, 20
 RT 114, 16, 51200
 MVA 100, 52, 16
 s_add_u32 s36, s36, 128
 MVA 100, 116, 80
 MVA 236, 116, 68
 MVA 236, 52, 4
 MVA 228, 52, 0
 MVA 228, 116, 64
 RT 116, 17, 49152
 MVA 240, 120, 64
 MVA 240, 56, 0
 RT 118, 17, 51200
 MVA 248, 56, 4
 MVA 248, 120, 68
 MVA 112, 120, 80
 MVA 112, 56, 16
 MVA 120, 56, 20
 MVA 120, 120, 84
 RT 120, 18, 49152
 MVA 124, 124, 84
 MVA 124, 60, 20
 RT 122, 18, 51200
 MVA 116, 60, 16
 MVA 116, 124, 80
 s_mov_b32 s65, s60
 s_add_u32 s60, s60, 32768
 MVA 252, 124, 68
 s_cmp_eq_u32 s60, 163840
 s_cselect_b32 s60, 65536, s60
 MVA 252, 60, 4
 s_add_u32 s3, s60, s62
 v_add_u32 v10, s3, v40
 MVA 244, 60, 0
 MVA 244, 124, 64
 RT 124, 19, 49152
 RT 126, 19, 51200
 s_mov_b32 s52, 6
.p2align 6
P1_LOOP0:
 s_waitcnt lgkmcnt(2)
 MAA 128, 32, 8
 MAA 128, 96, 72
 MAA 136, 96, 76
 MAA 136, 32, 12
 MVA 128, 32, 24
 MVA 128, 96, 88
 s_waitcnt vmcnt(16) lgkmcnt(0)
 s_barrier
 s_cmp_lg_u32 s52, 4
 s_cbranch_scc1 P1_ON0
 s_cmp_lg_u32 s4, 0
 s_cbranch_scc1 P1_OM0
 s_mov_b64 exec, 1
 buffer_atomic_add v36, v39, s[68:71], 0 offen sc1
 s_mov_b64 exec, -1
P1_OM0:
 s_cmp_lg_u32 s4, 3
 s_cbranch_scc1 P1_ON0
 buffer_load_dwordx4 a[192:195], v50, s[32:35], 0 offen offset:0
 buffer_load_dwordx4 a[196:199], v50, s[32:35], 0 offen offset:64
 buffer_load_dwordx4 a[200:203], v50, s[32:35], 0 offen offset:128
 buffer_load_dwordx4 a[204:207], v50, s[32:35], 0 offen offset:192
 buffer_load_dwordx4 a[208:211], v50, s[32:35], 0 offen offset:256
 buffer_load_dwordx4 a[212:215], v50, s[32:35], 0 offen offset:320
 buffer_load_dwordx4 a[216:219], v50, s[32:35], 0 offen offset:384
 buffer_load_dwordx4 a[220:223], v50, s[32:35], 0 offen offset:448
 buffer_load_dwordx4 a[224:227], v50, s[32:35], 0 offen offset:512
 buffer_load_dwordx4 a[228:231], v50, s[32:35], 0 offen offset:576
 buffer_load_dwordx4 a[232:235], v50, s[32:35], 0 offen offset:640
 buffer_load_dwordx4 a[236:239], v50, s[32:35], 0 offen offset:704
 buffer_load_dwordx4 a[240:243], v50, s[32:35], 0 offen offset:768
 buffer_load_dwordx4 a[244:247], v50, s[32:35], 0 offen offset:832
P1_ON0:
 MVA 136, 96, 92
 MVA 136, 32, 28
 RT 32, 12, 0
 s_add_u32 m0, s42, 49152
 MVA 140, 36, 28
 DMA 24, 12, 38, 0
 MVA 140, 100, 92
 RT 34, 12, 2048
 MVA 132, 100, 88
 MVA 132, 36, 24
 RA 64, 11, 0
 MAA 140, 36, 12
 DMA 25, 12, 38, 1024
 MAA 140, 100, 76
 RA 68, 11, 2048
 MAA 132, 100, 72
 MAA 132, 36, 8
 RT 36, 13, 0
 MAA 144, 40, 8
 DMA 26, 12, 38, 2048
 MAA 144, 104, 72
 RT 38, 13, 2048
 MAA 152, 104, 76
 MAA 152, 40, 12
 RA 80, 11, 8192
 MVA 144, 40, 24
 DMA 27, 12, 38, 3072
 MVA 144, 104, 88
 RA 84, 11, 10240
 MVA 152, 104, 92
 MVA 152, 40, 28
 RT 40, 14, 0
 s_add_u32 s3, s40, 4096
 s_add_u32 m0, s3, s61
 MVA 156, 44, 28
 DMA 20, 8, 37, 0
 MVA 156, 108, 92
 RT 42, 14, 2048
 MVA 148, 108, 88
 MVA 148, 44, 24
 RA 0, 10, 0
 MAA 156, 44, 12
 DMA 21, 8, 37, 1024
 MAA 156, 108, 76
 RA 4, 10, 2048
 MAA 148, 108, 72
 MAA 148, 44, 8
 RT 44, 15, 0
 MAA 160, 48, 8
 DMA 22, 8, 37, 2048
 MAA 160, 112, 72
 RT 46, 15, 2048
 MAA 168, 112, 76
 MAA 168, 48, 12
 RA 16, 10, 8192
 MVA 160, 48, 24
 DMA 23, 8, 37, 3072
 MVA 160, 112, 88
 RA 20, 10, 10240
 MVA 168, 112, 92
 MVA 168, 48, 28
 RT 48, 16, 0
 MVA 172, 52, 28
 s_add_u32 s38, s38, 262144
 MVA 172, 116, 92
 RT 50, 16, 2048
 MVA 164, 116, 88
 s_add_u32 s37, s37, 128
 MVA 164, 52, 24
 MAA 172, 52, 12
 MAA 172, 116, 76
 MAA 164, 116, 72
 MAA 164, 52, 8
 RT 52, 17, 0
 MAA 176, 56, 8
 MAA 176, 120, 72
 RT 54, 17, 2048
 MAA 184, 120, 76
 MAA 184, 56, 12
 MVA 176, 56, 24
 MVA 176, 120, 88
 MVA 184, 120, 92
 MVA 184, 56, 28
 RT 56, 18, 0
 MVA 188, 60, 28
 MVA 188, 124, 92
 RT 58, 18, 2048
 MVA 180, 124, 88
 MVA 180, 60, 24
 MAA 188, 60, 12
 s_mov_b32 s61, s65
 MAA 188, 124, 76
 s_add_u32 s3, s60, s62
 v_add_u32 v11, s3, v41
 MAA 180, 124, 72
 MAA 180, 60, 8
 RT 60, 19, 0
 RT 62, 19, 2048
 s_waitcnt lgkmcnt(2)
 MVA 192, 96, 64
 MVA 192, 32, 0
 MVA 200, 32, 4
 MVA 200, 96, 68
 MVA 64, 96, 80
 MVA 64, 32, 16
 s_waitcnt vmcnt(16) lgkmcnt(0)
 s_barrier
 MVA 72, 32, 20
 MVA 72, 96, 84
 RT 96, 12, 16384
 s_add_u32 m0, s42, 0
 MVA 76, 100, 84
 DMA 24, 12, 38, 0
 MVA 76, 36, 20
 RT 98, 12, 18432
 MVA 68, 36, 16
 MVA 68, 100, 80
 RA 8, 10, 4096
 MVA 204, 100, 68
 DMA 25, 12, 38, 1024
 MVA 204, 36, 4
 RA 12, 10, 6144
 MVA 196, 36, 0
 MVA 196, 100, 64
 RT 100, 13, 16384
 MVA 208, 104, 64
 DMA 26, 12, 38, 2048
 MVA 208, 40, 0
 RT 102, 13, 18432
 MVA 216, 40, 4
 MVA 216, 104, 68
 RA 24, 10, 12288
 MVA 80, 104, 80
 DMA 27, 12, 38, 3072
 MVA 80, 40, 16
 RA 28, 10, 14336
 MVA 88, 40, 20
 MVA 88, 104, 84
 RT 104, 14, 16384
 s_add_u32 m0, s40, s61
 MVA 92, 108, 84
 DMA 20, 8, 36, 0
 MVA 92, 44, 20
 RT 106, 14, 18432
 MVA 84, 44, 16
 MVA 84, 108, 80
 RA 72, 11, 4096
 MVA 220, 108, 68
 DMA 21, 8, 36, 1024
 MVA 220, 44, 4
 RA 76, 11, 6144
 MVA 212, 44, 0
 MVA 212, 108, 64
 RT 108, 15, 16384
 MVA 224, 112, 64
 DMA 22, 8, 36, 2048
 MVA 224, 48, 0
 RT 110, 15, 18432
 MVA 232, 48, 4
 MVA 232, 112, 68
 RA 88, 11, 12288
 MVA 96, 112, 80
 DMA 23, 8, 36, 3072
 MVA 96, 48, 16
 RA 92, 11, 14336
 MVA 104, 48, 20
 MVA 104, 112, 84
 RT 112, 16, 16384
 MVA 108, 116, 84
 s_add_u32 s38, s38, 262144
 MVA 108, 52, 20
 RT 114, 16, 18432
 MVA 100, 52, 16
 s_add_u32 s36, s36, 128
 MVA 100, 116, 80
 MVA 236, 116, 68
 MVA 236, 52, 4
 MVA 228, 52, 0
 MVA 228, 116, 64
 RT 116, 17, 16384
 MVA 240, 120, 64
 MVA 240, 56, 0
 RT 118, 17, 18432
 MVA 248, 56, 4
 MVA 248, 120, 68
 MVA 112, 120, 80
 MVA 112, 56, 16
 MVA 120, 56, 20
 MVA 120, 120, 84
 RT 120, 18, 16384
 MVA 124, 124, 84
 MVA 124, 60, 20
 RT 122, 18, 18432
 MVA 116, 60, 16
 MVA 116, 124, 80
 s_mov_b32 s65, s60
 s_add_u32 s60, s60, 32768
 MVA 252, 124, 68
 s_cmp_eq_u32 s60, 163840
 s_cselect_b32 s60, 65536, s60
 MVA 252, 60, 4
 s_add_u32 s3, s60, s62
 v_add_u32 v10, s3, v40
 MVA 244, 60, 0
 MVA 244, 124, 64
 RT 124, 19, 16384
 RT 126, 19, 18432
 s_waitcnt lgkmcnt(2)
 MAA 128, 32, 8
 MAA 128, 96, 72
 MAA 136, 96, 76
 MAA 136, 32, 12
 MVA 128, 32, 24
 MVA 128, 96, 88
 s_waitcnt vmcnt(16) lgkmcnt(0)
 s_barrier
 s_cmp_eq_u32 s52, 1
 s_cbranch_scc1 P1_OC0
 s_cmp_eq_u32 s52, 6
 s_cbranch_scc1 P1_OS0
P1_OB0:
 MVA 136, 96, 92
 MVA 136, 32, 28
 RT 32, 12, 32768
 s_add_u32 m0, s42, 16384
 MVA 140, 36, 28
 DMA 24, 12, 38, 0
 MVA 140, 100, 92
 RT 34, 12, 34816
 MVA 132, 100, 88
 MVA 132, 36, 24
 RA 64, 11, 0
 MAA 140, 36, 12
 DMA 25, 12, 38, 1024
 MAA 140, 100, 76
 RA 68, 11, 2048
 MAA 132, 100, 72
 MAA 132, 36, 8
 RT 36, 13, 32768
 MAA 144, 40, 8
 DMA 26, 12, 38, 2048
 MAA 144, 104, 72
 RT 38, 13, 34816
 MAA 152, 104, 76
 MAA 152, 40, 12
 RA 80, 11, 8192
 MVA 144, 40, 24
 DMA 27, 12, 38, 3072
 MVA 144, 104, 88
 RA 84, 11, 10240
 MVA 152, 104, 92
 MVA 152, 40, 28
 RT 40, 14, 32768
 s_add_u32 s3, s40, 4096
 s_add_u32 m0, s3, s61
 MVA 156, 44, 28
 DMA 20, 8, 37, 0
 MVA 156, 108, 92
 RT 42, 14, 34816
 MVA 148, 108, 88
 MVA 148, 44, 24
 RA 0, 10, 0
 MAA 156, 44, 12
 DMA 21, 8, 37, 1024
 MAA 156, 108, 76
 RA 4, 10, 2048
 MAA 148, 108, 72
 MAA 148, 44, 8
 RT 44, 15, 32768
 MAA 160, 48, 8
 DMA 22, 8, 37, 2048
 MAA 160, 112, 72
 RT 46, 15, 34816
 MAA 168, 112, 76
 MAA 168, 48, 12
 RA 16, 10, 8192
 MVA 160, 48, 24
 DMA 23, 8, 37, 3072
 MVA 160, 112, 88
 RA 20, 10, 10240
 MVA 168, 112, 92
 MVA 168, 48, 28
 RT 48, 16, 32768
 MVA 172, 52, 28
 s_add_u32 s38, s38, 262144
 MVA 172, 116, 92
 RT 50, 16, 34816
 MVA 164, 116, 88
 s_add_u32 s37, s37, 128
 MVA 164, 52, 24
 MAA 172, 52, 12
 MAA 172, 116, 76
 MAA 164, 116, 72
 MAA 164, 52, 8
 RT 52, 17, 32768
 MAA 176, 56, 8
 MAA 176, 120, 72
 RT 54, 17, 34816
 MAA 184, 120, 76
 MAA 184, 56, 12
 MVA 176, 56, 24
 MVA 176, 120, 88
 MVA 184, 120, 92
 MVA 184, 56, 28
 RT 56, 18, 32768
 MVA 188, 60, 28
 MVA 188, 124, 92
 RT 58, 18, 34816
 MVA 180, 124, 88
 MVA 180, 60, 24
 MAA 188, 60, 12
 s_mov_b32 s61, s65
 MAA 188, 124, 76
 s_add_u32 s3, s60, s62
 v_add_u32 v11, s3, v41
 MAA 180, 124, 72
 MAA 180, 60, 8
 RT 60, 19, 32768
 RT 62, 19, 34816
 s_waitcnt lgkmcnt(2)
 MVA 192, 96, 64
 MVA 192, 32, 0
 MVA 200, 32, 4
 MVA 200, 96, 68
 MVA 64, 96, 80
 MVA 64, 32, 16
 s_waitcnt vmcnt(16) lgkmcnt(0)
 s_barrier
 MVA 72, 32, 20
 MVA 72, 96, 84
 RT 96, 12, 49152
 s_add_u32 m0, s42, 32768
 MVA 76, 100, 84
 DMA 24, 12, 38, 0
 MVA 76, 36, 20
 RT 98, 12, 51200
 MVA 68, 36, 16
 MVA 68, 100, 80
 RA 8, 10, 4096
 MVA 204, 100, 68
 DMA 25, 12, 38, 1024
 MVA 204, 36, 4
 RA 12, 10, 6144
 MVA 196, 36, 0
 MVA 196, 100, 64
 RT 100, 13, 49152
 MVA 208, 104, 64
 DMA 26, 12, 38, 2048
 MVA 208, 40, 0
 RT 102, 13, 51200
 MVA 216, 40, 4
 MVA 216, 104, 68
 RA 24, 10, 12288
 MVA 80, 104, 80
 DMA 27, 12, 38, 3072
 MVA 80, 40, 16
 RA 28, 10, 14336
 MVA 88, 40, 20
 MVA 88, 104, 84
 RT 104, 14, 49152
 s_add_u32 m0, s40, s61
 MVA 92, 108, 84
 DMA 20, 8, 36, 0
 MVA 92, 44, 20
 RT 106, 14, 51200
 MVA 84, 44, 16
 MVA 84, 108, 80
 RA 72, 11, 4096
 MVA 220, 108, 68
 DMA 21, 8, 36, 1024
 MVA 220, 44, 4
 RA 76, 11, 6144
 MVA 212, 44, 0
 MVA 212, 108, 64
 RT 108, 15, 49152
 MVA 224, 112, 64
 DMA 22, 8, 36, 2048
 MVA 224, 48, 0
 RT 110, 15, 51200
 MVA 232, 48, 4
 MVA 232, 112, 68
 RA 88, 11, 12288
 MVA 96, 112, 80
 DMA 23, 8, 36, 3072
 MVA 96, 48, 16
 RA 92, 11, 14336
 MVA 104, 48, 20
 MVA 104, 112, 84
 RT 112, 16, 49152
 MVA 108, 116, 84
 s_add_u32 s38, s38, 262144
 MVA 108, 52, 20
 RT 114, 16, 51200
 MVA 100, 52, 16
 s_add_u32 s36, s36, 128
 MVA 100, 116, 80
 MVA 236, 116, 68
 MVA 236, 52, 4
 MVA 228, 52, 0
 MVA 228, 116, 64
 RT 116, 17, 49152
 MVA 240, 120, 64
 MVA 240, 56, 0
 RT 118, 17, 51200
 MVA 248, 56, 4
 MVA 248, 120, 68
 MVA 112, 120, 80
 MVA 112, 56, 16
 MVA 120, 56, 20
 MVA 120, 120, 84
 RT 120, 18, 49152
 MVA 124, 124, 84
 MVA 124, 60, 20
 RT 122, 18, 51200
 s_mov_b32 s65, s60
 s_add_u32 s60, s60, 32768
 MVA 116, 60, 16
 s_cmp_eq_u32 s60, 163840
 s_cselect_b32 s60, 65536, s60
 MVA 116, 124, 80
 s_add_u32 s3, s60, s62
 v_add_u32 v10, s3, v40
 MVA 252, 124, 68
 s_sub_u32 s52, s52, 1
 MVA 252, 60, 4
 s_cmp_gt_u32 s52, 0
 MVA 244, 60, 0
 MVA 244, 124, 64
 RT 124, 19, 49152
 RT 126, 19, 51200
 s_cbranch_scc1 P1_LOOP0
P1_LE0:
 s_waitcnt lgkmcnt(2)
 MAA 128, 32, 8
 MAA 128, 96, 72
 MAA 136, 96, 76
 MAA 136, 32, 12
 MVA 128, 32, 24
 MVA 128, 96, 88
 s_waitcnt vmcnt(16) lgkmcnt(0)
 s_barrier
 MVA 136, 96, 92
 MVA 136, 32, 28
 RT 32, 12, 0
 s_add_u32 m0, s42, 49152
 MVA 140, 36, 28
 DMA 24, 12, 38, 0
 MVA 140, 100, 92
 RT 34, 12, 2048
 MVA 132, 100, 88
 MVA 132, 36, 24
 RA 64, 11, 0
 MAA 140, 36, 12
 DMA 25, 12, 38, 1024
 MAA 140, 100, 76
 RA 68, 11, 2048
 MAA 132, 100, 72
 MAA 132, 36, 8
 RT 36, 13, 0
 MAA 144, 40, 8
 DMA 26, 12, 38, 2048
 MAA 144, 104, 72
 RT 38, 13, 2048
 MAA 152, 104, 76
 MAA 152, 40, 12
 RA 80, 11, 8192
 MVA 144, 40, 24
 DMA 27, 12, 38, 3072
 MVA 144, 104, 88
 RA 84, 11, 10240
 MVA 152, 104, 92
 MVA 152, 40, 28
 RT 40, 14, 0
 s_add_u32 s3, s40, 4096
 s_add_u32 m0, s3, s61
 MVA 156, 44, 28
 DMA 20, 8, 37, 0
 MVA 156, 108, 92
 RT 42, 14, 2048
 MVA 148, 108, 88
 MVA 148, 44, 24
 RA 0, 10, 0
 MAA 156, 44, 12
 DMA 21, 8, 37, 1024
 MAA 156, 108, 76
 RA 4, 10, 2048
 MAA 148, 108, 72
 MAA 148, 44, 8
 RT 44, 15, 0
 MAA 160, 48, 8
 DMA 22, 8, 37, 2048
 MAA 160, 112, 72
 RT 46, 15, 2048
 MAA 168, 112, 76
 MAA 168, 48, 12
 RA 16, 10, 8192
 MVA 160, 48, 24
 DMA 23, 8, 37, 3072
 MVA 160, 112, 88
 RA 20, 10, 10240
 MVA 168, 112, 92
 MVA 168, 48, 28
 RT 48, 16, 0
 MVA 172, 52, 28
 s_add_u32 s38, s38, 262144
 MVA 172, 116, 92
 RT 50, 16, 2048
 MVA 164, 116, 88
 s_add_u32 s37, s37, 128
 MVA 164, 52, 24
 MAA 172, 52, 12
 MAA 172, 116, 76
 MAA 164, 116, 72
 MAA 164, 52, 8
 RT 52, 17, 0
 MAA 176, 56, 8
 MAA 176, 120, 72
 RT 54, 17, 2048
 MAA 184, 120, 76
 MAA 184, 56, 12
 MVA 176, 56, 24
 MVA 176, 120, 88
 MVA 184, 120, 92
 MVA 184, 56, 28
 RT 56, 18, 0
 MVA 188, 60, 28
 MVA 188, 124, 92
 RT 58, 18, 2048
 MVA 180, 124, 88
 MVA 180, 60, 24
 MAA 188, 60, 12
 s_mov_b32 s61, s65
 MAA 188, 124, 76
 s_add_u32 s3, s60, s62
 v_add_u32 v11, s3, v41
 MAA 180, 124, 72
 MAA 180, 60, 8
 RT 60, 19, 0
 RT 62, 19, 2048
 s_waitcnt lgkmcnt(2)
 MVA 192, 96, 64
 MVA 192, 32, 0
 MVA 200, 32, 4
 MVA 200, 96, 68
 MVA 64, 96, 80
 MVA 64, 32, 16
 s_waitcnt vmcnt(16) lgkmcnt(0)
 s_barrier
 MVA 72, 32, 20
 MVA 72, 96, 84
 RT 96, 12, 16384
 s_add_u32 m0, s42, 0
 MVA 76, 100, 84
 DMA 24, 20, 78, 0
 MVA 76, 36, 20
 RT 98, 12, 18432
 MVA 68, 36, 16
 MVA 68, 100, 80
 RA 8, 10, 4096
 MVA 204, 100, 68
 DMA 25, 20, 78, 1024
 MVA 204, 36, 4
 RA 12, 10, 6144
 MVA 196, 36, 0
 MVA 196, 100, 64
 RT 100, 13, 16384
 MVA 208, 104, 64
 DMA 26, 20, 78, 2048
 MVA 208, 40, 0
 RT 102, 13, 18432
 MVA 216, 40, 4
 MVA 216, 104, 68
 RA 24, 10, 12288
 MVA 80, 104, 80
 DMA 27, 20, 78, 3072
 MVA 80, 40, 16
 RA 28, 10, 14336
 MVA 88, 40, 20
 MVA 88, 104, 84
 RT 104, 14, 16384
 s_add_u32 m0, s42, s61
 MVA 92, 108, 84
 DMA 28, 16, 76, 0
 MVA 92, 44, 20
 RT 106, 14, 18432
 MVA 84, 44, 16
 MVA 84, 108, 80
 RA 72, 11, 4096
 MVA 220, 108, 68
 DMA 29, 16, 76, 1024
 MVA 220, 44, 4
 RA 76, 11, 6144
 MVA 212, 44, 0
 MVA 212, 108, 64
 RT 108, 15, 16384
 MVA 224, 112, 64
 DMA 30, 16, 76, 2048
 MVA 224, 48, 0
 RT 110, 15, 18432
 MVA 232, 48, 4
 MVA 232, 112, 68
 RA 88, 11, 12288
 MVA 96, 112, 80
 DMA 31, 16, 76, 3072
 MVA 96, 48, 16
 RA 92, 11, 14336
 MVA 104, 48, 20
 MVA 104, 112, 84
 RT 112, 16, 16384
 MVA 108, 116, 84
 s_add_u32 s78, s78, 262144
 MVA 108, 52, 20
 RT 114, 16, 18432
 MVA 100, 52, 16
 s_add_u32 s76, s76, 128
 MVA 100, 116, 80
 MVA 236, 116, 68
 MVA 236, 52, 4
 MVA 228, 52, 0
 MVA 228, 116, 64
 RT 116, 17, 16384
 MVA 240, 120, 64
 MVA 240, 56, 0
 RT 118, 17, 18432
 MVA 248, 56, 4
 MVA 248, 120, 68
 MVA 112, 120, 80
 MVA 112, 56, 16
 MVA 120, 56, 20
 MVA 120, 120, 84
 RT 120, 18, 16384
 MVA 124, 124, 84
 MVA 124, 60, 20
 RT 122, 18, 18432
 MVA 116, 60, 16
 MVA 116, 124, 80
 s_mov_b32 s65, s60
 s_add_u32 s60, s60, 32768
 MVA 252, 124, 68
 s_cmp_eq_u32 s60, 163840
 s_cselect_b32 s60, 65536, s60
 MVA 252, 60, 4
 s_add_u32 s3, s60, s62
 v_add_u32 v10, s3, v40
 MVA 244, 60, 0
 MVA 244, 124, 64
 RT 124, 19, 16384
 RT 126, 19, 18432
 s_waitcnt lgkmcnt(2)
 MAA 128, 32, 8
 MAA 128, 96, 72
 MAA 136, 96, 76
 MAA 136, 32, 12
 MVA 128, 32, 24
 MVA 128, 96, 88
 s_waitcnt vmcnt(16) lgkmcnt(0)
 s_barrier
 v_readfirstlane_b32 s3, v37
 s_nop 0
 s_cmpk_lg_u32 s3, 256
 s_cbranch_scc1 P1_OW0
P1_OX0:
 MVA 136, 96, 92
 MVA 136, 32, 28
 RT 32, 12, 32768
 s_add_u32 m0, s42, 16384
 MVA 140, 36, 28
 DMA 24, 20, 78, 0
 MVA 140, 100, 92
 RT 34, 12, 34816
 MVA 132, 100, 88
 MVA 132, 36, 24
 RA 64, 11, 0
 MAA 140, 36, 12
 DMA 25, 20, 78, 1024
 MAA 140, 100, 76
 RA 68, 11, 2048
 MAA 132, 100, 72
 MAA 132, 36, 8
 RT 36, 13, 32768
 MAA 144, 40, 8
 DMA 26, 20, 78, 2048
 MAA 144, 104, 72
 RT 38, 13, 34816
 MAA 152, 104, 76
 MAA 152, 40, 12
 RA 80, 11, 8192
 MVA 144, 40, 24
 DMA 27, 20, 78, 3072
 MVA 144, 104, 88
 RA 84, 11, 10240
 MVA 152, 104, 92
 MVA 152, 40, 28
 RT 40, 14, 32768
 s_add_u32 s3, s42, 16384
 s_add_u32 m0, s3, s61
 MVA 156, 44, 28
 DMAS 52, 28, 77, 0
 MVA 156, 108, 92
 RT 42, 14, 34816
 MVA 148, 108, 88
 MVA 148, 44, 24
 RA 0, 10, 0
 MAA 156, 44, 12
 DMAS 52, 28, 77, 1024
 MAA 156, 108, 76
 RA 4, 10, 2048
 MAA 148, 108, 72
 MAA 148, 44, 8
 RT 44, 15, 32768
 MAA 160, 48, 8
 DMAS 52, 28, 77, 2048
 MAA 160, 112, 72
 RT 46, 15, 34816
 MAA 168, 112, 76
 MAA 168, 48, 12
 RA 16, 10, 8192
 MVA 160, 48, 24
 DMAS 52, 28, 77, 3072
 MVA 160, 112, 88
 RA 20, 10, 10240
 MVA 168, 112, 92
 MVA 168, 48, 28
 RT 48, 16, 32768
 MVA 172, 52, 28
 s_add_u32 s78, s78, 262144
 MVA 172, 116, 92
 RT 50, 16, 34816
 MVA 164, 116, 88
 s_add_u32 s77, s77, 16384
 MVA 164, 52, 24
 MAA 172, 52, 12
 MAA 172, 116, 76
 MAA 164, 116, 72
 MAA 164, 52, 8
 RT 52, 17, 32768
 MAA 176, 56, 8
 MAA 176, 120, 72
 RT 54, 17, 34816
 MAA 184, 120, 76
 MAA 184, 56, 12
 MVA 176, 56, 24
 MVA 176, 120, 88
 MVA 184, 120, 92
 MVA 184, 56, 28
 RT 56, 18, 32768
 MVA 188, 60, 28
 MVA 188, 124, 92
 RT 58, 18, 34816
 MVA 180, 124, 88
 MVA 180, 60, 24
 MAA 188, 60, 12
 s_mov_b32 s61, s65
 MAA 188, 124, 76
 s_add_u32 s3, s60, s62
 v_add_u32 v11, s3, v41
 MAA 180, 124, 72
 MAA 180, 60, 8
 RT 60, 19, 32768
 RT 62, 19, 34816
 s_waitcnt lgkmcnt(2)
 MVA 192, 96, 64
 MVA 192, 32, 0
 MVA 200, 32, 4
 MVA 200, 96, 68
 MVA 64, 96, 80
 MVA 64, 32, 16
 s_waitcnt vmcnt(16) lgkmcnt(0)
 s_barrier
 MVA 72, 32, 20
 MVA 72, 96, 84
 RT 96, 12, 49152
 s_add_u32 m0, s42, 32768
 MVA 76, 100, 84
 DMA 24, 20, 78, 0
 MVA 76, 36, 20
 RT 98, 12, 51200
 MVA 68, 36, 16
 MVA 68, 100, 80
 RA 8, 10, 4096
 MVA 204, 100, 68
 DMA 25, 20, 78, 1024
 MVA 204, 36, 4
 RA 12, 10, 6144
 MVA 196, 36, 0
 MVA 196, 100, 64
 RT 100, 13, 49152
 MVA 208, 104, 64
 DMA 26, 20, 78, 2048
 MVA 208, 40, 0
 RT 102, 13, 51200
 MVA 216, 40, 4
 MVA 216, 104, 68
 RA 24, 10, 12288
 MVA 80, 104, 80
 DMA 27, 20, 78, 3072
 MVA 80, 40, 16
 RA 28, 10, 14336
 MVA 88, 40, 20
 MVA 88, 104, 84
 RT 104, 14, 49152
 s_add_u32 m0, s42, s61
 MVA 92, 108, 84
 DMA 28, 16, 76, 0
 MVA 92, 44, 20
 RT 106, 14, 51200
 MVA 84, 44, 16
 MVA 84, 108, 80
 RA 72, 11, 4096
 MVA 220, 108, 68
 DMA 29, 16, 76, 1024
 MVA 220, 44, 4
 RA 76, 11, 6144
 MVA 212, 44, 0
 MVA 212, 108, 64
 RT 108, 15, 49152
 MVA 224, 112, 64
 DMA 30, 16, 76, 2048
 MVA 224, 48, 0
 RT 110, 15, 51200
 MVA 232, 48, 4
 MVA 232, 112, 68
 RA 88, 11, 12288
 MVA 96, 112, 80
 DMA 31, 16, 76, 3072
 MVA 96, 48, 16
 RA 92, 11, 14336
 MVA 104, 48, 20
 MVA 104, 112, 84
 RT 112, 16, 49152
 MVA 108, 116, 84
 s_add_u32 s78, s78, 262144
 MVA 108, 52, 20
 RT 114, 16, 51200
 MVA 100, 52, 16
 s_add_u32 s76, s76, 128
 MVA 100, 116, 80
 MVA 236, 116, 68
 MVA 236, 52, 4
 MVA 228, 52, 0
 MVA 228, 116, 64
 RT 116, 17, 49152
 MVA 240, 120, 64
 MVA 240, 56, 0
 RT 118, 17, 51200
 MVA 248, 56, 4
 MVA 248, 120, 68
 MVA 112, 120, 80
 MVA 112, 56, 16
 MVA 120, 56, 20
 MVA 120, 120, 84
 RT 120, 18, 49152
 MVA 124, 124, 84
 MVA 124, 60, 20
 RT 122, 18, 51200
 MVA 116, 60, 16
 MVA 116, 124, 80
 s_mov_b32 s65, s60
 s_add_u32 s60, s60, 32768
 MVA 252, 124, 68
 s_cmp_eq_u32 s60, 163840
 s_cselect_b32 s60, 65536, s60
 MVA 252, 60, 4
 v_add_u32 v10, s60, v40
 MVA 244, 60, 0
 MVA 244, 124, 64
 RT 124, 19, 49152
 RT 126, 19, 51200
 s_waitcnt lgkmcnt(2)
 MAA 128, 32, 8
 MAA 128, 96, 72
 MAA 136, 96, 76
 MAA 136, 32, 12
 MVA 128, 32, 24
 MVA 128, 96, 88
 s_waitcnt vmcnt(16) lgkmcnt(0)
 s_barrier
 MVA 136, 96, 92
 MVA 136, 32, 28
 s_add_u32 m0, s42, 49152
 MVA 140, 36, 28
 DMA 24, 20, 78, 0
 MVA 140, 100, 92
 MVA 132, 100, 88
 MVA 132, 36, 24
 RA 64, 11, 0
 MAA 140, 36, 12
 DMA 25, 20, 78, 1024
 MAA 140, 100, 76
 RA 68, 11, 2048
 MAA 132, 100, 72
 MAA 132, 36, 8
 MAA 144, 40, 8
 DMA 26, 20, 78, 2048
 MAA 144, 104, 72
 MAA 152, 104, 76
 MAA 152, 40, 12
 RA 80, 11, 8192
 MVA 144, 40, 24
 DMA 27, 20, 78, 3072
 MVA 144, 104, 88
 RA 84, 11, 10240
 MVA 152, 104, 92
 MVA 152, 40, 28
 s_add_u32 s3, s42, 16384
 s_add_u32 m0, s3, s61
 MVA 156, 44, 28
 DMAS 52, 28, 77, 0
 v_accvgpr_read_b32 v56, a128
 MVA 156, 108, 92
 v_accvgpr_read_b32 v57, a129
 v_accvgpr_read_b32 v58, a130
 MVA 148, 108, 88
 v_accvgpr_read_b32 v59, a131
 v_accvgpr_read_b32 v60, a132
 MVA 148, 44, 24
 v_accvgpr_read_b32 v61, a133
 v_accvgpr_read_b32 v62, a134
 MAA 156, 44, 12
 DMAS 52, 28, 77, 1024
 v_accvgpr_read_b32 v63, a135
 MAA 156, 108, 76
 CV 56, 56, 57
 CV 57, 58, 59
 MAA 148, 108, 72
 CV 58, 60, 61
 CV 59, 62, 63
 MAA 148, 44, 8
 s_add_u32 s50, s48, 33792
 buffer_store_dwordx4 v[56:59], v52, s[28:31], s50 offen offset:0 sc1
 MAA 160, 48, 8
 DMAS 52, 28, 77, 2048
 v_accvgpr_read_b32 v2, a136
 MAA 160, 112, 72
 v_accvgpr_read_b32 v3, a137
 v_accvgpr_read_b32 v4, a138
 MAA 168, 112, 76
 v_accvgpr_read_b32 v5, a139
 v_accvgpr_read_b32 v6, a140
 MAA 168, 48, 12
 v_accvgpr_read_b32 v7, a141
 v_accvgpr_read_b32 v8, a142
 MVA 160, 48, 24
 DMAS 52, 28, 77, 3072
 v_accvgpr_read_b32 v9, a143
 MVA 160, 112, 88
 CV 2, 2, 3
 CV 3, 4, 5
 MVA 168, 112, 92
 CV 4, 6, 7
 CV 5, 8, 9
 MVA 168, 48, 28
 buffer_store_dwordx4 v[2:5], v52, s[28:31], s50 offen offset:1024 sc1
 MVA 172, 52, 28
 s_add_u32 s78, s78, 262144
 v_accvgpr_read_b32 v56, a144
 MVA 172, 116, 92
 v_accvgpr_read_b32 v57, a145
 v_accvgpr_read_b32 v58, a146
 MVA 164, 116, 88
 s_add_u32 s77, s77, 16384
 v_accvgpr_read_b32 v59, a147
 MVA 164, 52, 24
 v_accvgpr_read_b32 v60, a148
 v_accvgpr_read_b32 v61, a149
 MAA 172, 52, 12
 v_accvgpr_read_b32 v62, a150
 v_accvgpr_read_b32 v63, a151
 MAA 172, 116, 76
 CV 56, 56, 57
 CV 57, 58, 59
 MAA 164, 116, 72
 CV 58, 60, 61
 CV 59, 62, 63
 MAA 164, 52, 8
 buffer_store_dwordx4 v[56:59], v52, s[28:31], s50 offen offset:2048 sc1
 CV 128, 128, 129
 MAA 176, 56, 8
 CV 129, 130, 131
 CV 130, 132, 133
 MAA 176, 120, 72
 CV 131, 134, 135
 CV 136, 136, 137
 MAA 184, 120, 76
 CV 137, 138, 139
 CV 138, 140, 141
 MAA 184, 56, 12
 CV 139, 142, 143
 CV 144, 144, 145
 MVA 176, 56, 24
 CV 145, 146, 147
 CV 146, 148, 149
 MVA 176, 120, 88
 CV 147, 150, 151
 CV 152, 152, 153
 MVA 184, 120, 92
 CV 153, 154, 155
 CV 154, 156, 157
 MVA 184, 56, 28
 CV 155, 158, 159
 CV 160, 160, 161
 MVA 188, 60, 28
 CV 161, 162, 163
 CV 162, 164, 165
 MVA 188, 124, 92
 CV 163, 166, 167
 CV 168, 168, 169
 MVA 180, 124, 88
 CV 169, 170, 171
 CV 170, 172, 173
 MVA 180, 60, 24
 CV 171, 174, 175
 MAA 188, 60, 12
 s_mov_b32 s61, s65
 MAA 188, 124, 76
 v_add_u32 v11, s60, v41
 MAA 180, 124, 72
 MAA 180, 60, 8
 s_waitcnt lgkmcnt(0)
 MVA 192, 96, 64
 MVA 200, 96, 68
 MVA 64, 96, 80
 MVA 72, 96, 84
 MVA 76, 100, 84
 MVA 68, 100, 80
 s_waitcnt vmcnt(19) lgkmcnt(0)
 s_barrier
 MVA 204, 100, 68
 CV 176, 176, 177
 CV 177, 178, 179
 MVA 196, 100, 64
 s_add_u32 m0, s42, s61
 CV 178, 180, 181
 MVA 208, 104, 64
 DMA 28, 16, 76, 0
 CV 179, 182, 183
 MVA 216, 104, 68
 CV 184, 184, 185
 CV 185, 186, 187
 MVA 80, 104, 80
 DMA 29, 16, 76, 1024
 CV 186, 188, 189
 MVA 88, 104, 84
 CV 187, 190, 191
 MVA 92, 108, 84
 DMA 30, 16, 76, 2048
 MVA 84, 108, 80
 MVA 220, 108, 68
 DMA 31, 16, 76, 3072
 CV 64, 64, 65
 MVA 212, 108, 64
 CV 65, 66, 67
 CV 66, 68, 69
 MVA 224, 112, 64
 s_add_u32 s76, s76, 128
 CV 67, 70, 71
 MVA 232, 112, 68
 CV 192, 192, 193
 CV 193, 194, 195
 MVA 96, 112, 80
 CV 194, 196, 197
 CV 195, 198, 199
 MVA 104, 112, 84
 CV 72, 72, 73
 CV 73, 74, 75
 MVA 108, 116, 84
 CV 74, 76, 77
 CV 75, 78, 79
 MVA 100, 116, 80
 CV 200, 200, 201
 CV 201, 202, 203
 MVA 236, 116, 68
 CV 202, 204, 205
 CV 203, 206, 207
 MVA 228, 116, 64
 CV 80, 80, 81
 CV 81, 82, 83
 MVA 240, 120, 64
 CV 82, 84, 85
 CV 83, 86, 87
 MVA 248, 120, 68
 CV 208, 208, 209
 CV 209, 210, 211
 MVA 112, 120, 80
 CV 210, 212, 213
 CV 211, 214, 215
 MVA 120, 120, 84
 CV 88, 88, 89
 CV 89, 90, 91
 MVA 124, 124, 84
 CV 90, 92, 93
 CV 91, 94, 95
 MVA 116, 124, 80
 CV 216, 216, 217
 CV 217, 218, 219
 MVA 252, 124, 68
 CV 218, 220, 221
 CV 219, 222, 223
 MVA 244, 124, 64
 s_nop 7
 CV 96, 96, 97
 CV 97, 98, 99
 CV 98, 100, 101
 CV 99, 102, 103
 CV 224, 224, 225
 CV 225, 226, 227
 CV 226, 228, 229
 CV 227, 230, 231
 CV 104, 104, 105
 CV 105, 106, 107
 CV 106, 108, 109
 CV 107, 110, 111
 CV 232, 232, 233
 CV 233, 234, 235
 CV 234, 236, 237
 CV 235, 238, 239
 CV 112, 112, 113
 CV 113, 114, 115
 CV 114, 116, 117
 CV 115, 118, 119
 CV 240, 240, 241
 CV 241, 242, 243
 CV 242, 244, 245
 CV 243, 246, 247
 CV 120, 120, 121
 CV 121, 122, 123
 CV 122, 124, 125
 CV 123, 126, 127
 CV 248, 248, 249
 CV 249, 250, 251
 CV 250, 252, 253
 CV 251, 254, 255
 s_cmp_eq_u32 s4, 2
 s_cbranch_scc1 P1_B1
 s_cmp_eq_u32 s4, 3
 s_cbranch_scc1 P1_B2
 s_branch P1_JOBB
P1_OC0:
 buffer_load_dword v37, v39, s[68:71], 0 offen sc1
 s_branch P1_OB0
P1_OS0:
 buffer_store_dwordx4 a[248:251], v52, s[28:31], s63 offen sc1
 buffer_store_dwordx4 a[252:255], v52, s[28:31], s64 offen sc1
 s_branch P1_OB0
P1_OW0:
 s_sleep 4
 buffer_load_dword v37, v39, s[68:71], 0 offen sc1
 s_waitcnt vmcnt(0)
 v_readfirstlane_b32 s3, v37
 s_nop 0
 s_cmpk_lg_u32 s3, 256
 s_cbranch_scc1 P1_OW0
 s_branch P1_OX0
P1_AV:
 RT 32, 12, 0
 RT 34, 12, 2048
 RA 0, 10, 0
 RA 4, 10, 2048
 RA 16, 10, 8192
 RA 20, 10, 10240
 RT 36, 13, 0
 RT 38, 13, 2048
 RT 40, 14, 0
 RT 42, 14, 2048
 RT 44, 15, 0
 RT 46, 15, 2048
 RT 48, 16, 0
 RT 50, 16, 2048
 RT 52, 17, 0
 RT 54, 17, 2048
 RT 56, 18, 0
 RT 58, 18, 2048
 RT 60, 19, 0
 RT 62, 19, 2048
 s_waitcnt lgkmcnt(0)
 MVZ 192, 0, 32
 s_waitcnt vmcnt(17) lgkmcnt(0)
 s_barrier
 MVZ 196, 4, 32
 RA 8, 10, 4096
 s_add_u32 m0, s40, 102400
 MVZ 64, 16, 32
 RA 12, 10, 6144
 DMA 20, 8, 37, 0
 MVZ 68, 20, 32
 RA 24, 10, 12288
 MVZ 76, 20, 36
 RA 28, 10, 14336
 DMA 21, 8, 37, 1024
 MVZ 72, 16, 36
 RT 96, 12, 16384
 MVZ 204, 4, 36
 RT 98, 12, 18432
 DMA 22, 8, 37, 2048
 MVZ 200, 0, 36
 RA 72, 11, 4096
 MVZ 208, 0, 40
 RA 76, 11, 6144
 DMA 23, 8, 37, 3072
 MVZ 212, 4, 40
 RA 88, 11, 12288
 s_add_u32 s37, s37, 128
 s_add_u32 m0, s42, 0
 MVZ 80, 16, 40
 RA 92, 11, 14336
 DMA 24, 12, 38, 0
 MVZ 84, 20, 40
 RT 100, 13, 16384
 MVZ 92, 20, 44
 RT 102, 13, 18432
 DMA 25, 12, 38, 1024
 MVZ 88, 16, 44
 RT 104, 14, 16384
 MVZ 220, 4, 44
 RT 106, 14, 18432
 DMA 26, 12, 38, 2048
 MVZ 216, 0, 44
 RT 108, 15, 16384
 MVZ 224, 0, 48
 RT 110, 15, 18432
 DMA 27, 12, 38, 3072
 MVZ 228, 4, 48
 RT 112, 16, 16384
 s_add_u32 m0, s40, s61
 MVZ 96, 16, 48
 RT 114, 16, 18432
 DMA 20, 8, 36, 0
 MVZ 100, 20, 48
 RT 116, 17, 16384
 MVZ 108, 20, 52
 RT 118, 17, 18432
 DMA 21, 8, 36, 1024
 MVZ 104, 16, 52
 RT 120, 18, 16384
 MVZ 236, 4, 52
 RT 122, 18, 18432
 DMA 22, 8, 36, 2048
 MVZ 232, 0, 52
 RT 124, 19, 16384
 MVZ 240, 0, 56
 RT 126, 19, 18432
 DMA 23, 8, 36, 3072
 MVZ 244, 4, 56
 MVZ 112, 16, 56
 s_add_u32 s38, s38, 262144
 MVZ 116, 20, 56
 s_mov_b32 s65, s60
 s_add_u32 s60, s60, 32768
 MVZ 124, 20, 60
 s_add_u32 s36, s36, 128
 s_cmp_eq_u32 s60, 163840
 s_cselect_b32 s60, 65536, s60
 MVZ 120, 16, 60
 s_add_u32 s3, s60, s62
 v_add_u32 v10, s3, v40
 MVZ 252, 4, 60
 MVZ 248, 0, 60
 s_waitcnt lgkmcnt(0)
 MAZ 128, 8, 32
 MAA 128, 72, 96
 MAZ 132, 76, 96
 MAA 132, 12, 32
 MVZ 128, 24, 32
 MVA 128, 88, 96
 s_waitcnt vmcnt(21) lgkmcnt(0)
 s_barrier
 MVZ 132, 92, 96
 MVA 132, 28, 32
 RT 32, 12, 32768
 s_add_u32 m0, s42, 16384
 MVZ 140, 28, 36
 DMA 24, 12, 38, 0
 MVA 140, 92, 100
 RT 34, 12, 34816
 MVZ 136, 88, 100
 MVA 136, 24, 36
 RA 64, 11, 0
 MAZ 140, 12, 36
 DMA 25, 12, 38, 1024
 MAA 140, 76, 100
 RA 68, 11, 2048
 MAZ 136, 72, 100
 MAA 136, 8, 36
 RT 36, 13, 32768
 MAZ 144, 8, 40
 DMA 26, 12, 38, 2048
 MAA 144, 72, 104
 RT 38, 13, 34816
 MAZ 148, 76, 104
 MAA 148, 12, 40
 RA 80, 11, 8192
 MVZ 144, 24, 40
 DMA 27, 12, 38, 3072
 MVA 144, 88, 104
 RA 84, 11, 10240
 MVZ 148, 92, 104
 MVA 148, 28, 40
 RT 40, 14, 32768
 s_add_u32 s3, s40, 4096
 s_add_u32 m0, s3, s61
 MVZ 156, 28, 44
 DMA 20, 8, 37, 0
 MVA 156, 92, 108
 RT 42, 14, 34816
 MVZ 152, 88, 108
 MVA 152, 24, 44
 RA 0, 10, 0
 MAZ 156, 12, 44
 DMA 21, 8, 37, 1024
 MAA 156, 76, 108
 RA 4, 10, 2048
 MAZ 152, 72, 108
 MAA 152, 8, 44
 RT 44, 15, 32768
 MAZ 160, 8, 48
 DMA 22, 8, 37, 2048
 MAA 160, 72, 112
 RT 46, 15, 34816
 MAZ 164, 76, 112
 MAA 164, 12, 48
 RA 16, 10, 8192
 MVZ 160, 24, 48
 DMA 23, 8, 37, 3072
 MVA 160, 88, 112
 RA 20, 10, 10240
 MVZ 164, 92, 112
 MVA 164, 28, 48
 RT 48, 16, 32768
 MVZ 172, 28, 52
 s_add_u32 s38, s38, 262144
 MVA 172, 92, 116
 RT 50, 16, 34816
 MVZ 168, 88, 116
 s_add_u32 s37, s37, 128
 MVA 168, 24, 52
 MAZ 172, 12, 52
 MAA 172, 76, 116
 MAZ 168, 72, 116
 MAA 168, 8, 52
 RT 52, 17, 32768
 MAZ 176, 8, 56
 MAA 176, 72, 120
 RT 54, 17, 34816
 MAZ 180, 76, 120
 MAA 180, 12, 56
 MVZ 176, 24, 56
 MVA 176, 88, 120
 MVZ 180, 92, 120
 MVA 180, 28, 56
 RT 56, 18, 32768
 MVZ 188, 28, 60
 MVA 188, 92, 124
 RT 58, 18, 34816
 MVZ 184, 88, 124
 MVA 184, 24, 60
 MAZ 188, 12, 60
 s_mov_b32 s61, s65
 MAA 188, 76, 124
 s_add_u32 s3, s60, s62
 v_add_u32 v11, s3, v41
 MAZ 184, 72, 124
 MAA 184, 8, 60
 RT 60, 19, 32768
 RT 62, 19, 34816
 s_waitcnt lgkmcnt(2)
 MVA 192, 64, 96
 MVA 192, 0, 32
 MVA 196, 4, 32
 MVA 196, 68, 96
 MVA 64, 80, 96
 MVA 64, 16, 32
 s_waitcnt vmcnt(16) lgkmcnt(0)
 s_barrier
 MVA 68, 20, 32
 MVA 68, 84, 96
 RT 96, 12, 49152
 s_add_u32 m0, s42, 32768
 MVA 76, 84, 100
 DMA 24, 12, 38, 0
 MVA 76, 20, 36
 RT 98, 12, 51200
 MVA 72, 16, 36
 MVA 72, 80, 100
 RA 8, 10, 4096
 MVA 204, 68, 100
 DMA 25, 12, 38, 1024
 MVA 204, 4, 36
 RA 12, 10, 6144
 MVA 200, 0, 36
 MVA 200, 64, 100
 RT 100, 13, 49152
 MVA 208, 64, 104
 DMA 26, 12, 38, 2048
 MVA 208, 0, 40
 RT 102, 13, 51200
 MVA 212, 4, 40
 MVA 212, 68, 104
 RA 24, 10, 12288
 MVA 80, 80, 104
 DMA 27, 12, 38, 3072
 MVA 80, 16, 40
 RA 28, 10, 14336
 MVA 84, 20, 40
 MVA 84, 84, 104
 RT 104, 14, 49152
 s_add_u32 m0, s40, s61
 MVA 92, 84, 108
 DMA 20, 8, 36, 0
 MVA 92, 20, 44
 RT 106, 14, 51200
 MVA 88, 16, 44
 MVA 88, 80, 108
 RA 72, 11, 4096
 MVA 220, 68, 108
 DMA 21, 8, 36, 1024
 MVA 220, 4, 44
 RA 76, 11, 6144
 MVA 216, 0, 44
 MVA 216, 64, 108
 RT 108, 15, 49152
 MVA 224, 64, 112
 DMA 22, 8, 36, 2048
 MVA 224, 0, 48
 RT 110, 15, 51200
 MVA 228, 4, 48
 MVA 228, 68, 112
 RA 88, 11, 12288
 MVA 96, 80, 112
 DMA 23, 8, 36, 3072
 MVA 96, 16, 48
 RA 92, 11, 14336
 MVA 100, 20, 48
 MVA 100, 84, 112
 RT 112, 16, 49152
 MVA 108, 84, 116
 s_add_u32 s38, s38, 262144
 MVA 108, 20, 52
 RT 114, 16, 51200
 MVA 104, 16, 52
 s_add_u32 s36, s36, 128
 MVA 104, 80, 116
 MVA 236, 68, 116
 MVA 236, 4, 52
 MVA 232, 0, 52
 MVA 232, 64, 116
 RT 116, 17, 49152
 MVA 240, 64, 120
 MVA 240, 0, 56
 RT 118, 17, 51200
 MVA 244, 4, 56
 MVA 244, 68, 120
 MVA 112, 80, 120
 MVA 112, 16, 56
 MVA 116, 20, 56
 MVA 116, 84, 120
 RT 120, 18, 49152
 MVA 124, 84, 124
 MVA 124, 20, 60
 RT 122, 18, 51200
 MVA 120, 16, 60
 MVA 120, 80, 124
 s_mov_b32 s65, s60
 s_add_u32 s60, s60, 32768
 MVA 252, 68, 124
 s_cmp_eq_u32 s60, 163840
 s_cselect_b32 s60, 65536, s60
 MVA 252, 4, 60
 s_add_u32 s3, s60, s62
 v_add_u32 v10, s3, v40
 MVA 248, 0, 60
 MVA 248, 64, 124
 RT 124, 19, 49152
 RT 126, 19, 51200
 s_mov_b32 s52, 6
.p2align 6
P1_LOOP1:
 s_waitcnt lgkmcnt(2)
 MAA 128, 8, 32
 MAA 128, 72, 96
 MAA 132, 76, 96
 MAA 132, 12, 32
 MVA 128, 24, 32
 MVA 128, 88, 96
 s_waitcnt vmcnt(16) lgkmcnt(0)
 s_barrier
 s_cmp_lg_u32 s52, 4
 s_cbranch_scc1 P1_ON1
 s_cmp_lg_u32 s4, 0
 s_cbranch_scc1 P1_OM1
 s_mov_b64 exec, 1
 buffer_atomic_add v36, v39, s[68:71], 0 offen sc1
 s_mov_b64 exec, -1
P1_OM1:
 s_cmp_lg_u32 s4, 3
 s_cbranch_scc1 P1_ON1
 buffer_load_dwordx4 a[192:195], v50, s[32:35], 0 offen offset:0
 buffer_load_dwordx4 a[196:199], v50, s[32:35], 0 offen offset:64
 buffer_load_dwordx4 a[200:203], v50, s[32:35], 0 offen offset:128
 buffer_load_dwordx4 a[204:207], v50, s[32:35], 0 offen offset:192
 buffer_load_dwordx4 a[208:211], v50, s[32:35], 0 offen offset:256
 buffer_load_dwordx4 a[212:215], v50, s[32:35], 0 offen offset:320
 buffer_load_dwordx4 a[216:219], v50, s[32:35], 0 offen offset:384
 buffer_load_dwordx4 a[220:223], v50, s[32:35], 0 offen offset:448
 buffer_load_dwordx4 a[224:227], v50, s[32:35], 0 offen offset:512
 buffer_load_dwordx4 a[228:231], v50, s[32:35], 0 offen offset:576
 buffer_load_dwordx4 a[232:235], v50, s[32:35], 0 offen offset:640
 buffer_load_dwordx4 a[236:239], v50, s[32:35], 0 offen offset:704
 buffer_load_dwordx4 a[240:243], v50, s[32:35], 0 offen offset:768
 buffer_load_dwordx4 a[244:247], v50, s[32:35], 0 offen offset:832
P1_ON1:
 MVA 132, 92, 96
 MVA 132, 28, 32
 RT 32, 12, 0
 s_add_u32 m0, s42, 49152
 MVA 140, 28, 36
 DMA 24, 12, 38, 0
 MVA 140, 92, 100
 RT 34, 12, 2048
 MVA 136, 88, 100
 MVA 136, 24, 36
 RA 64, 11, 0
 MAA 140, 12, 36
 DMA 25, 12, 38, 1024
 MAA 140, 76, 100
 RA 68, 11, 2048
 MAA 136, 72, 100
 MAA 136, 8, 36
 RT 36, 13, 0
 MAA 144, 8, 40
 DMA 26, 12, 38, 2048
 MAA 144, 72, 104
 RT 38, 13, 2048
 MAA 148, 76, 104
 MAA 148, 12, 40
 RA 80, 11, 8192
 MVA 144, 24, 40
 DMA 27, 12, 38, 3072
 MVA 144, 88, 104
 RA 84, 11, 10240
 MVA 148, 92, 104
 MVA 148, 28, 40
 RT 40, 14, 0
 s_add_u32 s3, s40, 4096
 s_add_u32 m0, s3, s61
 MVA 156, 28, 44
 DMA 20, 8, 37, 0
 MVA 156, 92, 108
 RT 42, 14, 2048
 MVA 152, 88, 108
 MVA 152, 24, 44
 RA 0, 10, 0
 MAA 156, 12, 44
 DMA 21, 8, 37, 1024
 MAA 156, 76, 108
 RA 4, 10, 2048
 MAA 152, 72, 108
 MAA 152, 8, 44
 RT 44, 15, 0
 MAA 160, 8, 48
 DMA 22, 8, 37, 2048
 MAA 160, 72, 112
 RT 46, 15, 2048
 MAA 164, 76, 112
 MAA 164, 12, 48
 RA 16, 10, 8192
 MVA 160, 24, 48
 DMA 23, 8, 37, 3072
 MVA 160, 88, 112
 RA 20, 10, 10240
 MVA 164, 92, 112
 MVA 164, 28, 48
 RT 48, 16, 0
 MVA 172, 28, 52
 s_add_u32 s38, s38, 262144
 MVA 172, 92, 116
 RT 50, 16, 2048
 MVA 168, 88, 116
 s_add_u32 s37, s37, 128
 MVA 168, 24, 52
 MAA 172, 12, 52
 MAA 172, 76, 116
 MAA 168, 72, 116
 MAA 168, 8, 52
 RT 52, 17, 0
 MAA 176, 8, 56
 MAA 176, 72, 120
 RT 54, 17, 2048
 MAA 180, 76, 120
 MAA 180, 12, 56
 MVA 176, 24, 56
 MVA 176, 88, 120
 MVA 180, 92, 120
 MVA 180, 28, 56
 RT 56, 18, 0
 MVA 188, 28, 60
 MVA 188, 92, 124
 RT 58, 18, 2048
 MVA 184, 88, 124
 MVA 184, 24, 60
 MAA 188, 12, 60
 s_mov_b32 s61, s65
 MAA 188, 76, 124
 s_add_u32 s3, s60, s62
 v_add_u32 v11, s3, v41
 MAA 184, 72, 124
 MAA 184, 8, 60
 RT 60, 19, 0
 RT 62, 19, 2048
 s_waitcnt lgkmcnt(2)
 MVA 192, 64, 96
 MVA 192, 0, 32
 MVA 196, 4, 32
 MVA 196, 68, 96
 MVA 64, 80, 96
 MVA 64, 16, 32
 s_waitcnt vmcnt(16) lgkmcnt(0)
 s_barrier
 MVA 68, 20, 32
 MVA 68, 84, 96
 RT 96, 12, 16384
 s_add_u32 m0, s42, 0
 MVA 76, 84, 100
 DMA 24, 12, 38, 0
 MVA 76, 20, 36
 RT 98, 12, 18432
 MVA 72, 16, 36
 MVA 72, 80, 100
 RA 8, 10, 4096
 MVA 204, 68, 100
 DMA 25, 12, 38, 1024
 MVA 204, 4, 36
 RA 12, 10, 6144
 MVA 200, 0, 36
 MVA 200, 64, 100
 RT 100, 13, 16384
 MVA 208, 64, 104
 DMA 26, 12, 38, 2048
 MVA 208, 0, 40
 RT 102, 13, 18432
 MVA 212, 4, 40
 MVA 212, 68, 104
 RA 24, 10, 12288
 MVA 80, 80, 104
 DMA 27, 12, 38, 3072
 MVA 80, 16, 40
 RA 28, 10, 14336
 MVA 84, 20, 40
 MVA 84, 84, 104
 RT 104, 14, 16384
 s_add_u32 m0, s40, s61
 MVA 92, 84, 108
 DMA 20, 8, 36, 0
 MVA 92, 20, 44
 RT 106, 14, 18432
 MVA 88, 16, 44
 MVA 88, 80, 108
 RA 72, 11, 4096
 MVA 220, 68, 108
 DMA 21, 8, 36, 1024
 MVA 220, 4, 44
 RA 76, 11, 6144
 MVA 216, 0, 44
 MVA 216, 64, 108
 RT 108, 15, 16384
 MVA 224, 64, 112
 DMA 22, 8, 36, 2048
 MVA 224, 0, 48
 RT 110, 15, 18432
 MVA 228, 4, 48
 MVA 228, 68, 112
 RA 88, 11, 12288
 MVA 96, 80, 112
 DMA 23, 8, 36, 3072
 MVA 96, 16, 48
 RA 92, 11, 14336
 MVA 100, 20, 48
 MVA 100, 84, 112
 RT 112, 16, 16384
 MVA 108, 84, 116
 s_add_u32 s38, s38, 262144
 MVA 108, 20, 52
 RT 114, 16, 18432
 MVA 104, 16, 52
 s_add_u32 s36, s36, 128
 MVA 104, 80, 116
 MVA 236, 68, 116
 MVA 236, 4, 52
 MVA 232, 0, 52
 MVA 232, 64, 116
 RT 116, 17, 16384
 MVA 240, 64, 120
 MVA 240, 0, 56
 RT 118, 17, 18432
 MVA 244, 4, 56
 MVA 244, 68, 120
 MVA 112, 80, 120
 MVA 112, 16, 56
 MVA 116, 20, 56
 MVA 116, 84, 120
 RT 120, 18, 16384
 MVA 124, 84, 124
 MVA 124, 20, 60
 RT 122, 18, 18432
 MVA 120, 16, 60
 MVA 120, 80, 124
 s_mov_b32 s65, s60
 s_add_u32 s60, s60, 32768
 MVA 252, 68, 124
 s_cmp_eq_u32 s60, 163840
 s_cselect_b32 s60, 65536, s60
 MVA 252, 4, 60
 s_add_u32 s3, s60, s62
 v_add_u32 v10, s3, v40
 MVA 248, 0, 60
 MVA 248, 64, 124
 RT 124, 19, 16384
 RT 126, 19, 18432
 s_waitcnt lgkmcnt(2)
 MAA 128, 8, 32
 MAA 128, 72, 96
 MAA 132, 76, 96
 MAA 132, 12, 32
 MVA 128, 24, 32
 MVA 128, 88, 96
 s_waitcnt vmcnt(16) lgkmcnt(0)
 s_barrier
 s_cmp_eq_u32 s52, 1
 s_cbranch_scc1 P1_OC1
 s_cmp_eq_u32 s52, 6
 s_cbranch_scc1 P1_OS1
P1_OB1:
 MVA 132, 92, 96
 MVA 132, 28, 32
 RT 32, 12, 32768
 s_add_u32 m0, s42, 16384
 MVA 140, 28, 36
 DMA 24, 12, 38, 0
 MVA 140, 92, 100
 RT 34, 12, 34816
 MVA 136, 88, 100
 MVA 136, 24, 36
 RA 64, 11, 0
 MAA 140, 12, 36
 DMA 25, 12, 38, 1024
 MAA 140, 76, 100
 RA 68, 11, 2048
 MAA 136, 72, 100
 MAA 136, 8, 36
 RT 36, 13, 32768
 MAA 144, 8, 40
 DMA 26, 12, 38, 2048
 MAA 144, 72, 104
 RT 38, 13, 34816
 MAA 148, 76, 104
 MAA 148, 12, 40
 RA 80, 11, 8192
 MVA 144, 24, 40
 DMA 27, 12, 38, 3072
 MVA 144, 88, 104
 RA 84, 11, 10240
 MVA 148, 92, 104
 MVA 148, 28, 40
 RT 40, 14, 32768
 s_add_u32 s3, s40, 4096
 s_add_u32 m0, s3, s61
 MVA 156, 28, 44
 DMA 20, 8, 37, 0
 MVA 156, 92, 108
 RT 42, 14, 34816
 MVA 152, 88, 108
 MVA 152, 24, 44
 RA 0, 10, 0
 MAA 156, 12, 44
 DMA 21, 8, 37, 1024
 MAA 156, 76, 108
 RA 4, 10, 2048
 MAA 152, 72, 108
 MAA 152, 8, 44
 RT 44, 15, 32768
 MAA 160, 8, 48
 DMA 22, 8, 37, 2048
 MAA 160, 72, 112
 RT 46, 15, 34816
 MAA 164, 76, 112
 MAA 164, 12, 48
 RA 16, 10, 8192
 MVA 160, 24, 48
 DMA 23, 8, 37, 3072
 MVA 160, 88, 112
 RA 20, 10, 10240
 MVA 164, 92, 112
 MVA 164, 28, 48
 RT 48, 16, 32768
 MVA 172, 28, 52
 s_add_u32 s38, s38, 262144
 MVA 172, 92, 116
 RT 50, 16, 34816
 MVA 168, 88, 116
 s_add_u32 s37, s37, 128
 MVA 168, 24, 52
 MAA 172, 12, 52
 MAA 172, 76, 116
 MAA 168, 72, 116
 MAA 168, 8, 52
 RT 52, 17, 32768
 MAA 176, 8, 56
 MAA 176, 72, 120
 RT 54, 17, 34816
 MAA 180, 76, 120
 MAA 180, 12, 56
 MVA 176, 24, 56
 MVA 176, 88, 120
 MVA 180, 92, 120
 MVA 180, 28, 56
 RT 56, 18, 32768
 MVA 188, 28, 60
 MVA 188, 92, 124
 RT 58, 18, 34816
 MVA 184, 88, 124
 MVA 184, 24, 60
 MAA 188, 12, 60
 s_mov_b32 s61, s65
 MAA 188, 76, 124
 s_add_u32 s3, s60, s62
 v_add_u32 v11, s3, v41
 MAA 184, 72, 124
 MAA 184, 8, 60
 RT 60, 19, 32768
 RT 62, 19, 34816
 s_waitcnt lgkmcnt(2)
 MVA 192, 64, 96
 MVA 192, 0, 32
 MVA 196, 4, 32
 MVA 196, 68, 96
 MVA 64, 80, 96
 MVA 64, 16, 32
 s_waitcnt vmcnt(16) lgkmcnt(0)
 s_barrier
 MVA 68, 20, 32
 MVA 68, 84, 96
 RT 96, 12, 49152
 s_add_u32 m0, s42, 32768
 MVA 76, 84, 100
 DMA 24, 12, 38, 0
 MVA 76, 20, 36
 RT 98, 12, 51200
 MVA 72, 16, 36
 MVA 72, 80, 100
 RA 8, 10, 4096
 MVA 204, 68, 100
 DMA 25, 12, 38, 1024
 MVA 204, 4, 36
 RA 12, 10, 6144
 MVA 200, 0, 36
 MVA 200, 64, 100
 RT 100, 13, 49152
 MVA 208, 64, 104
 DMA 26, 12, 38, 2048
 MVA 208, 0, 40
 RT 102, 13, 51200
 MVA 212, 4, 40
 MVA 212, 68, 104
 RA 24, 10, 12288
 MVA 80, 80, 104
 DMA 27, 12, 38, 3072
 MVA 80, 16, 40
 RA 28, 10, 14336
 MVA 84, 20, 40
 MVA 84, 84, 104
 RT 104, 14, 49152
 s_add_u32 m0, s40, s61
 MVA 92, 84, 108
 DMA 20, 8, 36, 0
 MVA 92, 20, 44
 RT 106, 14, 51200
 MVA 88, 16, 44
 MVA 88, 80, 108
 RA 72, 11, 4096
 MVA 220, 68, 108
 DMA 21, 8, 36, 1024
 MVA 220, 4, 44
 RA 76, 11, 6144
 MVA 216, 0, 44
 MVA 216, 64, 108
 RT 108, 15, 49152
 MVA 224, 64, 112
 DMA 22, 8, 36, 2048
 MVA 224, 0, 48
 RT 110, 15, 51200
 MVA 228, 4, 48
 MVA 228, 68, 112
 RA 88, 11, 12288
 MVA 96, 80, 112
 DMA 23, 8, 36, 3072
 MVA 96, 16, 48
 RA 92, 11, 14336
 MVA 100, 20, 48
 MVA 100, 84, 112
 RT 112, 16, 49152
 MVA 108, 84, 116
 s_add_u32 s38, s38, 262144
 MVA 108, 20, 52
 RT 114, 16, 51200
 MVA 104, 16, 52
 s_add_u32 s36, s36, 128
 MVA 104, 80, 116
 MVA 236, 68, 116
 MVA 236, 4, 52
 MVA 232, 0, 52
 MVA 232, 64, 116
 RT 116, 17, 49152
 MVA 240, 64, 120
 MVA 240, 0, 56
 RT 118, 17, 51200
 MVA 244, 4, 56
 MVA 244, 68, 120
 MVA 112, 80, 120
 MVA 112, 16, 56
 MVA 116, 20, 56
 MVA 116, 84, 120
 RT 120, 18, 49152
 MVA 124, 84, 124
 MVA 124, 20, 60
 RT 122, 18, 51200
 s_mov_b32 s65, s60
 s_add_u32 s60, s60, 32768
 MVA 120, 16, 60
 s_cmp_eq_u32 s60, 163840
 s_cselect_b32 s60, 65536, s60
 MVA 120, 80, 124
 s_add_u32 s3, s60, s62
 v_add_u32 v10, s3, v40
 MVA 252, 68, 124
 s_sub_u32 s52, s52, 1
 MVA 252, 4, 60
 s_cmp_gt_u32 s52, 0
 MVA 248, 0, 60
 MVA 248, 64, 124
 RT 124, 19, 49152
 RT 126, 19, 51200
 s_cbranch_scc1 P1_LOOP1
P1_LE1:
 s_waitcnt lgkmcnt(2)
 MAA 128, 8, 32
 MAA 128, 72, 96
 MAA 132, 76, 96
 MAA 132, 12, 32
 MVA 128, 24, 32
 MVA 128, 88, 96
 s_waitcnt vmcnt(16) lgkmcnt(0)
 s_barrier
 MVA 132, 92, 96
 MVA 132, 28, 32
 RT 32, 12, 0
 s_add_u32 m0, s42, 49152
 MVA 140, 28, 36
 DMA 24, 12, 38, 0
 MVA 140, 92, 100
 RT 34, 12, 2048
 MVA 136, 88, 100
 MVA 136, 24, 36
 RA 64, 11, 0
 MAA 140, 12, 36
 DMA 25, 12, 38, 1024
 MAA 140, 76, 100
 RA 68, 11, 2048
 MAA 136, 72, 100
 MAA 136, 8, 36
 RT 36, 13, 0
 MAA 144, 8, 40
 DMA 26, 12, 38, 2048
 MAA 144, 72, 104
 RT 38, 13, 2048
 MAA 148, 76, 104
 MAA 148, 12, 40
 RA 80, 11, 8192
 MVA 144, 24, 40
 DMA 27, 12, 38, 3072
 MVA 144, 88, 104
 RA 84, 11, 10240
 MVA 148, 92, 104
 MVA 148, 28, 40
 RT 40, 14, 0
 s_add_u32 s3, s40, 4096
 s_add_u32 m0, s3, s61
 MVA 156, 28, 44
 DMA 20, 8, 37, 0
 MVA 156, 92, 108
 RT 42, 14, 2048
 MVA 152, 88, 108
 MVA 152, 24, 44
 RA 0, 10, 0
 MAA 156, 12, 44
 DMA 21, 8, 37, 1024
 MAA 156, 76, 108
 RA 4, 10, 2048
 MAA 152, 72, 108
 MAA 152, 8, 44
 RT 44, 15, 0
 MAA 160, 8, 48
 DMA 22, 8, 37, 2048
 MAA 160, 72, 112
 RT 46, 15, 2048
 MAA 164, 76, 112
 MAA 164, 12, 48
 RA 16, 10, 8192
 MVA 160, 24, 48
 DMA 23, 8, 37, 3072
 MVA 160, 88, 112
 RA 20, 10, 10240
 MVA 164, 92, 112
 MVA 164, 28, 48
 RT 48, 16, 0
 MVA 172, 28, 52
 s_add_u32 s38, s38, 262144
 MVA 172, 92, 116
 RT 50, 16, 2048
 MVA 168, 88, 116
 s_add_u32 s37, s37, 128
 MVA 168, 24, 52
 MAA 172, 12, 52
 MAA 172, 76, 116
 MAA 168, 72, 116
 MAA 168, 8, 52
 RT 52, 17, 0
 MAA 176, 8, 56
 MAA 176, 72, 120
 RT 54, 17, 2048
 MAA 180, 76, 120
 MAA 180, 12, 56
 MVA 176, 24, 56
 MVA 176, 88, 120
 MVA 180, 92, 120
 MVA 180, 28, 56
 RT 56, 18, 0
 MVA 188, 28, 60
 MVA 188, 92, 124
 RT 58, 18, 2048
 MVA 184, 88, 124
 MVA 184, 24, 60
 MAA 188, 12, 60
 s_mov_b32 s61, s65
 MAA 188, 76, 124
 s_add_u32 s3, s60, s62
 v_add_u32 v11, s3, v41
 MAA 184, 72, 124
 MAA 184, 8, 60
 RT 60, 19, 0
 RT 62, 19, 2048
 s_waitcnt lgkmcnt(2)
 MVA 192, 64, 96
 MVA 192, 0, 32
 MVA 196, 4, 32
 MVA 196, 68, 96
 MVA 64, 80, 96
 MVA 64, 16, 32
 s_waitcnt vmcnt(16) lgkmcnt(0)
 s_barrier
 MVA 68, 20, 32
 MVA 68, 84, 96
 RT 96, 12, 16384
 s_add_u32 m0, s42, 0
 MVA 76, 84, 100
 DMA 24, 20, 78, 0
 MVA 76, 20, 36
 RT 98, 12, 18432
 MVA 72, 16, 36
 MVA 72, 80, 100
 RA 8, 10, 4096
 MVA 204, 68, 100
 DMA 25, 20, 78, 1024
 MVA 204, 4, 36
 RA 12, 10, 6144
 MVA 200, 0, 36
 MVA 200, 64, 100
 RT 100, 13, 16384
 MVA 208, 64, 104
 DMA 26, 20, 78, 2048
 MVA 208, 0, 40
 RT 102, 13, 18432
 MVA 212, 4, 40
 MVA 212, 68, 104
 RA 24, 10, 12288
 MVA 80, 80, 104
 DMA 27, 20, 78, 3072
 MVA 80, 16, 40
 RA 28, 10, 14336
 MVA 84, 20, 40
 MVA 84, 84, 104
 RT 104, 14, 16384
 s_add_u32 m0, s42, s61
 MVA 92, 84, 108
 DMA 28, 16, 76, 0
 MVA 92, 20, 44
 RT 106, 14, 18432
 MVA 88, 16, 44
 MVA 88, 80, 108
 RA 72, 11, 4096
 MVA 220, 68, 108
 DMA 29, 16, 76, 1024
 MVA 220, 4, 44
 RA 76, 11, 6144
 MVA 216, 0, 44
 MVA 216, 64, 108
 RT 108, 15, 16384
 MVA 224, 64, 112
 DMA 30, 16, 76, 2048
 MVA 224, 0, 48
 RT 110, 15, 18432
 MVA 228, 4, 48
 MVA 228, 68, 112
 RA 88, 11, 12288
 MVA 96, 80, 112
 DMA 31, 16, 76, 3072
 MVA 96, 16, 48
 RA 92, 11, 14336
 MVA 100, 20, 48
 MVA 100, 84, 112
 RT 112, 16, 16384
 MVA 108, 84, 116
 s_add_u32 s78, s78, 262144
 MVA 108, 20, 52
 RT 114, 16, 18432
 MVA 104, 16, 52
 s_add_u32 s76, s76, 128
 MVA 104, 80, 116
 MVA 236, 68, 116
 MVA 236, 4, 52
 MVA 232, 0, 52
 MVA 232, 64, 116
 RT 116, 17, 16384
 MVA 240, 64, 120
 MVA 240, 0, 56
 RT 118, 17, 18432
 MVA 244, 4, 56
 MVA 244, 68, 120
 MVA 112, 80, 120
 MVA 112, 16, 56
 MVA 116, 20, 56
 MVA 116, 84, 120
 RT 120, 18, 16384
 MVA 124, 84, 124
 MVA 124, 20, 60
 RT 122, 18, 18432
 MVA 120, 16, 60
 MVA 120, 80, 124
 s_mov_b32 s65, s60
 s_add_u32 s60, s60, 32768
 MVA 252, 68, 124
 s_cmp_eq_u32 s60, 163840
 s_cselect_b32 s60, 65536, s60
 MVA 252, 4, 60
 s_add_u32 s3, s60, s62
 v_add_u32 v10, s3, v40
 MVA 248, 0, 60
 MVA 248, 64, 124
 RT 124, 19, 16384
 RT 126, 19, 18432
 s_waitcnt lgkmcnt(2)
 MAA 128, 8, 32
 MAA 128, 72, 96
 MAA 132, 76, 96
 MAA 132, 12, 32
 MVA 128, 24, 32
 MVA 128, 88, 96
 s_waitcnt vmcnt(16) lgkmcnt(0)
 s_barrier
 v_readfirstlane_b32 s3, v37
 s_nop 0
 s_cmpk_lg_u32 s3, 256
 s_cbranch_scc1 P1_OW1
P1_OX1:
 MVA 132, 92, 96
 MVA 132, 28, 32
 RT 32, 12, 32768
 s_add_u32 m0, s42, 16384
 MVA 140, 28, 36
 DMA 24, 20, 78, 0
 MVA 140, 92, 100
 RT 34, 12, 34816
 MVA 136, 88, 100
 MVA 136, 24, 36
 RA 64, 11, 0
 MAA 140, 12, 36
 DMA 25, 20, 78, 1024
 MAA 140, 76, 100
 RA 68, 11, 2048
 MAA 136, 72, 100
 MAA 136, 8, 36
 RT 36, 13, 32768
 MAA 144, 8, 40
 DMA 26, 20, 78, 2048
 MAA 144, 72, 104
 RT 38, 13, 34816
 MAA 148, 76, 104
 MAA 148, 12, 40
 RA 80, 11, 8192
 MVA 144, 24, 40
 DMA 27, 20, 78, 3072
 MVA 144, 88, 104
 RA 84, 11, 10240
 MVA 148, 92, 104
 MVA 148, 28, 40
 RT 40, 14, 32768
 s_add_u32 s3, s42, 16384
 s_add_u32 m0, s3, s61
 MVA 156, 28, 44
 DMAS 52, 28, 77, 0
 MVA 156, 92, 108
 RT 42, 14, 34816
 MVA 152, 88, 108
 MVA 152, 24, 44
 RA 0, 10, 0
 MAA 156, 12, 44
 DMAS 52, 28, 77, 1024
 MAA 156, 76, 108
 RA 4, 10, 2048
 MAA 152, 72, 108
 MAA 152, 8, 44
 RT 44, 15, 32768
 MAA 160, 8, 48
 DMAS 52, 28, 77, 2048
 MAA 160, 72, 112
 RT 46, 15, 34816
 MAA 164, 76, 112
 MAA 164, 12, 48
 RA 16, 10, 8192
 MVA 160, 24, 48
 DMAS 52, 28, 77, 3072
 MVA 160, 88, 112
 RA 20, 10, 10240
 MVA 164, 92, 112
 MVA 164, 28, 48
 RT 48, 16, 32768
 MVA 172, 28, 52
 s_add_u32 s78, s78, 262144
 MVA 172, 92, 116
 RT 50, 16, 34816
 MVA 168, 88, 116
 s_add_u32 s77, s77, 16384
 MVA 168, 24, 52
 MAA 172, 12, 52
 MAA 172, 76, 116
 MAA 168, 72, 116
 MAA 168, 8, 52
 RT 52, 17, 32768
 MAA 176, 8, 56
 MAA 176, 72, 120
 RT 54, 17, 34816
 MAA 180, 76, 120
 MAA 180, 12, 56
 MVA 176, 24, 56
 MVA 176, 88, 120
 MVA 180, 92, 120
 MVA 180, 28, 56
 RT 56, 18, 32768
 MVA 188, 28, 60
 MVA 188, 92, 124
 RT 58, 18, 34816
 MVA 184, 88, 124
 MVA 184, 24, 60
 MAA 188, 12, 60
 s_mov_b32 s61, s65
 MAA 188, 76, 124
 s_add_u32 s3, s60, s62
 v_add_u32 v11, s3, v41
 MAA 184, 72, 124
 MAA 184, 8, 60
 RT 60, 19, 32768
 RT 62, 19, 34816
 s_waitcnt lgkmcnt(2)
 MVA 192, 64, 96
 MVA 192, 0, 32
 MVA 196, 4, 32
 MVA 196, 68, 96
 MVA 64, 80, 96
 MVA 64, 16, 32
 s_waitcnt vmcnt(16) lgkmcnt(0)
 s_barrier
 MVA 68, 20, 32
 MVA 68, 84, 96
 RT 96, 12, 49152
 s_add_u32 m0, s42, 32768
 MVA 76, 84, 100
 DMA 24, 20, 78, 0
 MVA 76, 20, 36
 RT 98, 12, 51200
 MVA 72, 16, 36
 MVA 72, 80, 100
 RA 8, 10, 4096
 MVA 204, 68, 100
 DMA 25, 20, 78, 1024
 MVA 204, 4, 36
 RA 12, 10, 6144
 MVA 200, 0, 36
 MVA 200, 64, 100
 RT 100, 13, 49152
 MVA 208, 64, 104
 DMA 26, 20, 78, 2048
 MVA 208, 0, 40
 RT 102, 13, 51200
 MVA 212, 4, 40
 MVA 212, 68, 104
 RA 24, 10, 12288
 MVA 80, 80, 104
 DMA 27, 20, 78, 3072
 MVA 80, 16, 40
 RA 28, 10, 14336
 MVA 84, 20, 40
 MVA 84, 84, 104
 RT 104, 14, 49152
 s_add_u32 m0, s42, s61
 MVA 92, 84, 108
 DMA 28, 16, 76, 0
 MVA 92, 20, 44
 RT 106, 14, 51200
 MVA 88, 16, 44
 MVA 88, 80, 108
 RA 72, 11, 4096
 MVA 220, 68, 108
 DMA 29, 16, 76, 1024
 MVA 220, 4, 44
 RA 76, 11, 6144
 MVA 216, 0, 44
 MVA 216, 64, 108
 RT 108, 15, 49152
 MVA 224, 64, 112
 DMA 30, 16, 76, 2048
 MVA 224, 0, 48
 RT 110, 15, 51200
 MVA 228, 4, 48
 MVA 228, 68, 112
 RA 88, 11, 12288
 MVA 96, 80, 112
 DMA 31, 16, 76, 3072
 MVA 96, 16, 48
 RA 92, 11, 14336
 MVA 100, 20, 48
 MVA 100, 84, 112
 RT 112, 16, 49152
 MVA 108, 84, 116
 s_add_u32 s78, s78, 262144
 MVA 108, 20, 52
 RT 114, 16, 51200
 MVA 104, 16, 52
 s_add_u32 s76, s76, 128
 MVA 104, 80, 116
 MVA 236, 68, 116
 MVA 236, 4, 52
 MVA 232, 0, 52
 MVA 232, 64, 116
 RT 116, 17, 49152
 MVA 240, 64, 120
 MVA 240, 0, 56
 RT 118, 17, 51200
 MVA 244, 4, 56
 MVA 244, 68, 120
 MVA 112, 80, 120
 MVA 112, 16, 56
 MVA 116, 20, 56
 MVA 116, 84, 120
 RT 120, 18, 49152
 MVA 124, 84, 124
 MVA 124, 20, 60
 RT 122, 18, 51200
 MVA 120, 16, 60
 MVA 120, 80, 124
 s_mov_b32 s65, s60
 s_add_u32 s60, s60, 32768
 MVA 252, 68, 124
 s_cmp_eq_u32 s60, 163840
 s_cselect_b32 s60, 65536, s60
 MVA 252, 4, 60
 v_add_u32 v10, s60, v40
 MVA 248, 0, 60
 MVA 248, 64, 124
 RT 124, 19, 49152
 RT 126, 19, 51200
 s_waitcnt lgkmcnt(2)
 MAA 128, 8, 32
 MAA 128, 72, 96
 MAA 132, 76, 96
 MAA 132, 12, 32
 MVA 128, 24, 32
 MVA 128, 88, 96
 s_waitcnt vmcnt(16) lgkmcnt(0)
 s_barrier
 MVA 132, 92, 96
 MVA 132, 28, 32
 s_add_u32 m0, s42, 49152
 MVA 140, 28, 36
 DMA 24, 20, 78, 0
 MVA 140, 92, 100
 MVA 136, 88, 100
 MVA 136, 24, 36
 RA 64, 11, 0
 MAA 140, 12, 36
 DMA 25, 20, 78, 1024
 v_accvgpr_read_b32 v56, a128
 MAA 140, 76, 100
 RA 68, 11, 2048
 v_accvgpr_read_b32 v57, a129
 MAA 136, 72, 100
 v_accvgpr_read_b32 v58, a130
 v_accvgpr_read_b32 v59, a131
 MAA 136, 8, 36
 v_accvgpr_read_b32 v60, a132
 v_accvgpr_read_b32 v61, a133
 MAA 144, 8, 40
 DMA 26, 20, 78, 2048
 v_accvgpr_read_b32 v62, a134
 MAA 144, 72, 104
 v_accvgpr_read_b32 v63, a135
 CV 56, 56, 57
 MAA 148, 76, 104
 CV 57, 58, 59
 CV 58, 60, 61
 MAA 148, 12, 40
 RA 80, 11, 8192
 CV 59, 62, 63
 MVA 144, 24, 40
 DMA 27, 20, 78, 3072
 s_add_u32 s50, s48, 33792
 MVA 144, 88, 104
 RA 84, 11, 10240
 buffer_store_dwordx4 v[56:59], v52, s[28:31], s50 offen offset:0 sc1
 MVA 148, 92, 104
 MVA 148, 28, 40
 s_add_u32 s3, s42, 16384
 s_add_u32 m0, s3, s61
 MVA 156, 28, 44
 DMAS 52, 28, 77, 0
 v_accvgpr_read_b32 v2, a136
 MVA 156, 92, 108
 v_accvgpr_read_b32 v3, a137
 v_accvgpr_read_b32 v4, a138
 MVA 152, 88, 108
 v_accvgpr_read_b32 v5, a139
 v_accvgpr_read_b32 v6, a140
 MVA 152, 24, 44
 v_accvgpr_read_b32 v7, a141
 v_accvgpr_read_b32 v8, a142
 MAA 156, 12, 44
 DMAS 52, 28, 77, 1024
 v_accvgpr_read_b32 v9, a143
 MAA 156, 76, 108
 CV 2, 2, 3
 CV 3, 4, 5
 MAA 152, 72, 108
 CV 4, 6, 7
 CV 5, 8, 9
 MAA 152, 8, 44
 buffer_store_dwordx4 v[2:5], v52, s[28:31], s50 offen offset:1024 sc1
 v_accvgpr_read_b32 v56, a144
 MAA 160, 8, 48
 DMAS 52, 28, 77, 2048
 v_accvgpr_read_b32 v57, a145
 MAA 160, 72, 112
 v_accvgpr_read_b32 v58, a146
 v_accvgpr_read_b32 v59, a147
 MAA 164, 76, 112
 v_accvgpr_read_b32 v60, a148
 v_accvgpr_read_b32 v61, a149
 MAA 164, 12, 48
 v_accvgpr_read_b32 v62, a150
 v_accvgpr_read_b32 v63, a151
 MVA 160, 24, 48
 DMAS 52, 28, 77, 3072
 CV 56, 56, 57
 MVA 160, 88, 112
 CV 57, 58, 59
 CV 58, 60, 61
 MVA 164, 92, 112
 CV 59, 62, 63
 buffer_store_dwordx4 v[56:59], v52, s[28:31], s50 offen offset:2048 sc1
 MVA 164, 28, 48
 CV 128, 128, 129
 CV 129, 130, 131
 MVA 172, 28, 52
 s_add_u32 s78, s78, 262144
 CV 130, 132, 133
 MVA 172, 92, 116
 CV 131, 134, 135
 CV 136, 136, 137
 MVA 168, 88, 116
 s_add_u32 s77, s77, 16384
 CV 137, 138, 139
 MVA 168, 24, 52
 CV 138, 140, 141
 CV 139, 142, 143
 MAA 172, 12, 52
 CV 144, 144, 145
 CV 145, 146, 147
 MAA 172, 76, 116
 CV 146, 148, 149
 CV 147, 150, 151
 MAA 168, 72, 116
 CV 152, 152, 153
 CV 153, 154, 155
 MAA 168, 8, 52
 CV 154, 156, 157
 CV 155, 158, 159
 MAA 176, 8, 56
 CV 160, 160, 161
 CV 161, 162, 163
 MAA 176, 72, 120
 CV 162, 164, 165
 CV 163, 166, 167
 MAA 180, 76, 120
 MAA 180, 12, 56
 MVA 176, 24, 56
 CV 168, 168, 169
 CV 169, 170, 171
 MVA 176, 88, 120
 CV 170, 172, 173
 CV 171, 174, 175
 MVA 180, 92, 120
 MVA 180, 28, 56
 MVA 188, 28, 60
 MVA 188, 92, 124
 MVA 184, 88, 124
 MVA 184, 24, 60
 MAA 188, 12, 60
 s_mov_b32 s61, s65
 MAA 188, 76, 124
 v_add_u32 v11, s60, v41
 MAA 184, 72, 124
 MAA 184, 8, 60
 s_waitcnt lgkmcnt(0)
 MVA 192, 64, 96
 MVA 196, 68, 96
 MVA 64, 80, 96
 MVA 68, 84, 96
 MVA 76, 84, 100
 MVA 72, 80, 100
 s_waitcnt vmcnt(19) lgkmcnt(0)
 s_barrier
 MVA 204, 68, 100
 CV 176, 176, 177
 CV 177, 178, 179
 MVA 200, 64, 100
 s_add_u32 m0, s42, s61
 CV 178, 180, 181
 MVA 208, 64, 104
 DMA 28, 16, 76, 0
 CV 179, 182, 183
 MVA 212, 68, 104
 CV 184, 184, 185
 CV 185, 186, 187
 MVA 80, 80, 104
 DMA 29, 16, 76, 1024
 CV 186, 188, 189
 MVA 84, 84, 104
 CV 187, 190, 191
 MVA 92, 84, 108
 DMA 30, 16, 76, 2048
 CV 64, 64, 65
 MVA 88, 80, 108
 CV 65, 66, 67
 CV 66, 68, 69
 MVA 220, 68, 108
 DMA 31, 16, 76, 3072
 CV 67, 70, 71
 MVA 216, 64, 108
 CV 192, 192, 193
 CV 193, 194, 195
 MVA 224, 64, 112
 s_add_u32 s76, s76, 128
 CV 194, 196, 197
 MVA 228, 68, 112
 CV 195, 198, 199
 CV 72, 72, 73
 MVA 96, 80, 112
 CV 73, 74, 75
 CV 74, 76, 77
 MVA 100, 84, 112
 CV 75, 78, 79
 CV 200, 200, 201
 MVA 108, 84, 116
 CV 201, 202, 203
 CV 202, 204, 205
 MVA 104, 80, 116
 CV 203, 206, 207
 CV 80, 80, 81
 MVA 236, 68, 116
 CV 81, 82, 83
 CV 82, 84, 85
 MVA 232, 64, 116
 CV 83, 86, 87
 CV 208, 208, 209
 MVA 240, 64, 120
 CV 209, 210, 211
 CV 210, 212, 213
 MVA 244, 68, 120
 CV 211, 214, 215
 CV 88, 88, 89
 MVA 112, 80, 120
 CV 89, 90, 91
 CV 90, 92, 93
 MVA 116, 84, 120
 CV 91, 94, 95
 CV 216, 216, 217
 MVA 124, 84, 124
 CV 217, 218, 219
 CV 218, 220, 221
 MVA 120, 80, 124
 CV 219, 222, 223
 CV 96, 96, 97
 MVA 252, 68, 124
 CV 97, 98, 99
 CV 98, 100, 101
 MVA 248, 64, 124
 CV 99, 102, 103
 s_nop 7
 CV 224, 224, 225
 CV 225, 226, 227
 CV 226, 228, 229
 CV 227, 230, 231
 CV 104, 104, 105
 CV 105, 106, 107
 CV 106, 108, 109
 CV 107, 110, 111
 CV 232, 232, 233
 CV 233, 234, 235
 CV 234, 236, 237
 CV 235, 238, 239
 CV 112, 112, 113
 CV 113, 114, 115
 CV 114, 116, 117
 CV 115, 118, 119
 CV 240, 240, 241
 CV 241, 242, 243
 CV 242, 244, 245
 CV 243, 246, 247
 CV 120, 120, 121
 CV 121, 122, 123
 CV 122, 124, 125
 CV 123, 126, 127
 CV 248, 248, 249
 CV 249, 250, 251
 CV 250, 252, 253
 CV 251, 254, 255
 s_cmp_eq_u32 s4, 2
 s_cbranch_scc1 P1_B1
 s_cmp_eq_u32 s4, 3
 s_cbranch_scc1 P1_B2
 s_branch P1_JOBB
P1_OC1:
 buffer_load_dword v37, v39, s[68:71], 0 offen sc1
 s_branch P1_OB1
P1_OS1:
 buffer_store_dwordx4 a[248:251], v52, s[28:31], s63 offen sc1
 buffer_store_dwordx4 a[252:255], v52, s[28:31], s64 offen sc1
 s_branch P1_OB1
P1_OW1:
 s_sleep 4
 buffer_load_dword v37, v39, s[68:71], 0 offen sc1
 s_waitcnt vmcnt(0)
 v_readfirstlane_b32 s3, v37
 s_nop 0
 s_cmpk_lg_u32 s3, 256
 s_cbranch_scc1 P1_OW1
 s_branch P1_OX1
P1_JOBB:
 RA 0, 10, 0
 RT 32, 42, 0
 RT 34, 42, 2048
 RT 36, 43, 0
 RT 38, 43, 2048
 RT 40, 44, 0
 RT 42, 44, 2048
 RT 44, 45, 0
 RT 46, 45, 2048
 RT 48, 46, 0
 RT 50, 46, 2048
 RT 52, 47, 0
 RT 54, 47, 2048
 RA 4, 10, 2048
 RA 8, 10, 4096
 RA 12, 10, 6144
 RA 16, 10, 8192
 RA 20, 10, 10240
 RA 24, 10, 12288
 RA 28, 10, 14336
 s_waitcnt vmcnt(15) lgkmcnt(0)
 MAZ 192, 32, 0
 s_barrier
 MVZ 68, 36, 0
 RA 64, 11, 0
 s_add_u32 m0, s42, 0
 MAZ 196, 40, 0
 DMA 24, 20, 78, 0
 MVZ 76, 44, 0
 RT 96, 42, 16384
 v_accvgpr_read_b32 v2, a152
 MAZ 200, 48, 0
 v_accvgpr_read_b32 v3, a153
 v_accvgpr_read_b32 v4, a154
 MVZ 84, 52, 0
 RT 98, 42, 18432
 v_accvgpr_read_b32 v5, a155
 MVZ 108, 52, 4
 DMA 25, 20, 78, 1024
 v_accvgpr_read_b32 v6, a156
 MAZ 212, 48, 4
 RT 100, 43, 16384
 v_accvgpr_read_b32 v7, a157
 MVZ 100, 44, 4
 v_accvgpr_read_b32 v8, a158
 v_accvgpr_read_b32 v9, a159
 MAZ 208, 40, 4
 RT 102, 43, 18432
 CV 2, 2, 3
 MVZ 92, 36, 4
 DMA 26, 20, 78, 2048
 CV 3, 4, 5
 MAZ 204, 32, 4
 RT 104, 44, 16384
 CV 4, 6, 7
 MAZ 216, 32, 8
 CV 5, 8, 9
 buffer_store_dwordx4 v[2:5], v52, s[28:31], s50 offen offset:3072 sc1
 MVZ 116, 36, 8
 RT 106, 44, 18432
 MAZ 220, 40, 8
 DMA 27, 20, 78, 3072
 MVZ 124, 44, 8
 RT 108, 45, 16384
 MAZ 224, 48, 8
 MVZ 132, 52, 8
 RT 110, 45, 18432
 s_add_u32 s3, s42, 16384
 s_add_u32 m0, s3, s61
 MVZ 156, 52, 12
 DMAS 52, 28, 77, 0
 MAZ 236, 48, 12
 RT 112, 46, 16384
 MVZ 148, 44, 12
 MAZ 232, 40, 12
 RT 114, 46, 18432
 MVZ 140, 36, 12
 DMAS 52, 28, 77, 1024
 MAZ 228, 32, 12
 RT 116, 47, 16384
 MAZ 240, 32, 16
 MVZ 164, 36, 16
 RT 118, 47, 18432
 MAZ 244, 40, 16
 DMAS 52, 28, 77, 2048
 MVZ 172, 44, 16
 RA 68, 11, 2048
 v_accvgpr_read_b32 v56, a160
 MAZ 248, 48, 16
 v_accvgpr_read_b32 v57, a161
 v_accvgpr_read_b32 v58, a162
 MVZ 180, 52, 16
 RA 72, 11, 4096
 v_accvgpr_read_b32 v59, a163
 MVZ 204, 52, 20
 DMAS 52, 28, 77, 3072
 v_accvgpr_read_b32 v60, a164
 MAZ 60, 48, 20
 RA 76, 11, 6144
 v_accvgpr_read_b32 v61, a165
 MVZ 196, 44, 20
 v_accvgpr_read_b32 v62, a166
 v_accvgpr_read_b32 v63, a167
 MAZ 56, 40, 20
 RA 80, 11, 8192
 CV 56, 56, 57
 MVZ 188, 36, 20
 s_add_u32 s78, s78, 262144
 CV 57, 58, 59
 MAZ 252, 32, 20
 RA 84, 11, 10240
 s_add_u32 s77, s77, 16384
 MAZ 120, 32, 24
 CV 58, 60, 61
 CV 59, 62, 63
 MVZ 212, 36, 24
 RA 88, 11, 12288
 s_add_u32 s50, s48, 37888
 MAZ 124, 40, 24
 buffer_store_dwordx4 v[56:59], v52, s[28:31], s50 offen offset:0 sc1
 MVZ 220, 44, 24
 RA 92, 11, 14336
 MAZ 128, 48, 24
 MVZ 228, 52, 24
 MVZ 252, 52, 28
 MAZ 140, 48, 28
 MVZ 244, 44, 28
 s_mov_b32 s61, s60
 s_add_u32 s60, s60, 32768
 MAZ 136, 40, 28
 s_cmp_eq_u32 s60, 163840
 s_cselect_b32 s60, 65536, s60
 MVZ 236, 36, 28
 v_add_u32 v10, s60, v40
 v_add_u32 v11, s60, v41
 MAZ 132, 32, 28
 s_waitcnt vmcnt(14) lgkmcnt(0)
 MAA 192, 96, 64
 s_barrier
 MVA 68, 100, 64
 RA 0, 10, 0
 s_add_u32 m0, s42, 16384
 MAA 196, 104, 64
 DMA 24, 20, 78, 0
 MVA 76, 108, 64
 RT 32, 42, 32768
 v_accvgpr_read_b32 v2, a168
 MAA 200, 112, 64
 v_accvgpr_read_b32 v3, a169
 v_accvgpr_read_b32 v4, a170
 MVA 84, 116, 64
 RT 34, 42, 34816
 v_accvgpr_read_b32 v5, a171
 MVA 108, 116, 68
 DMA 25, 20, 78, 1024
 v_accvgpr_read_b32 v6, a172
 MAA 212, 112, 68
 RT 36, 43, 32768
 v_accvgpr_read_b32 v7, a173
 MVA 100, 108, 68
 v_accvgpr_read_b32 v8, a174
 v_accvgpr_read_b32 v9, a175
 MAA 208, 104, 68
 RT 38, 43, 34816
 CV 2, 2, 3
 MVA 92, 100, 68
 DMA 26, 20, 78, 2048
 CV 3, 4, 5
 MAA 204, 96, 68
 RT 40, 44, 32768
 CV 4, 6, 7
 MAA 216, 96, 72
 CV 5, 8, 9
 buffer_store_dwordx4 v[2:5], v52, s[28:31], s50 offen offset:1024 sc1
 MVA 116, 100, 72
 RT 42, 44, 34816
 MAA 220, 104, 72
 DMA 27, 20, 78, 3072
 MVA 124, 108, 72
 RT 44, 45, 32768
 MAA 224, 112, 72
 MVA 132, 116, 72
 RT 46, 45, 34816
 s_add_u32 m0, s42, s61
 MVA 156, 116, 76
 DMA 28, 16, 76, 0
 MAA 236, 112, 76
 RT 48, 46, 32768
 MVA 148, 108, 76
 MAA 232, 104, 76
 RT 50, 46, 34816
 MVA 140, 100, 76
 DMA 29, 16, 76, 1024
 MAA 228, 96, 76
 RT 52, 47, 32768
 MAA 240, 96, 80
 MVA 164, 100, 80
 RT 54, 47, 34816
 MAA 244, 104, 80
 DMA 30, 16, 76, 2048
 MVA 172, 108, 80
 RA 4, 10, 2048
 v_accvgpr_read_b32 v56, a176
 MAA 248, 112, 80
 v_accvgpr_read_b32 v57, a177
 v_accvgpr_read_b32 v58, a178
 MVA 180, 116, 80
 RA 8, 10, 4096
 v_accvgpr_read_b32 v59, a179
 MVA 204, 116, 84
 DMA 31, 16, 76, 3072
 v_accvgpr_read_b32 v60, a180
 MAA 60, 112, 84
 RA 12, 10, 6144
 v_accvgpr_read_b32 v61, a181
 MVA 196, 108, 84
 v_accvgpr_read_b32 v62, a182
 v_accvgpr_read_b32 v63, a183
 MAA 56, 104, 84
 RA 16, 10, 8192
 CV 56, 56, 57
 MVA 188, 100, 84
 s_add_u32 s78, s78, 262144
 CV 57, 58, 59
 MAA 252, 96, 84
 RA 20, 10, 10240
 s_add_u32 s76, s76, 128
 MAA 120, 96, 88
 CV 58, 60, 61
 CV 59, 62, 63
 MVA 212, 100, 88
 RA 24, 10, 12288
 buffer_store_dwordx4 v[56:59], v52, s[28:31], s50 offen offset:2048 sc1
 MAA 124, 104, 88
 MVA 220, 108, 88
 RA 28, 10, 14336
 MAA 128, 112, 88
 MVA 228, 116, 88
 MVA 252, 116, 92
 MAA 140, 112, 92
 MVA 244, 108, 92
 MAA 136, 104, 92
 MVA 236, 100, 92
 MAA 132, 96, 92
 s_waitcnt vmcnt(20) lgkmcnt(0)
 MAA 192, 32, 0
 s_barrier
 MVA 68, 36, 0
 RA 64, 11, 0
 s_add_u32 m0, s42, 32768
 MAA 196, 40, 0
 DMA 24, 20, 78, 0
 MVA 76, 44, 0
 RT 96, 42, 49152
 v_accvgpr_read_b32 v2, a184
 MAA 200, 48, 0
 v_accvgpr_read_b32 v3, a185
 v_accvgpr_read_b32 v4, a186
 MVA 84, 52, 0
 RT 98, 42, 51200
 v_accvgpr_read_b32 v5, a187
 MVA 108, 52, 4
 DMA 25, 20, 78, 1024
 v_accvgpr_read_b32 v6, a188
 MAA 212, 48, 4
 RT 100, 43, 49152
 v_accvgpr_read_b32 v7, a189
 MVA 100, 44, 4
 v_accvgpr_read_b32 v8, a190
 v_accvgpr_read_b32 v9, a191
 MAA 208, 40, 4
 RT 102, 43, 51200
 CV 2, 2, 3
 MVA 92, 36, 4
 DMA 26, 20, 78, 2048
 CV 3, 4, 5
 MAA 204, 32, 4
 RT 104, 44, 49152
 CV 4, 6, 7
 MAA 216, 32, 8
 CV 5, 8, 9
 buffer_store_dwordx4 v[2:5], v52, s[28:31], s50 offen offset:3072 sc1
 MVA 116, 36, 8
 RT 106, 44, 51200
 MAA 220, 40, 8
 DMA 27, 20, 78, 3072
 MVA 124, 44, 8
 RT 108, 45, 49152
 MAA 224, 48, 8
 MVA 132, 52, 8
 RT 110, 45, 51200
 s_add_u32 s3, s42, 16384
 s_add_u32 m0, s3, s61
 MVA 156, 52, 12
 DMAS 52, 28, 77, 0
 MAA 236, 48, 12
 RT 112, 46, 49152
 s_add_u32 s50, s48, 0
 MVA 148, 44, 12
 buffer_store_dwordx4 v[192:195], v52, s[28:31], s50 offen offset:0 sc1
 MAA 232, 40, 12
 RT 114, 46, 51200
 MVA 140, 36, 12
 DMAS 52, 28, 77, 1024
 MAA 228, 32, 12
 RT 116, 47, 49152
 MAA 240, 32, 16
 MVA 164, 36, 16
 RT 118, 47, 51200
 MAA 244, 40, 16
 DMAS 52, 28, 77, 2048
 MVA 172, 44, 16
 RA 68, 11, 2048
 MAA 248, 48, 16
 MVA 180, 52, 16
 RA 72, 11, 4096
 MVA 204, 52, 20
 DMAS 52, 28, 77, 3072
 MAA 60, 48, 20
 RA 76, 11, 6144
 MVA 196, 44, 20
 MAA 56, 40, 20
 RA 80, 11, 8192
 MVA 188, 36, 20
 s_add_u32 s78, s78, 262144
 MAA 252, 32, 20
 RA 84, 11, 10240
 s_add_u32 s77, s77, 16384
 MAA 120, 32, 24
 buffer_store_dwordx4 v[200:203], v52, s[28:31], s50 offen offset:1024 sc1
 MVA 212, 36, 24
 RA 88, 11, 12288
 MAA 124, 40, 24
 MVA 220, 44, 24
 RA 92, 11, 14336
 MAA 128, 48, 24
 MVA 228, 52, 24
 MVA 252, 52, 28
 MAA 140, 48, 28
 MVA 244, 44, 28
 s_mov_b32 s61, s60
 s_add_u32 s60, s60, 32768
 MAA 136, 40, 28
 s_cmp_eq_u32 s60, 163840
 s_cselect_b32 s60, 65536, s60
 MVA 236, 36, 28
 v_add_u32 v10, s60, v40
 v_add_u32 v11, s60, v41
 MAA 132, 32, 28
 s_waitcnt vmcnt(21) lgkmcnt(0)
 MAA 192, 96, 64
 s_barrier
 MVA 68, 100, 64
 RA 0, 10, 0
 s_add_u32 m0, s42, 49152
 MAA 196, 104, 64
 DMA 24, 20, 78, 0
 MVA 76, 108, 64
 RT 32, 42, 0
 buffer_store_dwordx4 v[208:211], v52, s[28:31], s50 offen offset:2048 sc1
 MAA 200, 112, 64
 MVA 84, 116, 64
 RT 34, 42, 2048
 MVA 108, 116, 68
 DMA 25, 20, 78, 1024
 MAA 212, 112, 68
 RT 36, 43, 0
 MVA 100, 108, 68
 MAA 208, 104, 68
 RT 38, 43, 2048
 MVA 92, 100, 68
 DMA 26, 20, 78, 2048
 MAA 204, 96, 68
 RT 40, 44, 0
 MAA 216, 96, 72
 MVA 116, 100, 72
 RT 42, 44, 2048
 MAA 220, 104, 72
 DMA 27, 20, 78, 3072
 MVA 124, 108, 72
 RT 44, 45, 0
 MAA 224, 112, 72
 MVA 132, 116, 72
 RT 46, 45, 2048
 s_add_u32 m0, s42, s61
 MVA 156, 116, 76
 DMA 28, 16, 76, 0
 MAA 236, 112, 76
 RT 48, 46, 0
 buffer_store_dwordx4 v[216:219], v52, s[28:31], s50 offen offset:3072 sc1
 MVA 148, 108, 76
 MAA 232, 104, 76
 RT 50, 46, 2048
 MVA 140, 100, 76
 DMA 29, 16, 76, 1024
 MAA 228, 96, 76
 RT 52, 47, 0
 MAA 240, 96, 80
 MVA 164, 100, 80
 RT 54, 47, 2048
 MAA 244, 104, 80
 DMA 30, 16, 76, 2048
 MVA 172, 108, 80
 RA 4, 10, 2048
 MAA 248, 112, 80
 MVA 180, 116, 80
 RA 8, 10, 4096
 MVA 204, 116, 84
 DMA 31, 16, 76, 3072
 MAA 60, 112, 84
 RA 12, 10, 6144
 MVA 196, 108, 84
 MAA 56, 104, 84
 RA 16, 10, 8192
 MVA 188, 100, 84
 s_add_u32 s78, s78, 262144
 MAA 252, 96, 84
 RA 20, 10, 10240
 s_add_u32 s76, s76, 128
 MAA 120, 96, 88
 s_add_u32 s50, s48, 4096
 buffer_store_dwordx4 v[224:227], v52, s[28:31], s50 offen offset:0 sc1
 MVA 212, 100, 88
 RA 24, 10, 12288
 MAA 124, 104, 88
 MVA 220, 108, 88
 RA 28, 10, 14336
 MAA 128, 112, 88
 MVA 228, 116, 88
 MVA 252, 116, 92
 MAA 140, 112, 92
 MVA 244, 108, 92
 MAA 136, 104, 92
 MVA 236, 100, 92
 MAA 132, 96, 92
 s_waitcnt vmcnt(22) lgkmcnt(0)
 MAA 192, 32, 0
 s_barrier
 MVA 68, 36, 0
 RA 64, 11, 0
 s_add_u32 m0, s42, 0
 MAA 196, 40, 0
 DMA 24, 20, 78, 0
 MVA 76, 44, 0
 RT 96, 42, 16384
 buffer_store_dwordx4 v[232:235], v52, s[28:31], s50 offen offset:1024 sc1
 MAA 200, 48, 0
 MVA 84, 52, 0
 RT 98, 42, 18432
 MVA 108, 52, 4
 DMA 25, 20, 78, 1024
 MAA 212, 48, 4
 RT 100, 43, 16384
 MVA 100, 44, 4
 MAA 208, 40, 4
 RT 102, 43, 18432
 MVA 92, 36, 4
 DMA 26, 20, 78, 2048
 MAA 204, 32, 4
 RT 104, 44, 16384
 MAA 216, 32, 8
 MVA 116, 36, 8
 RT 106, 44, 18432
 MAA 220, 40, 8
 DMA 27, 20, 78, 3072
 MVA 124, 44, 8
 RT 108, 45, 16384
 MAA 224, 48, 8
 MVA 132, 52, 8
 RT 110, 45, 18432
 s_add_u32 s3, s42, 16384
 s_add_u32 m0, s3, s61
 MVA 156, 52, 12
 DMAS 52, 28, 77, 0
 MAA 236, 48, 12
 RT 112, 46, 16384
 buffer_store_dwordx4 v[240:243], v52, s[28:31], s50 offen offset:2048 sc1
 MVA 148, 44, 12
 MAA 232, 40, 12
 RT 114, 46, 18432
 MVA 140, 36, 12
 DMAS 52, 28, 77, 1024
 MAA 228, 32, 12
 RT 116, 47, 16384
 MAA 240, 32, 16
 MVA 164, 36, 16
 RT 118, 47, 18432
 MAA 244, 40, 16
 DMAS 52, 28, 77, 2048
 MVA 172, 44, 16
 RA 68, 11, 2048
 MAA 248, 48, 16
 MVA 180, 52, 16
 RA 72, 11, 4096
 MVA 204, 52, 20
 DMAS 52, 28, 77, 3072
 MAA 60, 48, 20
 RA 76, 11, 6144
 MVA 196, 44, 20
 MAA 56, 40, 20
 RA 80, 11, 8192
 MVA 188, 36, 20
 s_add_u32 s78, s78, 262144
 MAA 252, 32, 20
 RA 84, 11, 10240
 s_add_u32 s77, s77, 16384
 MAA 120, 32, 24
 buffer_store_dwordx4 v[248:251], v52, s[28:31], s50 offen offset:3072 sc1
 MVA 212, 36, 24
 RA 88, 11, 12288
 MAA 124, 40, 24
 MVA 220, 44, 24
 RA 92, 11, 14336
 MAA 128, 48, 24
 MVA 228, 52, 24
 MVA 252, 52, 28
 MAA 140, 48, 28
 MVA 244, 44, 28
 s_mov_b32 s61, s60
 s_add_u32 s60, s60, 32768
 MAA 136, 40, 28
 s_cmp_eq_u32 s60, 163840
 s_cselect_b32 s60, 65536, s60
 MVA 236, 36, 28
 v_add_u32 v10, s60, v40
 v_add_u32 v11, s60, v41
 MAA 132, 32, 28
 s_waitcnt vmcnt(22) lgkmcnt(0)
 MAA 192, 96, 64
 s_barrier
 MVA 68, 100, 64
 RA 0, 10, 0
 s_add_u32 m0, s42, 16384
 MAA 196, 104, 64
 DMA 24, 20, 78, 0
 MVA 76, 108, 64
 RT 32, 42, 32768
 s_add_u32 s50, s74, 0
 MAA 200, 112, 64
 buffer_store_dwordx4 v[64:67], v52, s[28:31], s50 offen offset:0 sc1
 MVA 84, 116, 64
 RT 34, 42, 34816
 MVA 108, 116, 68
 DMA 25, 20, 78, 1024
 MAA 212, 112, 68
 RT 36, 43, 32768
 MVA 100, 108, 68
 MAA 208, 104, 68
 RT 38, 43, 34816
 MVA 92, 100, 68
 DMA 26, 20, 78, 2048
 MAA 204, 96, 68
 RT 40, 44, 32768
 MAA 216, 96, 72
 MVA 116, 100, 72
 RT 42, 44, 34816
 MAA 220, 104, 72
 DMA 27, 20, 78, 3072
 MVA 124, 108, 72
 RT 44, 45, 32768
 MAA 224, 112, 72
 MVA 132, 116, 72
 RT 46, 45, 34816
 s_add_u32 m0, s42, s61
 MVA 156, 116, 76
 DMA 28, 16, 76, 0
 MAA 236, 112, 76
 RT 48, 46, 32768
 buffer_store_dwordx4 v[72:75], v52, s[28:31], s50 offen offset:1024 sc1
 MVA 148, 108, 76
 MAA 232, 104, 76
 RT 50, 46, 34816
 MVA 140, 100, 76
 DMA 29, 16, 76, 1024
 MAA 228, 96, 76
 RT 52, 47, 32768
 MAA 240, 96, 80
 MVA 164, 100, 80
 RT 54, 47, 34816
 MAA 244, 104, 80
 DMA 30, 16, 76, 2048
 MVA 172, 108, 80
 RA 4, 10, 2048
 MAA 248, 112, 80
 MVA 180, 116, 80
 RA 8, 10, 4096
 MVA 204, 116, 84
 DMA 31, 16, 76, 3072
 MAA 60, 112, 84
 RA 12, 10, 6144
 MVA 196, 108, 84
 MAA 56, 104, 84
 RA 16, 10, 8192
 MVA 188, 100, 84
 s_add_u32 s78, s78, 262144
 MAA 252, 96, 84
 RA 20, 10, 10240
 s_add_u32 s76, s76, 128
 MAA 120, 96, 88
 buffer_store_dwordx4 v[80:83], v52, s[28:31], s50 offen offset:2048 sc1
 MVA 212, 100, 88
 RA 24, 10, 12288
 MAA 124, 104, 88
 MVA 220, 108, 88
 RA 28, 10, 14336
 MAA 128, 112, 88
 MVA 228, 116, 88
 MVA 252, 116, 92
 MAA 140, 112, 92
 MVA 244, 108, 92
 MAA 136, 104, 92
 MVA 236, 100, 92
 MAA 132, 96, 92
 s_waitcnt vmcnt(22) lgkmcnt(0)
 MAA 192, 32, 0
 s_barrier
 MVA 68, 36, 0
 RA 64, 11, 0
 s_add_u32 m0, s42, 32768
 MAA 196, 40, 0
 DMA 24, 20, 78, 0
 MVA 76, 44, 0
 RT 96, 42, 49152
 buffer_store_dwordx4 v[88:91], v52, s[28:31], s50 offen offset:3072 sc1
 MAA 200, 48, 0
 MVA 84, 52, 0
 RT 98, 42, 51200
 MVA 108, 52, 4
 DMA 25, 20, 78, 1024
 MAA 212, 48, 4
 RT 100, 43, 49152
 MVA 100, 44, 4
 MAA 208, 40, 4
 RT 102, 43, 51200
 MVA 92, 36, 4
 DMA 26, 20, 78, 2048
 MAA 204, 32, 4
 RT 104, 44, 49152
 MAA 216, 32, 8
 MVA 116, 36, 8
 RT 106, 44, 51200
 MAA 220, 40, 8
 DMA 27, 20, 78, 3072
 MVA 124, 44, 8
 RT 108, 45, 49152
 MAA 224, 48, 8
 MVA 132, 52, 8
 RT 110, 45, 51200
 s_add_u32 s3, s42, 16384
 s_add_u32 m0, s3, s61
 MVA 156, 52, 12
 DMAS 52, 28, 77, 0
 MAA 236, 48, 12
 RT 112, 46, 49152
 s_add_u32 s50, s74, 4096
 MVA 148, 44, 12
 buffer_store_dwordx4 v[96:99], v52, s[28:31], s50 offen offset:0 sc1
 MAA 232, 40, 12
 RT 114, 46, 51200
 MVA 140, 36, 12
 DMAS 52, 28, 77, 1024
 MAA 228, 32, 12
 RT 116, 47, 49152
 MAA 240, 32, 16
 MVA 164, 36, 16
 RT 118, 47, 51200
 MAA 244, 40, 16
 DMAS 52, 28, 77, 2048
 MVA 172, 44, 16
 RA 68, 11, 2048
 MAA 248, 48, 16
 MVA 180, 52, 16
 RA 72, 11, 4096
 MVA 204, 52, 20
 DMAS 52, 28, 77, 3072
 MAA 60, 48, 20
 RA 76, 11, 6144
 MVA 196, 44, 20
 MAA 56, 40, 20
 RA 80, 11, 8192
 MVA 188, 36, 20
 s_add_u32 s78, s78, 262144
 MAA 252, 32, 20
 RA 84, 11, 10240
 s_add_u32 s77, s77, 16384
 MAA 120, 32, 24
 buffer_store_dwordx4 v[104:107], v52, s[28:31], s50 offen offset:1024 sc1
 MVA 212, 36, 24
 RA 88, 11, 12288
 MAA 124, 40, 24
 MVA 220, 44, 24
 RA 92, 11, 14336
 MAA 128, 48, 24
 MVA 228, 52, 24
 MVA 252, 52, 28
 MAA 140, 48, 28
 MVA 244, 44, 28
 s_mov_b32 s61, s60
 s_add_u32 s60, s60, 32768
 MAA 136, 40, 28
 s_cmp_eq_u32 s60, 163840
 s_cselect_b32 s60, 65536, s60
 MVA 236, 36, 28
 v_add_u32 v10, s60, v40
 v_add_u32 v11, s60, v41
 MAA 132, 32, 28
 s_waitcnt vmcnt(22) lgkmcnt(0)
 MAA 192, 96, 64
 s_barrier
 MVA 68, 100, 64
 RA 0, 10, 0
 s_add_u32 m0, s42, 49152
 MAA 196, 104, 64
 DMA 24, 20, 78, 0
 MVA 76, 108, 64
 RT 32, 42, 0
 buffer_store_dwordx4 v[112:115], v52, s[28:31], s50 offen offset:2048 sc1
 MAA 200, 112, 64
 MVA 84, 116, 64
 RT 34, 42, 2048
 MVA 108, 116, 68
 DMA 25, 20, 78, 1024
 MAA 212, 112, 68
 RT 36, 43, 0
 MVA 100, 108, 68
 MAA 208, 104, 68
 RT 38, 43, 2048
 MVA 92, 100, 68
 DMA 26, 20, 78, 2048
 MAA 204, 96, 68
 RT 40, 44, 0
 MAA 216, 96, 72
 MVA 116, 100, 72
 RT 42, 44, 2048
 MAA 220, 104, 72
 DMA 27, 20, 78, 3072
 MVA 124, 108, 72
 RT 44, 45, 0
 MAA 224, 112, 72
 MVA 132, 116, 72
 RT 46, 45, 2048
 s_add_u32 m0, s42, s61
 MVA 156, 116, 76
 DMA 28, 16, 76, 0
 MAA 236, 112, 76
 RT 48, 46, 0
 buffer_store_dwordx4 v[120:123], v52, s[28:31], s50 offen offset:3072 sc1
 MVA 148, 108, 76
 MAA 232, 104, 76
 RT 50, 46, 2048
 MVA 140, 100, 76
 DMA 29, 16, 76, 1024
 MAA 228, 96, 76
 RT 52, 47, 0
 MAA 240, 96, 80
 MVA 164, 100, 80
 RT 54, 47, 2048
 MAA 244, 104, 80
 DMA 30, 16, 76, 2048
 MVA 172, 108, 80
 RA 4, 10, 2048
 MAA 248, 112, 80
 MVA 180, 116, 80
 RA 8, 10, 4096
 MVA 204, 116, 84
 DMA 31, 16, 76, 3072
 MAA 60, 112, 84
 RA 12, 10, 6144
 MVA 196, 108, 84
 MAA 56, 104, 84
 RA 16, 10, 8192
 MVA 188, 100, 84
 s_add_u32 s78, s78, 262144
 MAA 252, 96, 84
 RA 20, 10, 10240
 s_add_u32 s76, s76, 128
 MAA 120, 96, 88
 s_add_u32 s50, s81, 0
 buffer_store_dwordx4 v[128:131], v52, s[28:31], s50 offen offset:0 sc1
 MVA 212, 100, 88
 RA 24, 10, 12288
 MAA 124, 104, 88
 MVA 220, 108, 88
 RA 28, 10, 14336
 MAA 128, 112, 88
 MVA 228, 116, 88
 MVA 252, 116, 92
 MAA 140, 112, 92
 MVA 244, 108, 92
 MAA 136, 104, 92
 MVA 236, 100, 92
 MAA 132, 96, 92
 s_waitcnt vmcnt(22) lgkmcnt(0)
 MAA 192, 32, 0
 s_barrier
 MVA 68, 36, 0
 RA 64, 11, 0
 s_add_u32 m0, s42, 0
 MAA 196, 40, 0
 DMA 24, 20, 78, 0
 MVA 76, 44, 0
 RT 96, 42, 16384
 buffer_store_dwordx4 v[136:139], v52, s[28:31], s50 offen offset:1024 sc1
 MAA 200, 48, 0
 MVA 84, 52, 0
 RT 98, 42, 18432
 MVA 108, 52, 4
 DMA 25, 20, 78, 1024
 MAA 212, 48, 4
 RT 100, 43, 16384
 MVA 100, 44, 4
 MAA 208, 40, 4
 RT 102, 43, 18432
 MVA 92, 36, 4
 DMA 26, 20, 78, 2048
 MAA 204, 32, 4
 RT 104, 44, 16384
 MAA 216, 32, 8
 MVA 116, 36, 8
 RT 106, 44, 18432
 MAA 220, 40, 8
 DMA 27, 20, 78, 3072
 MVA 124, 44, 8
 RT 108, 45, 16384
 MAA 224, 48, 8
 MVA 132, 52, 8
 RT 110, 45, 18432
 s_add_u32 s3, s42, 16384
 s_add_u32 m0, s3, s61
 MVA 156, 52, 12
 DMAS 52, 28, 77, 0
 MAA 236, 48, 12
 RT 112, 46, 16384
 buffer_store_dwordx4 v[144:147], v52, s[28:31], s50 offen offset:2048 sc1
 MVA 148, 44, 12
 MAA 232, 40, 12
 RT 114, 46, 18432
 MVA 140, 36, 12
 DMAS 52, 28, 77, 1024
 MAA 228, 32, 12
 RT 116, 47, 16384
 MAA 240, 32, 16
 MVA 164, 36, 16
 RT 118, 47, 18432
 MAA 244, 40, 16
 DMAS 52, 28, 77, 2048
 MVA 172, 44, 16
 RA 68, 11, 2048
 MAA 248, 48, 16
 MVA 180, 52, 16
 RA 72, 11, 4096
 MVA 204, 52, 20
 DMAS 52, 28, 77, 3072
 MAA 60, 48, 20
 RA 76, 11, 6144
 MVA 196, 44, 20
 MAA 56, 40, 20
 RA 80, 11, 8192
 MVA 188, 36, 20
 s_add_u32 s78, s78, 262144
 MAA 252, 32, 20
 RA 84, 11, 10240
 s_add_u32 s77, s77, 16384
 MAA 120, 32, 24
 buffer_store_dwordx4 v[152:155], v52, s[28:31], s50 offen offset:3072 sc1
 MVA 212, 36, 24
 RA 88, 11, 12288
 MAA 124, 40, 24
 MVA 220, 44, 24
 RA 92, 11, 14336
 MAA 128, 48, 24
 MVA 228, 52, 24
 MVA 252, 52, 28
 MAA 140, 48, 28
 MVA 244, 44, 28
 s_mov_b32 s61, s60
 s_add_u32 s60, s60, 32768
 MAA 136, 40, 28
 s_cmp_eq_u32 s60, 163840
 s_cselect_b32 s60, 65536, s60
 MVA 236, 36, 28
 v_add_u32 v10, s60, v40
 v_add_u32 v11, s60, v41
 MAA 132, 32, 28
 s_waitcnt vmcnt(22) lgkmcnt(0)
 MAA 192, 96, 64
 s_barrier
 MVA 68, 100, 64
 RA 0, 10, 0
 s_add_u32 m0, s42, 16384
 MAA 196, 104, 64
 DMA 24, 20, 78, 0
 MVA 76, 108, 64
 RT 32, 42, 32768
 s_add_u32 s50, s81, 4096
 MAA 200, 112, 64
 buffer_store_dwordx4 v[160:163], v52, s[28:31], s50 offen offset:0 sc1
 MVA 84, 116, 64
 RT 34, 42, 34816
 MVA 108, 116, 68
 DMA 25, 20, 78, 1024
 MAA 212, 112, 68
 RT 36, 43, 32768
 MVA 100, 108, 68
 MAA 208, 104, 68
 RT 38, 43, 34816
 MVA 92, 100, 68
 DMA 26, 20, 78, 2048
 MAA 204, 96, 68
 RT 40, 44, 32768
 MAA 216, 96, 72
 MVA 116, 100, 72
 RT 42, 44, 34816
 MAA 220, 104, 72
 DMA 27, 20, 78, 3072
 MVA 124, 108, 72
 RT 44, 45, 32768
 MAA 224, 112, 72
 MVA 132, 116, 72
 RT 46, 45, 34816
 MVA 156, 116, 76
 s_add_u32 s78, s78, 262144
 MAA 236, 112, 76
 RT 48, 46, 32768
 MVA 148, 108, 76
 MAA 232, 104, 76
 RT 50, 46, 34816
 MVA 140, 100, 76
 MAA 228, 96, 76
 RT 52, 47, 32768
 MAA 240, 96, 80
 MVA 164, 100, 80
 RT 54, 47, 34816
 MAA 244, 104, 80
 MVA 172, 108, 80
 RA 4, 10, 2048
 buffer_store_dwordx4 v[168:171], v52, s[28:31], s50 offen offset:1024 sc1
 MAA 248, 112, 80
 MVA 180, 116, 80
 RA 8, 10, 4096
 MVA 204, 116, 84
 MAA 60, 112, 84
 RA 12, 10, 6144
 MVA 196, 108, 84
 MAA 56, 104, 84
 RA 16, 10, 8192
 MVA 188, 100, 84
 MAA 252, 96, 84
 RA 20, 10, 10240
 MAA 120, 96, 88
 MVA 212, 100, 88
 RA 24, 10, 12288
 MAA 124, 104, 88
 MVA 220, 108, 88
 RA 28, 10, 14336
 MAA 128, 112, 88
 MVA 228, 116, 88
 MVA 252, 116, 92
 MAA 140, 112, 92
 MVA 244, 108, 92
 MAA 136, 104, 92
 MVA 236, 100, 92
 MAA 132, 96, 92
 s_waitcnt vmcnt(17) lgkmcnt(0)
 MAA 192, 32, 0
 s_barrier
 MVA 68, 36, 0
 RA 64, 11, 0
 MAA 196, 40, 0
 MVA 76, 44, 0
 RT 96, 42, 49152
 buffer_store_dwordx4 v[176:179], v52, s[28:31], s50 offen offset:2048 sc1
 MAA 200, 48, 0
 MVA 84, 52, 0
 RT 98, 42, 51200
 MVA 108, 52, 4
 MAA 212, 48, 4
 RT 100, 43, 49152
 MVA 100, 44, 4
 MAA 208, 40, 4
 RT 102, 43, 51200
 MVA 92, 36, 4
 MAA 204, 32, 4
 RT 104, 44, 49152
 MAA 216, 32, 8
 MVA 116, 36, 8
 RT 106, 44, 51200
 MAA 220, 40, 8
 MVA 124, 44, 8
 RT 108, 45, 49152
 MAA 224, 48, 8
 MVA 132, 52, 8
 RT 110, 45, 51200
 MVA 156, 52, 12
 MAA 236, 48, 12
 RT 112, 46, 49152
 MVA 148, 44, 12
 MAA 232, 40, 12
 RT 114, 46, 51200
 MVA 140, 36, 12
 MAA 228, 32, 12
 RT 116, 47, 49152
 MAA 240, 32, 16
 MVA 164, 36, 16
 RT 118, 47, 51200
 MAA 244, 40, 16
 MVA 172, 44, 16
 RA 68, 11, 2048
 buffer_store_dwordx4 v[184:187], v52, s[28:31], s50 offen offset:3072 sc1
 MAA 248, 48, 16
 MVA 180, 52, 16
 RA 72, 11, 4096
 MVA 204, 52, 20
 MAA 60, 48, 20
 RA 76, 11, 6144
 MVA 196, 44, 20
 MAA 56, 40, 20
 RA 80, 11, 8192
 MVA 188, 36, 20
 MAA 252, 32, 20
 RA 84, 11, 10240
 MAA 120, 32, 24
 MVA 212, 36, 24
 RA 88, 11, 12288
 MAA 124, 40, 24
 MVA 220, 44, 24
 RA 92, 11, 14336
 MAA 128, 48, 24
 MVA 228, 52, 24
 MVA 252, 52, 28
 MAA 140, 48, 28
 MVA 244, 44, 28
 s_mov_b32 s61, s60
 s_add_u32 s60, s60, 32768
 MAA 136, 40, 28
 s_cmp_eq_u32 s60, 163840
 s_cselect_b32 s60, 65536, s60
 MVA 236, 36, 28
 v_add_u32 v10, s60, v40
 v_add_u32 v11, s60, v41
 MAA 132, 32, 28
 s_waitcnt vmcnt(8) lgkmcnt(0)
 MAA 192, 96, 64
 s_barrier
 MVA 68, 100, 64
 RA 0, 10, 0
 MAA 196, 104, 64
 MVA 76, 108, 64
 RT 32, 42, 0
 MAA 200, 112, 64
 MVA 84, 116, 64
 RT 34, 42, 2048
 MVA 108, 116, 68
 MAA 212, 112, 68
 RT 36, 43, 0
 MVA 100, 108, 68
 MAA 208, 104, 68
 RT 38, 43, 2048
 MVA 92, 100, 68
 MAA 204, 96, 68
 RT 40, 44, 0
 MAA 216, 96, 72
 MVA 116, 100, 72
 RT 42, 44, 2048
 MAA 220, 104, 72
 MVA 124, 108, 72
 RT 44, 45, 0
 MAA 224, 112, 72
 MVA 132, 116, 72
 RT 46, 45, 2048
 MVA 156, 116, 76
 MAA 236, 112, 76
 RT 48, 46, 0
 MVA 148, 108, 76
 MAA 232, 104, 76
 RT 50, 46, 2048
 MVA 140, 100, 76
 MAA 228, 96, 76
 RT 52, 47, 0
 MAA 240, 96, 80
 MVA 164, 100, 80
 RT 54, 47, 2048
 MAA 244, 104, 80
 MVA 172, 108, 80
 RA 4, 10, 2048
 MAA 248, 112, 80
 MVA 180, 116, 80
 RA 8, 10, 4096
 MVA 204, 116, 84
 MAA 60, 112, 84
 RA 12, 10, 6144
 MVA 196, 108, 84
 MAA 56, 104, 84
 RA 16, 10, 8192
 MVA 188, 100, 84
 MAA 252, 96, 84
 RA 20, 10, 10240
 MAA 120, 96, 88
 MVA 212, 100, 88
 RA 24, 10, 12288
 MAA 124, 104, 88
 MVA 220, 108, 88
 RA 28, 10, 14336
 MAA 128, 112, 88
 MVA 228, 116, 88
 MVA 252, 116, 92
 MAA 140, 112, 92
 MVA 244, 108, 92
 MAA 136, 104, 92
 MVA 236, 100, 92
 MAA 132, 96, 92
 s_waitcnt vmcnt(2) lgkmcnt(0)
 MAA 192, 32, 0
 s_barrier
 MVA 68, 36, 0
 RA 64, 11, 0
 MAA 196, 40, 0
 MVA 76, 44, 0
 RT 96, 42, 16384
 MAA 200, 48, 0
 MVA 84, 52, 0
 RT 98, 42, 18432
 MVA 108, 52, 4
 MAA 212, 48, 4
 RT 100, 43, 16384
 MVA 100, 44, 4
 MAA 208, 40, 4
 RT 102, 43, 18432
 MVA 92, 36, 4
 MAA 204, 32, 4
 RT 104, 44, 16384
 MAA 216, 32, 8
 MVA 116, 36, 8
 RT 106, 44, 18432
 MAA 220, 40, 8
 MVA 124, 44, 8
 RT 108, 45, 16384
 MAA 224, 48, 8
 MVA 132, 52, 8
 RT 110, 45, 18432
 MVA 156, 52, 12
 MAA 236, 48, 12
 RT 112, 46, 16384
 MVA 148, 44, 12
 MAA 232, 40, 12
 RT 114, 46, 18432
 MVA 140, 36, 12
 MAA 228, 32, 12
 RT 116, 47, 16384
 MAA 240, 32, 16
 MVA 164, 36, 16
 RT 118, 47, 18432
 MAA 244, 40, 16
 MVA 172, 44, 16
 RA 68, 11, 2048
 MAA 248, 48, 16
 MVA 180, 52, 16
 RA 72, 11, 4096
 MVA 204, 52, 20
 MAA 60, 48, 20
 RA 76, 11, 6144
 MVA 196, 44, 20
 MAA 56, 40, 20
 RA 80, 11, 8192
 MVA 188, 36, 20
 MAA 252, 32, 20
 RA 84, 11, 10240
 MAA 120, 32, 24
 MVA 212, 36, 24
 RA 88, 11, 12288
 MAA 124, 40, 24
 MVA 220, 44, 24
 RA 92, 11, 14336
 MAA 128, 48, 24
 MVA 228, 52, 24
 MVA 252, 52, 28
 MAA 140, 48, 28
 MVA 244, 44, 28
 MAA 136, 40, 28
 MVA 236, 36, 28
 MAA 132, 32, 28
 s_waitcnt lgkmcnt(0)
 buffer_load_dword v38, v55, s[28:31], s49 offen sc1
 MAA 192, 96, 64
 MVA 68, 100, 64
 MAA 196, 104, 64
 MVA 76, 108, 64
 MAA 200, 112, 64
 MVA 84, 116, 64
 MVA 108, 116, 68
 MAA 212, 112, 68
 MVA 100, 108, 68
 MAA 208, 104, 68
 MVA 92, 100, 68
 MAA 204, 96, 68
 MAA 216, 96, 72
 MVA 116, 100, 72
 MAA 220, 104, 72
 MVA 124, 108, 72
 MAA 224, 112, 72
 MVA 132, 116, 72
 MVA 156, 116, 76
 MAA 236, 112, 76
 MVA 148, 108, 76
 MAA 232, 104, 76
 MVA 140, 100, 76
 MAA 228, 96, 76
 MAA 240, 96, 80
 MVA 164, 100, 80
 MAA 244, 104, 80
 MVA 172, 108, 80
 MAA 248, 112, 80
 MVA 180, 116, 80
 MVA 204, 116, 84
 MAA 60, 112, 84
 MVA 196, 108, 84
 MAA 56, 104, 84
 MVA 188, 100, 84
 MAA 252, 96, 84
 MAA 120, 96, 88
 MVA 212, 100, 88
 MAA 124, 104, 88
 MVA 220, 108, 88
 MAA 128, 112, 88
 MVA 228, 116, 88
 MVA 252, 116, 92
 MAA 140, 112, 92
 MVA 244, 108, 92
 MAA 136, 104, 92
 MVA 236, 100, 92
 MAA 132, 96, 92
 s_mov_b32 s79, 1
P1_CHK0:
 s_waitcnt vmcnt(0)
 v_readfirstlane_b32 s3, v37
 v_cmp_eq_u32 vcc, 0, v38
 s_cmpk_eq_u32 s3, 256
 s_cbranch_scc1 P1_CHKOK0
 s_mov_b32 s79, 0
 s_sleep 4
 buffer_load_dword v37, v39, s[68:71], 0 offen sc1
 s_branch P1_CHK0
P1_CHKOK0:
 s_cmp_eq_u64 vcc, 0
 s_cselect_b32 s79, s79, 0
 s_barrier
 s_cmp_eq_u32 s79, 0
 s_cbranch_scc1 P1_KD000
 s_add_u32 m0, s42, 0
 s_add_u32 s3, s39, 0
 DMAS 52, 28, 3, 0
 DMAS 52, 28, 3, 1024
 DMAS 52, 28, 3, 2048
 DMAS 52, 28, 3, 3072
P1_KD000:
 s_mul_i32 s50, s46, 1115136
 s_mul_i32 s3, s47, 69632
 s_add_u32 s50, s50, s3
 s_mul_i32 s3, s4, 6144
 s_add_u32 s50, s50, s3
 s_add_u32 s50, s50, 35651584
 s_sub_u32 s3, s6, 16
 s_cmp_lt_u32 s3, 14
 s_cselect_b32 s50, s50, 0x70000000
 v_accvgpr_read_b32 v64, a192
 v_accvgpr_read_b32 v65, a193
 v_accvgpr_read_b32 v66, a194
 v_accvgpr_read_b32 v67, a195
 v_pk_mul_f32 v[64:65], v[64:65], s[56:57]
 v_pk_mul_f32 v[66:67], v[66:67], s[56:57]
 v_pk_mul_f32 v[68:69], v[68:69], s[56:57]
 v_pk_mul_f32 v[70:71], v[70:71], s[56:57]
 CV 64, 64, 65
 CV 65, 66, 67
 CV 66, 68, 69
 CV 67, 70, 71
 s_add_u32 s51, s50, 0
 buffer_store_dwordx4 v[64:67], v52, s[28:31], s51 offen offset:0 sc1
 ds_write_b128 v51, v[64:67] offset:0
 v_accvgpr_read_b32 v72, a196
 v_accvgpr_read_b32 v73, a197
 v_accvgpr_read_b32 v74, a198
 v_accvgpr_read_b32 v75, a199
 v_pk_mul_f32 v[72:73], v[72:73], s[56:57]
 v_pk_mul_f32 v[74:75], v[74:75], s[56:57]
 v_pk_mul_f32 v[76:77], v[76:77], s[56:57]
 v_pk_mul_f32 v[78:79], v[78:79], s[56:57]
 CV 72, 72, 73
 CV 73, 74, 75
 CV 74, 76, 77
 CV 75, 78, 79
 s_add_u32 s51, s50, 0
 buffer_store_dwordx4 v[72:75], v52, s[28:31], s51 offen offset:2048 sc1
 ds_write_b128 v51, v[72:75] offset:2048
 v_accvgpr_read_b32 v80, a200
 v_accvgpr_read_b32 v81, a201
 v_accvgpr_read_b32 v82, a202
 v_accvgpr_read_b32 v83, a203
 v_pk_mul_f32 v[80:81], v[80:81], s[56:57]
 v_pk_mul_f32 v[82:83], v[82:83], s[56:57]
 v_pk_mul_f32 v[84:85], v[84:85], s[56:57]
 v_pk_mul_f32 v[86:87], v[86:87], s[56:57]
 CV 80, 80, 81
 CV 81, 82, 83
 CV 82, 84, 85
 CV 83, 86, 87
 s_add_u32 s51, s50, 4096
 buffer_store_dwordx4 v[80:83], v52, s[28:31], s51 offen offset:0 sc1
 ds_write_b128 v51, v[80:83] offset:4096
 s_cmp_eq_u32 s79, 0
 s_cbranch_scc1 P1_KD001
 s_add_u32 m0, s42, 16384
 s_add_u32 s3, s39, 33792
 DMAS 52, 28, 3, 0
 DMAS 52, 28, 3, 1024
 DMAS 52, 28, 3, 2048
 DMAS 52, 28, 3, 3072
P1_KD001:
 v_accvgpr_read_b32 v88, a204
 v_accvgpr_read_b32 v89, a205
 v_accvgpr_read_b32 v90, a206
 v_accvgpr_read_b32 v91, a207
 v_pk_mul_f32 v[88:89], v[88:89], s[56:57]
 v_pk_mul_f32 v[90:91], v[90:91], s[56:57]
 v_pk_mul_f32 v[92:93], v[92:93], s[56:57]
 v_pk_mul_f32 v[94:95], v[94:95], s[56:57]
 CV 88, 88, 89
 CV 89, 90, 91
 CV 90, 92, 93
 CV 91, 94, 95
 s_add_u32 s51, s50, 16384
 buffer_store_dwordx4 v[88:91], v52, s[28:31], s51 offen offset:1024 sc1
 ds_write_b128 v51, v[88:91] offset:16384
 v_accvgpr_read_b32 v96, a208
 v_accvgpr_read_b32 v97, a209
 v_accvgpr_read_b32 v98, a210
 v_accvgpr_read_b32 v99, a211
 v_pk_mul_f32 v[96:97], v[96:97], s[56:57]
 v_pk_mul_f32 v[98:99], v[98:99], s[56:57]
 v_pk_mul_f32 v[100:101], v[100:101], s[56:57]
 v_pk_mul_f32 v[102:103], v[102:103], s[56:57]
 CV 96, 96, 97
 CV 97, 98, 99
 CV 98, 100, 101
 CV 99, 102, 103
 s_add_u32 s51, s50, 16384
 buffer_store_dwordx4 v[96:99], v52, s[28:31], s51 offen offset:3072 sc1
 ds_write_b128 v51, v[96:99] offset:18432
 v_accvgpr_read_b32 v104, a212
 v_accvgpr_read_b32 v105, a213
 v_accvgpr_read_b32 v106, a214
 v_accvgpr_read_b32 v107, a215
 v_pk_mul_f32 v[104:105], v[104:105], s[56:57]
 v_pk_mul_f32 v[106:107], v[106:107], s[56:57]
 v_pk_mul_f32 v[108:109], v[108:109], s[56:57]
 v_pk_mul_f32 v[110:111], v[110:111], s[56:57]
 CV 104, 104, 105
 CV 105, 106, 107
 CV 106, 108, 109
 CV 107, 110, 111
 s_add_u32 s51, s50, 20480
 buffer_store_dwordx4 v[104:107], v52, s[28:31], s51 offen offset:1024 sc1
 ds_write_b128 v51, v[104:107] offset:20480
 s_cmp_eq_u32 s79, 0
 s_cbranch_scc1 P1_KD010
 s_add_u32 m0, s42, 65536
 s_add_u32 s3, s39, 0
 DMAS 54, 28, 3, 0
 DMAS 54, 28, 3, 1024
 DMAS 54, 28, 3, 2048
 DMAS 54, 28, 3, 3072
P1_KD010:
 v_accvgpr_read_b32 v112, a216
 v_accvgpr_read_b32 v113, a217
 v_accvgpr_read_b32 v114, a218
 v_accvgpr_read_b32 v115, a219
 v_pk_mul_f32 v[112:113], v[112:113], s[56:57]
 v_pk_mul_f32 v[114:115], v[114:115], s[56:57]
 v_pk_mul_f32 v[116:117], v[116:117], s[56:57]
 v_pk_mul_f32 v[118:119], v[118:119], s[56:57]
 CV 112, 112, 113
 CV 113, 114, 115
 CV 114, 116, 117
 CV 115, 118, 119
 s_add_u32 s51, s50, 32768
 buffer_store_dwordx4 v[112:115], v52, s[28:31], s51 offen offset:2048 sc1
 ds_write_b128 v51, v[112:115] offset:32768
 v_accvgpr_read_b32 v120, a220
 v_accvgpr_read_b32 v121, a221
 v_accvgpr_read_b32 v122, a222
 v_accvgpr_read_b32 v123, a223
 v_pk_mul_f32 v[120:121], v[120:121], s[56:57]
 v_pk_mul_f32 v[122:123], v[122:123], s[56:57]
 v_pk_mul_f32 v[124:125], v[124:125], s[56:57]
 v_pk_mul_f32 v[126:127], v[126:127], s[56:57]
 CV 120, 120, 121
 CV 121, 122, 123
 CV 122, 124, 125
 CV 123, 126, 127
 s_add_u32 s51, s50, 36864
 buffer_store_dwordx4 v[120:123], v52, s[28:31], s51 offen offset:0 sc1
 ds_write_b128 v51, v[120:123] offset:34816
 v_accvgpr_read_b32 v128, a224
 v_accvgpr_read_b32 v129, a225
 v_accvgpr_read_b32 v130, a226
 v_accvgpr_read_b32 v131, a227
 v_pk_mul_f32 v[128:129], v[128:129], s[56:57]
 v_pk_mul_f32 v[130:131], v[130:131], s[56:57]
 v_pk_mul_f32 v[132:133], v[132:133], s[56:57]
 v_pk_mul_f32 v[134:135], v[134:135], s[56:57]
 CV 128, 128, 129
 CV 129, 130, 131
 CV 130, 132, 133
 CV 131, 134, 135
 s_add_u32 s51, s50, 36864
 buffer_store_dwordx4 v[128:131], v52, s[28:31], s51 offen offset:2048 sc1
 ds_write_b128 v51, v[128:131] offset:36864
 s_cmp_eq_u32 s79, 0
 s_cbranch_scc1 P1_KD002
 s_add_u32 m0, s42, 32768
 s_add_u32 s3, s39, 67584
 DMAS 52, 28, 3, 0
 DMAS 52, 28, 3, 1024
 DMAS 52, 28, 3, 2048
 DMAS 52, 28, 3, 3072
P1_KD002:
 v_accvgpr_read_b32 v136, a228
 v_accvgpr_read_b32 v137, a229
 v_accvgpr_read_b32 v138, a230
 v_accvgpr_read_b32 v139, a231
 v_pk_mul_f32 v[136:137], v[136:137], s[56:57]
 v_pk_mul_f32 v[138:139], v[138:139], s[56:57]
 v_pk_mul_f32 v[140:141], v[140:141], s[56:57]
 v_pk_mul_f32 v[142:143], v[142:143], s[56:57]
 CV 136, 136, 137
 CV 137, 138, 139
 CV 138, 140, 141
 CV 139, 142, 143
 s_add_u32 s51, s50, 49152
 buffer_store_dwordx4 v[136:139], v52, s[28:31], s51 offen offset:3072 sc1
 ds_write_b128 v51, v[136:139] offset:49152
 v_accvgpr_read_b32 v144, a232
 v_accvgpr_read_b32 v145, a233
 v_accvgpr_read_b32 v146, a234
 v_accvgpr_read_b32 v147, a235
 v_pk_mul_f32 v[144:145], v[144:145], s[56:57]
 v_pk_mul_f32 v[146:147], v[146:147], s[56:57]
 v_pk_mul_f32 v[148:149], v[148:149], s[56:57]
 v_pk_mul_f32 v[150:151], v[150:151], s[56:57]
 CV 144, 144, 145
 CV 145, 146, 147
 CV 146, 148, 149
 CV 147, 150, 151
 s_add_u32 s51, s50, 53248
 buffer_store_dwordx4 v[144:147], v52, s[28:31], s51 offen offset:1024 sc1
 ds_write_b128 v51, v[144:147] offset:51200
 v_accvgpr_read_b32 v152, a236
 v_accvgpr_read_b32 v153, a237
 v_accvgpr_read_b32 v154, a238
 v_accvgpr_read_b32 v155, a239
 v_pk_mul_f32 v[152:153], v[152:153], s[56:57]
 v_pk_mul_f32 v[154:155], v[154:155], s[56:57]
 v_pk_mul_f32 v[156:157], v[156:157], s[56:57]
 v_pk_mul_f32 v[158:159], v[158:159], s[56:57]
 CV 152, 152, 153
 CV 153, 154, 155
 CV 154, 156, 157
 CV 155, 158, 159
 s_add_u32 s51, s50, 53248
 buffer_store_dwordx4 v[152:155], v52, s[28:31], s51 offen offset:3072 sc1
 ds_write_b128 v51, v[152:155] offset:53248
 s_cmp_eq_u32 s79, 0
 s_cbranch_scc1 P1_KD011
 s_add_u32 m0, s42, 81920
 s_add_u32 s3, s39, 33792
 DMAS 54, 28, 3, 0
 DMAS 54, 28, 3, 1024
 DMAS 54, 28, 3, 2048
 DMAS 54, 28, 3, 3072
P1_KD011:
 v_accvgpr_read_b32 v160, a240
 v_accvgpr_read_b32 v161, a241
 v_accvgpr_read_b32 v162, a242
 v_accvgpr_read_b32 v163, a243
 v_pk_mul_f32 v[160:161], v[160:161], s[56:57]
 v_pk_mul_f32 v[162:163], v[162:163], s[56:57]
 v_pk_mul_f32 v[164:165], v[164:165], s[56:57]
 v_pk_mul_f32 v[166:167], v[166:167], s[56:57]
 CV 160, 160, 161
 CV 161, 162, 163
 CV 162, 164, 165
 CV 163, 166, 167
 s_add_u32 s51, s50, 53248
 buffer_store_dwordx4 v[160:163], v52, s[28:31], s51 offen offset:0 sc1
 ds_write_b128 v51, v[160:163] offset:50176
 v_accvgpr_read_b32 v168, a244
 v_accvgpr_read_b32 v169, a245
 v_accvgpr_read_b32 v170, a246
 v_accvgpr_read_b32 v171, a247
 v_pk_mul_f32 v[168:169], v[168:169], s[56:57]
 v_pk_mul_f32 v[170:171], v[170:171], s[56:57]
 v_pk_mul_f32 v[172:173], v[172:173], s[56:57]
 v_pk_mul_f32 v[174:175], v[174:175], s[56:57]
 CV 168, 168, 169
 CV 169, 170, 171
 CV 170, 172, 173
 CV 171, 174, 175
 s_add_u32 s51, s50, 53248
 buffer_store_dwordx4 v[168:171], v52, s[28:31], s51 offen offset:2048 sc1
 ds_write_b128 v51, v[168:171] offset:52224
 v_accvgpr_read_b32 v176, a248
 v_accvgpr_read_b32 v177, a249
 v_accvgpr_read_b32 v178, a250
 v_accvgpr_read_b32 v179, a251
 v_pk_mul_f32 v[176:177], v[176:177], s[56:57]
 v_pk_mul_f32 v[178:179], v[178:179], s[56:57]
 v_pk_mul_f32 v[180:181], v[180:181], s[56:57]
 v_pk_mul_f32 v[182:183], v[182:183], s[56:57]
 CV 176, 176, 177
 CV 177, 178, 179
 CV 178, 180, 181
 CV 179, 182, 183
 s_add_u32 s51, s50, 57344
 buffer_store_dwordx4 v[176:179], v52, s[28:31], s51 offen offset:0 sc1
 ds_write_b128 v51, v[176:179] offset:54272
 v_accvgpr_read_b32 v184, a252
 v_accvgpr_read_b32 v185, a253
 v_accvgpr_read_b32 v186, a254
 v_accvgpr_read_b32 v187, a255
 v_pk_mul_f32 v[184:185], v[184:185], s[56:57]
 v_pk_mul_f32 v[186:187], v[186:187], s[56:57]
 v_pk_mul_f32 v[188:189], v[188:189], s[56:57]
 v_pk_mul_f32 v[190:191], v[190:191], s[56:57]
 CV 184, 184, 185
 CV 185, 186, 187
 CV 186, 188, 189
 CV 187, 190, 191
 s_add_u32 s51, s50, 32768
 buffer_store_dwordx4 v[184:187], v52, s[28:31], s51 offen offset:3072 sc1
 ds_write_b128 v51, v[184:187] offset:33792
 v_accvgpr_read_b32 v192, a56
 v_accvgpr_read_b32 v193, a57
 v_accvgpr_read_b32 v194, a58
 v_accvgpr_read_b32 v195, a59
 v_pk_mul_f32 v[192:193], v[192:193], s[56:57]
 v_pk_mul_f32 v[194:195], v[194:195], s[56:57]
 v_pk_mul_f32 v[196:197], v[196:197], s[56:57]
 v_pk_mul_f32 v[198:199], v[198:199], s[56:57]
 CV 192, 192, 193
 CV 193, 194, 195
 CV 194, 196, 197
 CV 195, 198, 199
 s_add_u32 s51, s50, 36864
 buffer_store_dwordx4 v[192:195], v52, s[28:31], s51 offen offset:1024 sc1
 ds_write_b128 v51, v[192:195] offset:35840
 v_accvgpr_read_b32 v200, a60
 v_accvgpr_read_b32 v201, a61
 v_accvgpr_read_b32 v202, a62
 v_accvgpr_read_b32 v203, a63
 v_pk_mul_f32 v[200:201], v[200:201], s[56:57]
 v_pk_mul_f32 v[202:203], v[202:203], s[56:57]
 v_pk_mul_f32 v[204:205], v[204:205], s[56:57]
 v_pk_mul_f32 v[206:207], v[206:207], s[56:57]
 CV 200, 200, 201
 CV 201, 202, 203
 CV 202, 204, 205
 CV 203, 206, 207
 s_add_u32 s51, s50, 36864
 buffer_store_dwordx4 v[200:203], v52, s[28:31], s51 offen offset:3072 sc1
 ds_write_b128 v51, v[200:203] offset:37888
 v_accvgpr_read_b32 v208, a120
 v_accvgpr_read_b32 v209, a121
 v_accvgpr_read_b32 v210, a122
 v_accvgpr_read_b32 v211, a123
 v_pk_mul_f32 v[208:209], v[208:209], s[56:57]
 v_pk_mul_f32 v[210:211], v[210:211], s[56:57]
 v_pk_mul_f32 v[212:213], v[212:213], s[56:57]
 v_pk_mul_f32 v[214:215], v[214:215], s[56:57]
 CV 208, 208, 209
 CV 209, 210, 211
 CV 210, 212, 213
 CV 211, 214, 215
 s_add_u32 s51, s50, 16384
 buffer_store_dwordx4 v[208:211], v52, s[28:31], s51 offen offset:2048 sc1
 ds_write_b128 v51, v[208:211] offset:17408
 v_accvgpr_read_b32 v216, a124
 v_accvgpr_read_b32 v217, a125
 v_accvgpr_read_b32 v218, a126
 v_accvgpr_read_b32 v219, a127
 v_pk_mul_f32 v[216:217], v[216:217], s[56:57]
 v_pk_mul_f32 v[218:219], v[218:219], s[56:57]
 v_pk_mul_f32 v[220:221], v[220:221], s[56:57]
 v_pk_mul_f32 v[222:223], v[222:223], s[56:57]
 CV 216, 216, 217
 CV 217, 218, 219
 CV 218, 220, 221
 CV 219, 222, 223
 s_add_u32 s51, s50, 20480
 buffer_store_dwordx4 v[216:219], v52, s[28:31], s51 offen offset:0 sc1
 ds_write_b128 v51, v[216:219] offset:19456
 v_accvgpr_read_b32 v224, a128
 v_accvgpr_read_b32 v225, a129
 v_accvgpr_read_b32 v226, a130
 v_accvgpr_read_b32 v227, a131
 v_pk_mul_f32 v[224:225], v[224:225], s[56:57]
 v_pk_mul_f32 v[226:227], v[226:227], s[56:57]
 v_pk_mul_f32 v[228:229], v[228:229], s[56:57]
 v_pk_mul_f32 v[230:231], v[230:231], s[56:57]
 CV 224, 224, 225
 CV 225, 226, 227
 CV 226, 228, 229
 CV 227, 230, 231
 s_add_u32 s51, s50, 20480
 buffer_store_dwordx4 v[224:227], v52, s[28:31], s51 offen offset:2048 sc1
 ds_write_b128 v51, v[224:227] offset:21504
 v_accvgpr_read_b32 v232, a132
 v_accvgpr_read_b32 v233, a133
 v_accvgpr_read_b32 v234, a134
 v_accvgpr_read_b32 v235, a135
 v_pk_mul_f32 v[232:233], v[232:233], s[56:57]
 v_pk_mul_f32 v[234:235], v[234:235], s[56:57]
 v_pk_mul_f32 v[236:237], v[236:237], s[56:57]
 v_pk_mul_f32 v[238:239], v[238:239], s[56:57]
 CV 232, 232, 233
 CV 233, 234, 235
 CV 234, 236, 237
 CV 235, 238, 239
 s_add_u32 s51, s50, 0
 buffer_store_dwordx4 v[232:235], v52, s[28:31], s51 offen offset:1024 sc1
 ds_write_b128 v51, v[232:235] offset:1024
 v_accvgpr_read_b32 v240, a136
 v_accvgpr_read_b32 v241, a137
 v_accvgpr_read_b32 v242, a138
 v_accvgpr_read_b32 v243, a139
 v_pk_mul_f32 v[240:241], v[240:241], s[56:57]
 v_pk_mul_f32 v[242:243], v[242:243], s[56:57]
 v_pk_mul_f32 v[244:245], v[244:245], s[56:57]
 v_pk_mul_f32 v[246:247], v[246:247], s[56:57]
 CV 240, 240, 241
 CV 241, 242, 243
 CV 242, 244, 245
 CV 243, 246, 247
 s_add_u32 s51, s50, 0
 buffer_store_dwordx4 v[240:243], v52, s[28:31], s51 offen offset:3072 sc1
 ds_write_b128 v51, v[240:243] offset:3072
 v_accvgpr_read_b32 v248, a140
 v_accvgpr_read_b32 v249, a141
 v_accvgpr_read_b32 v250, a142
 v_accvgpr_read_b32 v251, a143
 v_pk_mul_f32 v[248:249], v[248:249], s[56:57]
 v_pk_mul_f32 v[250:251], v[250:251], s[56:57]
 v_pk_mul_f32 v[252:253], v[252:253], s[56:57]
 v_pk_mul_f32 v[254:255], v[254:255], s[56:57]
 CV 248, 248, 249
 CV 249, 250, 251
 CV 250, 252, 253
 CV 251, 254, 255
 s_add_u32 s51, s50, 4096
 buffer_store_dwordx4 v[248:251], v52, s[28:31], s51 offen offset:1024 sc1
 ds_write_b128 v51, v[248:251] offset:5120
 s_branch P1_DONE
P1_B1:
 RA 0, 10, 0
 RT 32, 42, 0
 RT 34, 42, 2048
 RT 36, 43, 0
 RT 38, 43, 2048
 RT 40, 44, 0
 RT 42, 44, 2048
 RT 44, 45, 0
 RT 46, 45, 2048
 RT 48, 46, 0
 RT 50, 46, 1024
 RT 52, 47, 0
 RT 54, 47, 1024
 RA 4, 10, 2048
 RA 8, 10, 4096
 RA 12, 10, 6144
 RA 16, 10, 8192
 RA 20, 10, 10240
 RA 24, 10, 12288
 RA 28, 10, 14336
 s_waitcnt vmcnt(15) lgkmcnt(0)
 MAZ 192, 32, 0
 s_barrier
 MVZ 68, 36, 0
 RA 64, 11, 0
 s_add_u32 m0, s42, 0
 MAZ 196, 40, 0
 DMA 24, 20, 78, 0
 MVZ 76, 44, 0
 RT 96, 42, 16384
 v_accvgpr_read_b32 v2, a152
 MAZ 200, 48, 0
 v_accvgpr_read_b32 v3, a153
 v_accvgpr_read_b32 v4, a154
 MVZ 84, 52, 0
 RT 98, 42, 18432
 v_accvgpr_read_b32 v5, a155
 MVZ 108, 52, 4
 DMA 25, 20, 78, 1024
 v_accvgpr_read_b32 v6, a156
 MAZ 212, 48, 4
 RT 100, 43, 16384
 v_accvgpr_read_b32 v7, a157
 MVZ 100, 44, 4
 v_accvgpr_read_b32 v8, a158
 v_accvgpr_read_b32 v9, a159
 MAZ 208, 40, 4
 RT 102, 43, 18432
 CV 2, 2, 3
 MVZ 92, 36, 4
 DMA 26, 20, 78, 2048
 CV 3, 4, 5
 MAZ 204, 32, 4
 RT 104, 44, 16384
 CV 4, 6, 7
 MAZ 216, 32, 8
 CV 5, 8, 9
 buffer_store_dwordx4 v[2:5], v52, s[28:31], s50 offen offset:3072 sc1
 MVZ 116, 36, 8
 RT 106, 44, 18432
 MAZ 220, 40, 8
 DMA 27, 20, 78, 3072
 MVZ 124, 44, 8
 RT 108, 45, 16384
 MAZ 224, 48, 8
 MVZ 132, 52, 8
 RT 110, 45, 18432
 s_add_u32 s3, s42, 16384
 s_add_u32 m0, s3, s61
 MVZ 156, 52, 12
 DMAS 52, 28, 77, 0
 MAZ 236, 48, 12
 RT 112, 46, 8192
 MVZ 148, 44, 12
 MAZ 232, 40, 12
 RT 114, 46, 9216
 MVZ 140, 36, 12
 DMAS 52, 28, 77, 1024
 MAZ 228, 32, 12
 RT 116, 47, 8192
 MAZ 240, 32, 16
 MVZ 164, 36, 16
 RT 118, 47, 9216
 MAZ 244, 40, 16
 DMAS 52, 28, 77, 2048
 MVZ 172, 44, 16
 RA 68, 11, 2048
 v_accvgpr_read_b32 v56, a160
 MAZ 248, 48, 16
 v_accvgpr_read_b32 v57, a161
 v_accvgpr_read_b32 v58, a162
 MVZ 180, 52, 16
 RA 72, 11, 4096
 v_accvgpr_read_b32 v59, a163
 MVZ 204, 52, 20
 DMAS 52, 28, 77, 3072
 v_accvgpr_read_b32 v60, a164
 MAZ 60, 48, 20
 RA 76, 11, 6144
 v_accvgpr_read_b32 v61, a165
 MVZ 196, 44, 20
 v_accvgpr_read_b32 v62, a166
 v_accvgpr_read_b32 v63, a167
 MAZ 56, 40, 20
 RA 80, 11, 8192
 CV 56, 56, 57
 MVZ 188, 36, 20
 s_add_u32 s78, s78, 262144
 CV 57, 58, 59
 MAZ 252, 32, 20
 RA 84, 11, 10240
 s_add_u32 s77, s77, 16384
 MAZ 120, 32, 24
 CV 58, 60, 61
 CV 59, 62, 63
 MVZ 212, 36, 24
 RA 88, 11, 12288
 s_add_u32 s50, s48, 37888
 MAZ 124, 40, 24
 buffer_store_dwordx4 v[56:59], v52, s[28:31], s50 offen offset:0 sc1
 MVZ 220, 44, 24
 RA 92, 11, 14336
 MAZ 128, 48, 24
 MVZ 228, 52, 24
 MVZ 252, 52, 28
 MAZ 140, 48, 28
 s_mov_b32 s61, s60
 s_add_u32 s60, s60, 32768
 MVZ 244, 44, 28
 s_cmp_eq_u32 s60, 163840
 s_cselect_b32 s60, 65536, s60
 MAZ 136, 40, 28
 v_add_u32 v10, s60, v40
 v_add_u32 v11, s60, v41
 MVZ 236, 36, 28
 v_add_u32 v46, 32768, v46
 v_add_u32 v47, 32768, v47
 MAZ 132, 32, 28
 s_waitcnt vmcnt(14) lgkmcnt(0)
 MAA 192, 96, 64
 s_barrier
 MVA 68, 100, 64
 RA 0, 10, 0
 s_add_u32 m0, s42, 16384
 MAA 196, 104, 64
 DMA 24, 20, 78, 0
 MVA 76, 108, 64
 RT 32, 42, 32768
 v_accvgpr_read_b32 v2, a168
 MAA 200, 112, 64
 v_accvgpr_read_b32 v3, a169
 v_accvgpr_read_b32 v4, a170
 MVA 84, 116, 64
 RT 34, 42, 34816
 v_accvgpr_read_b32 v5, a171
 MVA 108, 116, 68
 DMA 25, 20, 78, 1024
 v_accvgpr_read_b32 v6, a172
 MAA 212, 112, 68
 RT 36, 43, 32768
 v_accvgpr_read_b32 v7, a173
 MVA 100, 108, 68
 v_accvgpr_read_b32 v8, a174
 v_accvgpr_read_b32 v9, a175
 MAA 208, 104, 68
 RT 38, 43, 34816
 CV 2, 2, 3
 MVA 92, 100, 68
 DMA 26, 20, 78, 2048
 CV 3, 4, 5
 MAA 204, 96, 68
 RT 40, 44, 32768
 CV 4, 6, 7
 MAA 216, 96, 72
 CV 5, 8, 9
 buffer_store_dwordx4 v[2:5], v52, s[28:31], s50 offen offset:1024 sc1
 MVA 116, 100, 72
 RT 42, 44, 34816
 MAA 220, 104, 72
 DMA 27, 20, 78, 3072
 MVA 124, 108, 72
 RT 44, 45, 32768
 MAA 224, 112, 72
 MVA 132, 116, 72
 RT 46, 45, 34816
 s_add_u32 m0, s42, s61
 MVA 156, 116, 76
 DMA 28, 16, 76, 0
 MAA 236, 112, 76
 RT 48, 46, 0
 MVA 148, 108, 76
 MAA 232, 104, 76
 RT 50, 46, 1024
 MVA 140, 100, 76
 DMA 29, 16, 76, 1024
 MAA 228, 96, 76
 RT 52, 47, 0
 MAA 240, 96, 80
 MVA 164, 100, 80
 RT 54, 47, 1024
 MAA 244, 104, 80
 DMA 30, 16, 76, 2048
 MVA 172, 108, 80
 RA 4, 10, 2048
 v_accvgpr_read_b32 v56, a176
 MAA 248, 112, 80
 v_accvgpr_read_b32 v57, a177
 v_accvgpr_read_b32 v58, a178
 MVA 180, 116, 80
 RA 8, 10, 4096
 v_accvgpr_read_b32 v59, a179
 MVA 204, 116, 84
 DMA 31, 16, 76, 3072
 v_accvgpr_read_b32 v60, a180
 MAA 60, 112, 84
 RA 12, 10, 6144
 v_accvgpr_read_b32 v61, a181
 MVA 196, 108, 84
 v_accvgpr_read_b32 v62, a182
 v_accvgpr_read_b32 v63, a183
 MAA 56, 104, 84
 RA 16, 10, 8192
 CV 56, 56, 57
 MVA 188, 100, 84
 s_add_u32 s78, s78, 262144
 CV 57, 58, 59
 MAA 252, 96, 84
 RA 20, 10, 10240
 s_add_u32 s76, s76, 128
 MAA 120, 96, 88
 CV 58, 60, 61
 CV 59, 62, 63
 MVA 212, 100, 88
 RA 24, 10, 12288
 buffer_store_dwordx4 v[56:59], v52, s[28:31], s50 offen offset:2048 sc1
 MAA 124, 104, 88
 MVA 220, 108, 88
 RA 28, 10, 14336
 MAA 128, 112, 88
 MVA 228, 116, 88
 MVA 252, 116, 92
 MAA 140, 112, 92
 MVA 244, 108, 92
 MAA 136, 104, 92
 MVA 236, 100, 92
 MAA 132, 96, 92
 s_waitcnt vmcnt(20) lgkmcnt(0)
 MAA 192, 32, 0
 s_barrier
 MVA 68, 36, 0
 RA 64, 11, 0
 s_add_u32 m0, s42, 32768
 MAA 196, 40, 0
 DMA 24, 20, 78, 0
 MVA 76, 44, 0
 RT 96, 42, 49152
 v_accvgpr_read_b32 v2, a184
 MAA 200, 48, 0
 v_accvgpr_read_b32 v3, a185
 v_accvgpr_read_b32 v4, a186
 MVA 84, 52, 0
 RT 98, 42, 51200
 v_accvgpr_read_b32 v5, a187
 MVA 108, 52, 4
 DMA 25, 20, 78, 1024
 v_accvgpr_read_b32 v6, a188
 MAA 212, 48, 4
 RT 100, 43, 49152
 v_accvgpr_read_b32 v7, a189
 MVA 100, 44, 4
 v_accvgpr_read_b32 v8, a190
 v_accvgpr_read_b32 v9, a191
 MAA 208, 40, 4
 RT 102, 43, 51200
 CV 2, 2, 3
 MVA 92, 36, 4
 DMA 26, 20, 78, 2048
 CV 3, 4, 5
 MAA 204, 32, 4
 RT 104, 44, 49152
 CV 4, 6, 7
 MAA 216, 32, 8
 CV 5, 8, 9
 buffer_store_dwordx4 v[2:5], v52, s[28:31], s50 offen offset:3072 sc1
 MVA 116, 36, 8
 RT 106, 44, 51200
 MAA 220, 40, 8
 DMA 27, 20, 78, 3072
 MVA 124, 44, 8
 RT 108, 45, 49152
 MAA 224, 48, 8
 MVA 132, 52, 8
 RT 110, 45, 51200
 s_add_u32 s3, s42, 16384
 s_add_u32 m0, s3, s61
 MVA 156, 52, 12
 DMAS 52, 28, 77, 0
 MAA 236, 48, 12
 RT 112, 46, 8192
 s_add_u32 s50, s48, 0
 MVA 148, 44, 12
 buffer_store_dwordx4 v[192:195], v52, s[28:31], s50 offen offset:0 sc1
 MAA 232, 40, 12
 RT 114, 46, 9216
 MVA 140, 36, 12
 DMAS 52, 28, 77, 1024
 MAA 228, 32, 12
 RT 116, 47, 8192
 MAA 240, 32, 16
 MVA 164, 36, 16
 RT 118, 47, 9216
 MAA 244, 40, 16
 DMAS 52, 28, 77, 2048
 MVA 172, 44, 16
 RA 68, 11, 2048
 MAA 248, 48, 16
 MVA 180, 52, 16
 RA 72, 11, 4096
 MVA 204, 52, 20
 DMAS 52, 28, 77, 3072
 MAA 60, 48, 20
 RA 76, 11, 6144
 MVA 196, 44, 20
 MAA 56, 40, 20
 RA 80, 11, 8192
 MVA 188, 36, 20
 s_add_u32 s78, s78, 262144
 MAA 252, 32, 20
 RA 84, 11, 10240
 s_add_u32 s77, s77, 16384
 MAA 120, 32, 24
 buffer_store_dwordx4 v[200:203], v52, s[28:31], s50 offen offset:1024 sc1
 MVA 212, 36, 24
 RA 88, 11, 12288
 MAA 124, 40, 24
 MVA 220, 44, 24
 RA 92, 11, 14336
 MAA 128, 48, 24
 MVA 228, 52, 24
 MVA 252, 52, 28
 MAA 140, 48, 28
 s_mov_b32 s61, s60
 s_add_u32 s60, s60, 32768
 MVA 244, 44, 28
 s_cmp_eq_u32 s60, 163840
 s_cselect_b32 s60, 65536, s60
 MAA 136, 40, 28
 v_add_u32 v10, s60, v40
 v_add_u32 v11, s60, v41
 MVA 236, 36, 28
 v_add_u32 v46, 4294901760, v46
 v_add_u32 v47, 4294901760, v47
 MAA 132, 32, 28
 s_waitcnt vmcnt(21) lgkmcnt(0)
 MAA 192, 96, 64
 s_barrier
 MVA 68, 100, 64
 RA 0, 10, 0
 s_add_u32 m0, s42, 49152
 MAA 196, 104, 64
 DMA 24, 20, 78, 0
 MVA 76, 108, 64
 RT 32, 42, 0
 buffer_store_dwordx4 v[208:211], v52, s[28:31], s50 offen offset:2048 sc1
 MAA 200, 112, 64
 MVA 84, 116, 64
 RT 34, 42, 2048
 MVA 108, 116, 68
 DMA 25, 20, 78, 1024
 MAA 212, 112, 68
 RT 36, 43, 0
 MVA 100, 108, 68
 MAA 208, 104, 68
 RT 38, 43, 2048
 MVA 92, 100, 68
 DMA 26, 20, 78, 2048
 MAA 204, 96, 68
 RT 40, 44, 0
 MAA 216, 96, 72
 MVA 116, 100, 72
 RT 42, 44, 2048
 MAA 220, 104, 72
 DMA 27, 20, 78, 3072
 MVA 124, 108, 72
 RT 44, 45, 0
 MAA 224, 112, 72
 MVA 132, 116, 72
 RT 46, 45, 2048
 s_add_u32 m0, s42, s61
 MVA 156, 116, 76
 DMA 28, 16, 76, 0
 MAA 236, 112, 76
 RT 48, 46, 0
 buffer_store_dwordx4 v[216:219], v52, s[28:31], s50 offen offset:3072 sc1
 MVA 148, 108, 76
 MAA 232, 104, 76
 RT 50, 46, 1024
 MVA 140, 100, 76
 DMA 29, 16, 76, 1024
 MAA 228, 96, 76
 RT 52, 47, 0
 MAA 240, 96, 80
 MVA 164, 100, 80
 RT 54, 47, 1024
 MAA 244, 104, 80
 DMA 30, 16, 76, 2048
 MVA 172, 108, 80
 RA 4, 10, 2048
 MAA 248, 112, 80
 MVA 180, 116, 80
 RA 8, 10, 4096
 MVA 204, 116, 84
 DMA 31, 16, 76, 3072
 MAA 60, 112, 84
 RA 12, 10, 6144
 MVA 196, 108, 84
 MAA 56, 104, 84
 RA 16, 10, 8192
 MVA 188, 100, 84
 s_add_u32 s78, s78, 262144
 MAA 252, 96, 84
 RA 20, 10, 10240
 s_add_u32 s76, s76, 128
 MAA 120, 96, 88
 s_add_u32 s50, s48, 4096
 buffer_store_dwordx4 v[224:227], v52, s[28:31], s50 offen offset:0 sc1
 MVA 212, 100, 88
 RA 24, 10, 12288
 MAA 124, 104, 88
 MVA 220, 108, 88
 RA 28, 10, 14336
 MAA 128, 112, 88
 MVA 228, 116, 88
 MVA 252, 116, 92
 MAA 140, 112, 92
 MVA 244, 108, 92
 MAA 136, 104, 92
 MVA 236, 100, 92
 MAA 132, 96, 92
 s_waitcnt vmcnt(22) lgkmcnt(0)
 MAA 192, 32, 0
 s_barrier
 MVA 68, 36, 0
 RA 64, 11, 0
 s_add_u32 m0, s42, 0
 MAA 196, 40, 0
 DMA 24, 20, 78, 0
 MVA 76, 44, 0
 RT 96, 42, 16384
 buffer_store_dwordx4 v[232:235], v52, s[28:31], s50 offen offset:1024 sc1
 MAA 200, 48, 0
 MVA 84, 52, 0
 RT 98, 42, 18432
 MVA 108, 52, 4
 DMA 25, 20, 78, 1024
 MAA 212, 48, 4
 RT 100, 43, 16384
 MVA 100, 44, 4
 MAA 208, 40, 4
 RT 102, 43, 18432
 MVA 92, 36, 4
 DMA 26, 20, 78, 2048
 MAA 204, 32, 4
 RT 104, 44, 16384
 MAA 216, 32, 8
 MVA 116, 36, 8
 RT 106, 44, 18432
 MAA 220, 40, 8
 DMA 27, 20, 78, 3072
 MVA 124, 44, 8
 RT 108, 45, 16384
 MAA 224, 48, 8
 MVA 132, 52, 8
 RT 110, 45, 18432
 s_add_u32 s3, s42, 16384
 s_add_u32 m0, s3, s61
 MVA 156, 52, 12
 DMAS 52, 28, 77, 0
 MAA 236, 48, 12
 RT 112, 46, 8192
 buffer_store_dwordx4 v[240:243], v52, s[28:31], s50 offen offset:2048 sc1
 MVA 148, 44, 12
 MAA 232, 40, 12
 RT 114, 46, 9216
 MVA 140, 36, 12
 DMAS 52, 28, 77, 1024
 MAA 228, 32, 12
 RT 116, 47, 8192
 MAA 240, 32, 16
 MVA 164, 36, 16
 RT 118, 47, 9216
 MAA 244, 40, 16
 DMAS 52, 28, 77, 2048
 MVA 172, 44, 16
 RA 68, 11, 2048
 MAA 248, 48, 16
 MVA 180, 52, 16
 RA 72, 11, 4096
 MVA 204, 52, 20
 DMAS 52, 28, 77, 3072
 MAA 60, 48, 20
 RA 76, 11, 6144
 MVA 196, 44, 20
 MAA 56, 40, 20
 RA 80, 11, 8192
 MVA 188, 36, 20
 s_add_u32 s78, s78, 262144
 MAA 252, 32, 20
 RA 84, 11, 10240
 s_add_u32 s77, s77, 16384
 MAA 120, 32, 24
 buffer_store_dwordx4 v[248:251], v52, s[28:31], s50 offen offset:3072 sc1
 MVA 212, 36, 24
 RA 88, 11, 12288
 MAA 124, 40, 24
 MVA 220, 44, 24
 RA 92, 11, 14336
 MAA 128, 48, 24
 MVA 228, 52, 24
 MVA 252, 52, 28
 MAA 140, 48, 28
 s_mov_b32 s61, s60
 s_add_u32 s60, s60, 32768
 MVA 244, 44, 28
 s_cmp_eq_u32 s60, 163840
 s_cselect_b32 s60, 65536, s60
 MAA 136, 40, 28
 v_add_u32 v10, s60, v40
 v_add_u32 v11, s60, v41
 MVA 236, 36, 28
 v_add_u32 v46, 32768, v46
 v_add_u32 v47, 32768, v47
 MAA 132, 32, 28
 s_waitcnt vmcnt(22) lgkmcnt(0)
 MAA 192, 96, 64
 s_barrier
 MVA 68, 100, 64
 RA 0, 10, 0
 s_add_u32 m0, s42, 16384
 MAA 196, 104, 64
 DMA 24, 20, 78, 0
 MVA 76, 108, 64
 RT 32, 42, 32768
 s_add_u32 s50, s74, 0
 MAA 200, 112, 64
 buffer_store_dwordx4 v[64:67], v52, s[28:31], s50 offen offset:0 sc1
 MVA 84, 116, 64
 RT 34, 42, 34816
 MVA 108, 116, 68
 DMA 25, 20, 78, 1024
 MAA 212, 112, 68
 RT 36, 43, 32768
 MVA 100, 108, 68
 MAA 208, 104, 68
 RT 38, 43, 34816
 MVA 92, 100, 68
 DMA 26, 20, 78, 2048
 MAA 204, 96, 68
 RT 40, 44, 32768
 MAA 216, 96, 72
 MVA 116, 100, 72
 RT 42, 44, 34816
 MAA 220, 104, 72
 DMA 27, 20, 78, 3072
 MVA 124, 108, 72
 RT 44, 45, 32768
 MAA 224, 112, 72
 MVA 132, 116, 72
 RT 46, 45, 34816
 s_add_u32 m0, s42, s61
 MVA 156, 116, 76
 DMA 28, 16, 76, 0
 MAA 236, 112, 76
 RT 48, 46, 0
 buffer_store_dwordx4 v[72:75], v52, s[28:31], s50 offen offset:1024 sc1
 MVA 148, 108, 76
 MAA 232, 104, 76
 RT 50, 46, 1024
 MVA 140, 100, 76
 DMA 29, 16, 76, 1024
 MAA 228, 96, 76
 RT 52, 47, 0
 MAA 240, 96, 80
 MVA 164, 100, 80
 RT 54, 47, 1024
 MAA 244, 104, 80
 DMA 30, 16, 76, 2048
 MVA 172, 108, 80
 RA 4, 10, 2048
 MAA 248, 112, 80
 MVA 180, 116, 80
 RA 8, 10, 4096
 MVA 204, 116, 84
 DMA 31, 16, 76, 3072
 MAA 60, 112, 84
 RA 12, 10, 6144
 MVA 196, 108, 84
 MAA 56, 104, 84
 RA 16, 10, 8192
 MVA 188, 100, 84
 s_add_u32 s78, s78, 262144
 MAA 252, 96, 84
 RA 20, 10, 10240
 s_add_u32 s76, s76, 128
 MAA 120, 96, 88
 buffer_store_dwordx4 v[80:83], v52, s[28:31], s50 offen offset:2048 sc1
 MVA 212, 100, 88
 RA 24, 10, 12288
 MAA 124, 104, 88
 MVA 220, 108, 88
 RA 28, 10, 14336
 MAA 128, 112, 88
 MVA 228, 116, 88
 MVA 252, 116, 92
 MAA 140, 112, 92
 MVA 244, 108, 92
 MAA 136, 104, 92
 MVA 236, 100, 92
 MAA 132, 96, 92
 s_waitcnt vmcnt(22) lgkmcnt(0)
 MAA 192, 32, 0
 s_barrier
 MVA 68, 36, 0
 RA 64, 11, 0
 s_add_u32 m0, s42, 32768
 MAA 196, 40, 0
 DMA 24, 20, 78, 0
 MVA 76, 44, 0
 RT 96, 42, 49152
 buffer_store_dwordx4 v[88:91], v52, s[28:31], s50 offen offset:3072 sc1
 MAA 200, 48, 0
 MVA 84, 52, 0
 RT 98, 42, 51200
 MVA 108, 52, 4
 DMA 25, 20, 78, 1024
 MAA 212, 48, 4
 RT 100, 43, 49152
 MVA 100, 44, 4
 MAA 208, 40, 4
 RT 102, 43, 51200
 MVA 92, 36, 4
 DMA 26, 20, 78, 2048
 MAA 204, 32, 4
 RT 104, 44, 49152
 MAA 216, 32, 8
 MVA 116, 36, 8
 RT 106, 44, 51200
 MAA 220, 40, 8
 DMA 27, 20, 78, 3072
 MVA 124, 44, 8
 RT 108, 45, 49152
 MAA 224, 48, 8
 MVA 132, 52, 8
 RT 110, 45, 51200
 s_add_u32 s3, s42, 16384
 s_add_u32 m0, s3, s61
 MVA 156, 52, 12
 DMAS 52, 28, 77, 0
 MAA 236, 48, 12
 RT 112, 46, 8192
 s_add_u32 s50, s74, 4096
 MVA 148, 44, 12
 buffer_store_dwordx4 v[96:99], v52, s[28:31], s50 offen offset:0 sc1
 MAA 232, 40, 12
 RT 114, 46, 9216
 MVA 140, 36, 12
 DMAS 52, 28, 77, 1024
 MAA 228, 32, 12
 RT 116, 47, 8192
 MAA 240, 32, 16
 MVA 164, 36, 16
 RT 118, 47, 9216
 MAA 244, 40, 16
 DMAS 52, 28, 77, 2048
 MVA 172, 44, 16
 RA 68, 11, 2048
 MAA 248, 48, 16
 MVA 180, 52, 16
 RA 72, 11, 4096
 MVA 204, 52, 20
 DMAS 52, 28, 77, 3072
 MAA 60, 48, 20
 RA 76, 11, 6144
 MVA 196, 44, 20
 MAA 56, 40, 20
 RA 80, 11, 8192
 MVA 188, 36, 20
 s_add_u32 s78, s78, 262144
 MAA 252, 32, 20
 RA 84, 11, 10240
 s_add_u32 s77, s77, 16384
 MAA 120, 32, 24
 buffer_store_dwordx4 v[104:107], v52, s[28:31], s50 offen offset:1024 sc1
 MVA 212, 36, 24
 RA 88, 11, 12288
 MAA 124, 40, 24
 MVA 220, 44, 24
 RA 92, 11, 14336
 MAA 128, 48, 24
 MVA 228, 52, 24
 MVA 252, 52, 28
 MAA 140, 48, 28
 s_mov_b32 s61, s60
 s_add_u32 s60, s60, 32768
 MVA 244, 44, 28
 s_cmp_eq_u32 s60, 163840
 s_cselect_b32 s60, 65536, s60
 MAA 136, 40, 28
 v_add_u32 v10, s60, v40
 v_add_u32 v11, s60, v41
 MVA 236, 36, 28
 v_add_u32 v46, 32768, v46
 v_add_u32 v47, 32768, v47
 MAA 132, 32, 28
 s_waitcnt vmcnt(22) lgkmcnt(0)
 MAA 192, 96, 64
 s_barrier
 MVA 68, 100, 64
 RA 0, 10, 0
 s_add_u32 m0, s42, 49152
 MAA 196, 104, 64
 DMA 24, 20, 78, 0
 MVA 76, 108, 64
 RT 32, 42, 0
 buffer_store_dwordx4 v[112:115], v52, s[28:31], s50 offen offset:2048 sc1
 MAA 200, 112, 64
 MVA 84, 116, 64
 RT 34, 42, 2048
 MVA 108, 116, 68
 DMA 25, 20, 78, 1024
 MAA 212, 112, 68
 RT 36, 43, 0
 MVA 100, 108, 68
 MAA 208, 104, 68
 RT 38, 43, 2048
 MVA 92, 100, 68
 DMA 26, 20, 78, 2048
 MAA 204, 96, 68
 RT 40, 44, 0
 MAA 216, 96, 72
 MVA 116, 100, 72
 RT 42, 44, 2048
 MAA 220, 104, 72
 DMA 27, 20, 78, 3072
 MVA 124, 108, 72
 RT 44, 45, 0
 MAA 224, 112, 72
 MVA 132, 116, 72
 RT 46, 45, 2048
 s_add_u32 m0, s42, s61
 MVA 156, 116, 76
 DMA 28, 16, 76, 0
 MAA 236, 112, 76
 RT 48, 46, 0
 buffer_store_dwordx4 v[120:123], v52, s[28:31], s50 offen offset:3072 sc1
 MVA 148, 108, 76
 MAA 232, 104, 76
 RT 50, 46, 1024
 MVA 140, 100, 76
 DMA 29, 16, 76, 1024
 MAA 228, 96, 76
 RT 52, 47, 0
 MAA 240, 96, 80
 MVA 164, 100, 80
 RT 54, 47, 1024
 MAA 244, 104, 80
 DMA 30, 16, 76, 2048
 MVA 172, 108, 80
 RA 4, 10, 2048
 MAA 248, 112, 80
 MVA 180, 116, 80
 RA 8, 10, 4096
 MVA 204, 116, 84
 DMA 31, 16, 76, 3072
 MAA 60, 112, 84
 RA 12, 10, 6144
 MVA 196, 108, 84
 MAA 56, 104, 84
 RA 16, 10, 8192
 MVA 188, 100, 84
 s_add_u32 s78, s78, 262144
 MAA 252, 96, 84
 RA 20, 10, 10240
 s_add_u32 s76, s76, 128
 MAA 120, 96, 88
 s_add_u32 s50, s81, 0
 buffer_store_dwordx4 v[128:131], v52, s[28:31], s50 offen offset:0 sc1
 MVA 212, 100, 88
 RA 24, 10, 12288
 MAA 124, 104, 88
 MVA 220, 108, 88
 RA 28, 10, 14336
 MAA 128, 112, 88
 MVA 228, 116, 88
 MVA 252, 116, 92
 MAA 140, 112, 92
 MVA 244, 108, 92
 MAA 136, 104, 92
 MVA 236, 100, 92
 MAA 132, 96, 92
 s_waitcnt vmcnt(22) lgkmcnt(0)
 MAA 192, 32, 0
 s_barrier
 MVA 68, 36, 0
 RA 64, 11, 0
 s_add_u32 m0, s42, 0
 MAA 196, 40, 0
 DMA 24, 20, 78, 0
 MVA 76, 44, 0
 RT 96, 42, 16384
 buffer_store_dwordx4 v[136:139], v52, s[28:31], s50 offen offset:1024 sc1
 MAA 200, 48, 0
 MVA 84, 52, 0
 RT 98, 42, 18432
 MVA 108, 52, 4
 DMA 25, 20, 78, 1024
 MAA 212, 48, 4
 RT 100, 43, 16384
 MVA 100, 44, 4
 MAA 208, 40, 4
 RT 102, 43, 18432
 MVA 92, 36, 4
 DMA 26, 20, 78, 2048
 MAA 204, 32, 4
 RT 104, 44, 16384
 MAA 216, 32, 8
 MVA 116, 36, 8
 RT 106, 44, 18432
 MAA 220, 40, 8
 DMA 27, 20, 78, 3072
 MVA 124, 44, 8
 RT 108, 45, 16384
 MAA 224, 48, 8
 MVA 132, 52, 8
 RT 110, 45, 18432
 s_add_u32 s3, s42, 16384
 s_add_u32 m0, s3, s61
 MVA 156, 52, 12
 DMAS 52, 28, 77, 0
 MAA 236, 48, 12
 RT 112, 46, 8192
 buffer_store_dwordx4 v[144:147], v52, s[28:31], s50 offen offset:2048 sc1
 MVA 148, 44, 12
 MAA 232, 40, 12
 RT 114, 46, 9216
 MVA 140, 36, 12
 DMAS 52, 28, 77, 1024
 MAA 228, 32, 12
 RT 116, 47, 8192
 MAA 240, 32, 16
 MVA 164, 36, 16
 RT 118, 47, 9216
 MAA 244, 40, 16
 DMAS 52, 28, 77, 2048
 MVA 172, 44, 16
 RA 68, 11, 2048
 MAA 248, 48, 16
 MVA 180, 52, 16
 RA 72, 11, 4096
 MVA 204, 52, 20
 DMAS 52, 28, 77, 3072
 MAA 60, 48, 20
 RA 76, 11, 6144
 MVA 196, 44, 20
 MAA 56, 40, 20
 RA 80, 11, 8192
 MVA 188, 36, 20
 s_add_u32 s78, s78, 262144
 MAA 252, 32, 20
 RA 84, 11, 10240
 s_add_u32 s77, s77, 16384
 MAA 120, 32, 24
 buffer_store_dwordx4 v[152:155], v52, s[28:31], s50 offen offset:3072 sc1
 MVA 212, 36, 24
 RA 88, 11, 12288
 MAA 124, 40, 24
 MVA 220, 44, 24
 RA 92, 11, 14336
 MAA 128, 48, 24
 MVA 228, 52, 24
 MVA 252, 52, 28
 MAA 140, 48, 28
 s_mov_b32 s61, s60
 s_add_u32 s60, s60, 32768
 MVA 244, 44, 28
 s_cmp_eq_u32 s60, 163840
 s_cselect_b32 s60, 65536, s60
 MAA 136, 40, 28
 v_add_u32 v10, s60, v40
 v_add_u32 v11, s60, v41
 MVA 236, 36, 28
 v_add_u32 v46, 4294901760, v46
 v_add_u32 v47, 4294901760, v47
 MAA 132, 32, 28
 s_waitcnt vmcnt(22) lgkmcnt(0)
 MAA 192, 96, 64
 s_barrier
 MVA 68, 100, 64
 RA 0, 10, 0
 s_add_u32 m0, s42, 16384
 MAA 196, 104, 64
 DMA 24, 20, 78, 0
 MVA 76, 108, 64
 RT 32, 42, 32768
 s_add_u32 s50, s81, 4096
 MAA 200, 112, 64
 buffer_store_dwordx4 v[160:163], v52, s[28:31], s50 offen offset:0 sc1
 MVA 84, 116, 64
 RT 34, 42, 34816
 MVA 108, 116, 68
 DMA 25, 20, 78, 1024
 MAA 212, 112, 68
 RT 36, 43, 32768
 MVA 100, 108, 68
 MAA 208, 104, 68
 RT 38, 43, 34816
 MVA 92, 100, 68
 DMA 26, 20, 78, 2048
 MAA 204, 96, 68
 RT 40, 44, 32768
 MAA 216, 96, 72
 MVA 116, 100, 72
 RT 42, 44, 34816
 MAA 220, 104, 72
 DMA 27, 20, 78, 3072
 MVA 124, 108, 72
 RT 44, 45, 32768
 MAA 224, 112, 72
 MVA 132, 116, 72
 RT 46, 45, 34816
 MVA 156, 116, 76
 s_add_u32 s78, s78, 262144
 MAA 236, 112, 76
 RT 48, 46, 0
 MVA 148, 108, 76
 MAA 232, 104, 76
 RT 50, 46, 1024
 MVA 140, 100, 76
 MAA 228, 96, 76
 RT 52, 47, 0
 MAA 240, 96, 80
 MVA 164, 100, 80
 RT 54, 47, 1024
 MAA 244, 104, 80
 MVA 172, 108, 80
 RA 4, 10, 2048
 buffer_store_dwordx4 v[168:171], v52, s[28:31], s50 offen offset:1024 sc1
 MAA 248, 112, 80
 MVA 180, 116, 80
 RA 8, 10, 4096
 MVA 204, 116, 84
 MAA 60, 112, 84
 RA 12, 10, 6144
 MVA 196, 108, 84
 MAA 56, 104, 84
 RA 16, 10, 8192
 MVA 188, 100, 84
 MAA 252, 96, 84
 RA 20, 10, 10240
 MAA 120, 96, 88
 MVA 212, 100, 88
 RA 24, 10, 12288
 MAA 124, 104, 88
 MVA 220, 108, 88
 RA 28, 10, 14336
 MAA 128, 112, 88
 MVA 228, 116, 88
 MVA 252, 116, 92
 MAA 140, 112, 92
 MVA 244, 108, 92
 MAA 136, 104, 92
 MVA 236, 100, 92
 MAA 132, 96, 92
 s_waitcnt vmcnt(17) lgkmcnt(0)
 MAA 192, 32, 0
 s_barrier
 MVA 68, 36, 0
 RA 64, 11, 0
 MAA 196, 40, 0
 MVA 76, 44, 0
 RT 96, 42, 49152
 buffer_store_dwordx4 v[176:179], v52, s[28:31], s50 offen offset:2048 sc1
 MAA 200, 48, 0
 MVA 84, 52, 0
 RT 98, 42, 51200
 MVA 108, 52, 4
 MAA 212, 48, 4
 RT 100, 43, 49152
 MVA 100, 44, 4
 MAA 208, 40, 4
 RT 102, 43, 51200
 MVA 92, 36, 4
 MAA 204, 32, 4
 RT 104, 44, 49152
 MAA 216, 32, 8
 MVA 116, 36, 8
 RT 106, 44, 51200
 MAA 220, 40, 8
 MVA 124, 44, 8
 RT 108, 45, 49152
 MAA 224, 48, 8
 MVA 132, 52, 8
 RT 110, 45, 51200
 MVA 156, 52, 12
 MAA 236, 48, 12
 RT 112, 46, 8192
 MVA 148, 44, 12
 MAA 232, 40, 12
 RT 114, 46, 9216
 MVA 140, 36, 12
 MAA 228, 32, 12
 RT 116, 47, 8192
 MAA 240, 32, 16
 MVA 164, 36, 16
 RT 118, 47, 9216
 MAA 244, 40, 16
 MVA 172, 44, 16
 RA 68, 11, 2048
 buffer_store_dwordx4 v[184:187], v52, s[28:31], s50 offen offset:3072 sc1
 MAA 248, 48, 16
 MVA 180, 52, 16
 RA 72, 11, 4096
 MVA 204, 52, 20
 MAA 60, 48, 20
 RA 76, 11, 6144
 MVA 196, 44, 20
 MAA 56, 40, 20
 RA 80, 11, 8192
 MVA 188, 36, 20
 MAA 252, 32, 20
 RA 84, 11, 10240
 MAA 120, 32, 24
 MVA 212, 36, 24
 RA 88, 11, 12288
 MAA 124, 40, 24
 MVA 220, 44, 24
 RA 92, 11, 14336
 MAA 128, 48, 24
 MVA 228, 52, 24
 MVA 252, 52, 28
 MAA 140, 48, 28
 s_mov_b32 s61, s60
 s_add_u32 s60, s60, 32768
 MVA 244, 44, 28
 s_cmp_eq_u32 s60, 163840
 s_cselect_b32 s60, 65536, s60
 MAA 136, 40, 28
 v_add_u32 v10, s60, v40
 v_add_u32 v11, s60, v41
 MVA 236, 36, 28
 v_add_u32 v46, 32768, v46
 v_add_u32 v47, 32768, v47
 MAA 132, 32, 28
 s_waitcnt vmcnt(8) lgkmcnt(0)
 MAA 192, 96, 64
 s_barrier
 MVA 68, 100, 64
 RA 0, 10, 0
 MAA 196, 104, 64
 MVA 76, 108, 64
 RT 32, 42, 0
 MAA 200, 112, 64
 MVA 84, 116, 64
 RT 34, 42, 2048
 MVA 108, 116, 68
 MAA 212, 112, 68
 RT 36, 43, 0
 MVA 100, 108, 68
 MAA 208, 104, 68
 RT 38, 43, 2048
 MVA 92, 100, 68
 MAA 204, 96, 68
 RT 40, 44, 0
 MAA 216, 96, 72
 MVA 116, 100, 72
 RT 42, 44, 2048
 MAA 220, 104, 72
 MVA 124, 108, 72
 RT 44, 45, 0
 MAA 224, 112, 72
 MVA 132, 116, 72
 RT 46, 45, 2048
 MVA 156, 116, 76
 MAA 236, 112, 76
 RT 48, 46, 0
 MVA 148, 108, 76
 MAA 232, 104, 76
 RT 50, 46, 1024
 MVA 140, 100, 76
 MAA 228, 96, 76
 RT 52, 47, 0
 MAA 240, 96, 80
 MVA 164, 100, 80
 RT 54, 47, 1024
 MAA 244, 104, 80
 MVA 172, 108, 80
 RA 4, 10, 2048
 MAA 248, 112, 80
 MVA 180, 116, 80
 RA 8, 10, 4096
 MVA 204, 116, 84
 MAA 60, 112, 84
 RA 12, 10, 6144
 MVA 196, 108, 84
 MAA 56, 104, 84
 RA 16, 10, 8192
 MVA 188, 100, 84
 MAA 252, 96, 84
 RA 20, 10, 10240
 MAA 120, 96, 88
 MVA 212, 100, 88
 RA 24, 10, 12288
 MAA 124, 104, 88
 MVA 220, 108, 88
 RA 28, 10, 14336
 MAA 128, 112, 88
 MVA 228, 116, 88
 MVA 252, 116, 92
 MAA 140, 112, 92
 MVA 244, 108, 92
 MAA 136, 104, 92
 MVA 236, 100, 92
 MAA 132, 96, 92
 s_waitcnt vmcnt(2) lgkmcnt(0)
 MAA 192, 32, 0
 s_barrier
 MVA 68, 36, 0
 RA 64, 11, 0
 MAA 196, 40, 0
 MVA 76, 44, 0
 RT 96, 42, 16384
 MAA 200, 48, 0
 MVA 84, 52, 0
 RT 98, 42, 18432
 MVA 108, 52, 4
 MAA 212, 48, 4
 RT 100, 43, 16384
 MVA 100, 44, 4
 MAA 208, 40, 4
 RT 102, 43, 18432
 MVA 92, 36, 4
 MAA 204, 32, 4
 RT 104, 44, 16384
 MAA 216, 32, 8
 MVA 116, 36, 8
 RT 106, 44, 18432
 MAA 220, 40, 8
 MVA 124, 44, 8
 RT 108, 45, 16384
 MAA 224, 48, 8
 MVA 132, 52, 8
 RT 110, 45, 18432
 MVA 156, 52, 12
 MAA 236, 48, 12
 RT 112, 46, 8192
 MVA 148, 44, 12
 MAA 232, 40, 12
 RT 114, 46, 9216
 MVA 140, 36, 12
 MAA 228, 32, 12
 RT 116, 47, 8192
 MAA 240, 32, 16
 MVA 164, 36, 16
 RT 118, 47, 9216
 MAA 244, 40, 16
 MVA 172, 44, 16
 RA 68, 11, 2048
 MAA 248, 48, 16
 MVA 180, 52, 16
 RA 72, 11, 4096
 MVA 204, 52, 20
 MAA 60, 48, 20
 RA 76, 11, 6144
 MVA 196, 44, 20
 MAA 56, 40, 20
 RA 80, 11, 8192
 MVA 188, 36, 20
 MAA 252, 32, 20
 RA 84, 11, 10240
 MAA 120, 32, 24
 MVA 212, 36, 24
 RA 88, 11, 12288
 MAA 124, 40, 24
 MVA 220, 44, 24
 RA 92, 11, 14336
 MAA 128, 48, 24
 MVA 228, 52, 24
 MVA 252, 52, 28
 MAA 140, 48, 28
 MVA 244, 44, 28
 MAA 136, 40, 28
 MVA 236, 36, 28
 MAA 132, 32, 28
 s_waitcnt lgkmcnt(0)
 buffer_load_dword v38, v55, s[28:31], s49 offen sc1
 MAA 192, 96, 64
 MVA 68, 100, 64
 MAA 196, 104, 64
 MVA 76, 108, 64
 MAA 200, 112, 64
 MVA 84, 116, 64
 MVA 108, 116, 68
 MAA 212, 112, 68
 MVA 100, 108, 68
 MAA 208, 104, 68
 MVA 92, 100, 68
 MAA 204, 96, 68
 MAA 216, 96, 72
 MVA 116, 100, 72
 MAA 220, 104, 72
 MVA 124, 108, 72
 MAA 224, 112, 72
 MVA 132, 116, 72
 MVA 156, 116, 76
 MAA 236, 112, 76
 MVA 148, 108, 76
 MAA 232, 104, 76
 MVA 140, 100, 76
 MAA 228, 96, 76
 MAA 240, 96, 80
 MVA 164, 100, 80
 MAA 244, 104, 80
 MVA 172, 108, 80
 MAA 248, 112, 80
 MVA 180, 116, 80
 MVA 204, 116, 84
 MAA 60, 112, 84
 MVA 196, 108, 84
 MAA 56, 104, 84
 MVA 188, 100, 84
 MAA 252, 96, 84
 MAA 120, 96, 88
 MVA 212, 100, 88
 MAA 124, 104, 88
 MVA 220, 108, 88
 MAA 128, 112, 88
 MVA 228, 116, 88
 MVA 252, 116, 92
 MAA 140, 112, 92
 MVA 244, 108, 92
 MAA 136, 104, 92
 MVA 236, 100, 92
 MAA 132, 96, 92
 s_mov_b32 s79, 1
P1_CHK1:
 s_waitcnt vmcnt(0)
 v_readfirstlane_b32 s3, v37
 v_cmp_eq_u32 vcc, 0, v38
 s_cmpk_eq_u32 s3, 256
 s_cbranch_scc1 P1_CHKOK1
 s_mov_b32 s79, 0
 s_sleep 4
 buffer_load_dword v37, v39, s[68:71], 0 offen sc1
 s_branch P1_CHK1
P1_CHKOK1:
 s_cmp_eq_u64 vcc, 0
 s_cselect_b32 s79, s79, 0
 s_barrier
 s_cmp_eq_u32 s79, 0
 s_cbranch_scc1 P1_KD100
 s_add_u32 m0, s42, 0
 s_add_u32 s3, s39, 0
 DMAS 52, 28, 3, 0
 DMAS 52, 28, 3, 1024
 DMAS 52, 28, 3, 2048
 DMAS 52, 28, 3, 3072
P1_KD100:
 s_mul_i32 s50, s46, 1115136
 s_mul_i32 s3, s47, 69632
 s_add_u32 s50, s50, s3
 s_mul_i32 s3, s4, 6144
 s_add_u32 s50, s50, s3
 s_add_u32 s50, s50, 35651584
 s_sub_u32 s3, s6, 16
 s_cmp_lt_u32 s3, 14
 s_cselect_b32 s50, s50, 0x70000000
 v_accvgpr_read_b32 v64, a192
 v_accvgpr_read_b32 v65, a193
 v_accvgpr_read_b32 v66, a194
 v_accvgpr_read_b32 v67, a195
 v_pk_mul_f32 v[64:65], v[64:65], s[56:57]
 v_pk_mul_f32 v[66:67], v[66:67], s[56:57]
 v_pk_mul_f32 v[68:69], v[68:69], s[56:57]
 v_pk_mul_f32 v[70:71], v[70:71], s[56:57]
 CV 64, 64, 65
 CV 65, 66, 67
 CV 66, 68, 69
 CV 67, 70, 71
 s_add_u32 s51, s50, 0
 buffer_store_dwordx4 v[64:67], v52, s[28:31], s51 offen offset:0 sc1
 ds_write_b128 v51, v[64:67] offset:0
 v_accvgpr_read_b32 v72, a196
 v_accvgpr_read_b32 v73, a197
 v_accvgpr_read_b32 v74, a198
 v_accvgpr_read_b32 v75, a199
 v_pk_mul_f32 v[72:73], v[72:73], s[56:57]
 v_pk_mul_f32 v[74:75], v[74:75], s[56:57]
 v_pk_mul_f32 v[76:77], v[76:77], s[56:57]
 v_pk_mul_f32 v[78:79], v[78:79], s[56:57]
 CV 72, 72, 73
 CV 73, 74, 75
 CV 74, 76, 77
 CV 75, 78, 79
 s_add_u32 s51, s50, 0
 buffer_store_dwordx4 v[72:75], v52, s[28:31], s51 offen offset:2048 sc1
 ds_write_b128 v51, v[72:75] offset:2048
 s_cmp_eq_u32 s79, 0
 s_cbranch_scc1 P1_KD101
 s_add_u32 m0, s42, 16384
 s_add_u32 s3, s39, 33792
 DMAS 52, 28, 3, 0
 DMAS 52, 28, 3, 1024
 DMAS 52, 28, 3, 2048
 DMAS 52, 28, 3, 3072
P1_KD101:
 v_accvgpr_read_b32 v88, a204
 v_accvgpr_read_b32 v89, a205
 v_accvgpr_read_b32 v90, a206
 v_accvgpr_read_b32 v91, a207
 v_pk_mul_f32 v[88:89], v[88:89], s[56:57]
 v_pk_mul_f32 v[90:91], v[90:91], s[56:57]
 v_pk_mul_f32 v[92:93], v[92:93], s[56:57]
 v_pk_mul_f32 v[94:95], v[94:95], s[56:57]
 CV 88, 88, 89
 CV 89, 90, 91
 CV 90, 92, 93
 CV 91, 94, 95
 s_add_u32 s51, s50, 16384
 buffer_store_dwordx4 v[88:91], v52, s[28:31], s51 offen offset:1024 sc1
 ds_write_b128 v51, v[88:91] offset:16384
 v_accvgpr_read_b32 v96, a208
 v_accvgpr_read_b32 v97, a209
 v_accvgpr_read_b32 v98, a210
 v_accvgpr_read_b32 v99, a211
 v_pk_mul_f32 v[96:97], v[96:97], s[56:57]
 v_pk_mul_f32 v[98:99], v[98:99], s[56:57]
 v_pk_mul_f32 v[100:101], v[100:101], s[56:57]
 v_pk_mul_f32 v[102:103], v[102:103], s[56:57]
 CV 96, 96, 97
 CV 97, 98, 99
 CV 98, 100, 101
 CV 99, 102, 103
 s_add_u32 s51, s50, 16384
 buffer_store_dwordx4 v[96:99], v52, s[28:31], s51 offen offset:3072 sc1
 ds_write_b128 v51, v[96:99] offset:18432
 s_cmp_eq_u32 s79, 0
 s_cbranch_scc1 P1_KD110
 s_add_u32 m0, s42, 65536
 s_add_u32 s3, s39, 0
 DMAS 54, 28, 3, 0
 DMAS 54, 28, 3, 1024
 DMAS 54, 28, 3, 2048
 DMAS 54, 28, 3, 3072
P1_KD110:
 v_accvgpr_read_b32 v112, a216
 v_accvgpr_read_b32 v113, a217
 v_accvgpr_read_b32 v114, a218
 v_accvgpr_read_b32 v115, a219
 v_pk_mul_f32 v[112:113], v[112:113], s[56:57]
 v_pk_mul_f32 v[114:115], v[114:115], s[56:57]
 v_pk_mul_f32 v[116:117], v[116:117], s[56:57]
 v_pk_mul_f32 v[118:119], v[118:119], s[56:57]
 CV 112, 112, 113
 CV 113, 114, 115
 CV 114, 116, 117
 CV 115, 118, 119
 s_add_u32 s51, s50, 32768
 buffer_store_dwordx4 v[112:115], v52, s[28:31], s51 offen offset:2048 sc1
 ds_write_b128 v51, v[112:115] offset:32768
 v_accvgpr_read_b32 v120, a220
 v_accvgpr_read_b32 v121, a221
 v_accvgpr_read_b32 v122, a222
 v_accvgpr_read_b32 v123, a223
 v_pk_mul_f32 v[120:121], v[120:121], s[56:57]
 v_pk_mul_f32 v[122:123], v[122:123], s[56:57]
 v_pk_mul_f32 v[124:125], v[124:125], s[56:57]
 v_pk_mul_f32 v[126:127], v[126:127], s[56:57]
 CV 120, 120, 121
 CV 121, 122, 123
 CV 122, 124, 125
 CV 123, 126, 127
 s_add_u32 s51, s50, 36864
 buffer_store_dwordx4 v[120:123], v52, s[28:31], s51 offen offset:0 sc1
 ds_write_b128 v51, v[120:123] offset:34816
 s_cmp_eq_u32 s79, 0
 s_cbranch_scc1 P1_KD102
 s_add_u32 m0, s42, 32768
 s_add_u32 s3, s39, 67584
 DMAS 52, 28, 3, 0
 DMAS 52, 28, 3, 1024
 DMAS 52, 28, 3, 2048
 DMAS 52, 28, 3, 3072
P1_KD102:
 v_accvgpr_read_b32 v136, a228
 v_accvgpr_read_b32 v137, a229
 v_accvgpr_read_b32 v138, a230
 v_accvgpr_read_b32 v139, a231
 v_pk_mul_f32 v[136:137], v[136:137], s[56:57]
 v_pk_mul_f32 v[138:139], v[138:139], s[56:57]
 v_pk_mul_f32 v[140:141], v[140:141], s[56:57]
 v_pk_mul_f32 v[142:143], v[142:143], s[56:57]
 CV 136, 136, 137
 CV 137, 138, 139
 CV 138, 140, 141
 CV 139, 142, 143
 s_add_u32 s51, s50, 49152
 buffer_store_dwordx4 v[136:139], v52, s[28:31], s51 offen offset:3072 sc1
 ds_write_b128 v51, v[136:139] offset:49152
 v_accvgpr_read_b32 v144, a232
 v_accvgpr_read_b32 v145, a233
 v_accvgpr_read_b32 v146, a234
 v_accvgpr_read_b32 v147, a235
 v_pk_mul_f32 v[144:145], v[144:145], s[56:57]
 v_pk_mul_f32 v[146:147], v[146:147], s[56:57]
 v_pk_mul_f32 v[148:149], v[148:149], s[56:57]
 v_pk_mul_f32 v[150:151], v[150:151], s[56:57]
 CV 144, 144, 145
 CV 145, 146, 147
 CV 146, 148, 149
 CV 147, 150, 151
 s_add_u32 s51, s50, 53248
 buffer_store_dwordx4 v[144:147], v52, s[28:31], s51 offen offset:1024 sc1
 ds_write_b128 v51, v[144:147] offset:51200
 s_cmp_eq_u32 s79, 0
 s_cbranch_scc1 P1_KD111
 s_add_u32 m0, s42, 81920
 s_add_u32 s3, s39, 33792
 DMAS 54, 28, 3, 0
 DMAS 54, 28, 3, 1024
 DMAS 54, 28, 3, 2048
 DMAS 54, 28, 3, 3072
P1_KD111:
 v_accvgpr_read_b32 v160, a240
 v_accvgpr_read_b32 v161, a241
 v_accvgpr_read_b32 v162, a242
 v_accvgpr_read_b32 v163, a243
 v_pk_mul_f32 v[160:161], v[160:161], s[56:57]
 v_pk_mul_f32 v[162:163], v[162:163], s[56:57]
 v_pk_mul_f32 v[164:165], v[164:165], s[56:57]
 v_pk_mul_f32 v[166:167], v[166:167], s[56:57]
 CV 160, 160, 161
 CV 161, 162, 163
 CV 162, 164, 165
 CV 163, 166, 167
 s_add_u32 s51, s50, 53248
 buffer_store_dwordx4 v[160:163], v52, s[28:31], s51 offen offset:0 sc1
 ds_write_b128 v51, v[160:163] offset:50176
 v_accvgpr_read_b32 v168, a244
 v_accvgpr_read_b32 v169, a245
 v_accvgpr_read_b32 v170, a246
 v_accvgpr_read_b32 v171, a247
 v_pk_mul_f32 v[168:169], v[168:169], s[56:57]
 v_pk_mul_f32 v[170:171], v[170:171], s[56:57]
 v_pk_mul_f32 v[172:173], v[172:173], s[56:57]
 v_pk_mul_f32 v[174:175], v[174:175], s[56:57]
 CV 168, 168, 169
 CV 169, 170, 171
 CV 170, 172, 173
 CV 171, 174, 175
 s_add_u32 s51, s50, 53248
 buffer_store_dwordx4 v[168:171], v52, s[28:31], s51 offen offset:2048 sc1
 ds_write_b128 v51, v[168:171] offset:52224
 v_accvgpr_read_b32 v184, a252
 v_accvgpr_read_b32 v185, a253
 v_accvgpr_read_b32 v186, a254
 v_accvgpr_read_b32 v187, a255
 v_pk_mul_f32 v[184:185], v[184:185], s[56:57]
 v_pk_mul_f32 v[186:187], v[186:187], s[56:57]
 v_pk_mul_f32 v[188:189], v[188:189], s[56:57]
 v_pk_mul_f32 v[190:191], v[190:191], s[56:57]
 CV 184, 184, 185
 CV 185, 186, 187
 CV 186, 188, 189
 CV 187, 190, 191
 s_add_u32 s51, s50, 32768
 buffer_store_dwordx4 v[184:187], v52, s[28:31], s51 offen offset:3072 sc1
 ds_write_b128 v51, v[184:187] offset:33792
 v_accvgpr_read_b32 v192, a56
 v_accvgpr_read_b32 v193, a57
 v_accvgpr_read_b32 v194, a58
 v_accvgpr_read_b32 v195, a59
 v_pk_mul_f32 v[192:193], v[192:193], s[56:57]
 v_pk_mul_f32 v[194:195], v[194:195], s[56:57]
 v_pk_mul_f32 v[196:197], v[196:197], s[56:57]
 v_pk_mul_f32 v[198:199], v[198:199], s[56:57]
 CV 192, 192, 193
 CV 193, 194, 195
 CV 194, 196, 197
 CV 195, 198, 199
 s_add_u32 s51, s50, 36864
 buffer_store_dwordx4 v[192:195], v52, s[28:31], s51 offen offset:1024 sc1
 ds_write_b128 v51, v[192:195] offset:35840
 v_accvgpr_read_b32 v208, a120
 v_accvgpr_read_b32 v209, a121
 v_accvgpr_read_b32 v210, a122
 v_accvgpr_read_b32 v211, a123
 v_pk_mul_f32 v[208:209], v[208:209], s[56:57]
 v_pk_mul_f32 v[210:211], v[210:211], s[56:57]
 v_pk_mul_f32 v[212:213], v[212:213], s[56:57]
 v_pk_mul_f32 v[214:215], v[214:215], s[56:57]
 CV 208, 208, 209
 CV 209, 210, 211
 CV 210, 212, 213
 CV 211, 214, 215
 s_add_u32 s51, s50, 16384
 buffer_store_dwordx4 v[208:211], v52, s[28:31], s51 offen offset:2048 sc1
 ds_write_b128 v51, v[208:211] offset:17408
 v_accvgpr_read_b32 v216, a124
 v_accvgpr_read_b32 v217, a125
 v_accvgpr_read_b32 v218, a126
 v_accvgpr_read_b32 v219, a127
 v_pk_mul_f32 v[216:217], v[216:217], s[56:57]
 v_pk_mul_f32 v[218:219], v[218:219], s[56:57]
 v_pk_mul_f32 v[220:221], v[220:221], s[56:57]
 v_pk_mul_f32 v[222:223], v[222:223], s[56:57]
 CV 216, 216, 217
 CV 217, 218, 219
 CV 218, 220, 221
 CV 219, 222, 223
 s_add_u32 s51, s50, 20480
 buffer_store_dwordx4 v[216:219], v52, s[28:31], s51 offen offset:0 sc1
 ds_write_b128 v51, v[216:219] offset:19456
 v_accvgpr_read_b32 v232, a132
 v_accvgpr_read_b32 v233, a133
 v_accvgpr_read_b32 v234, a134
 v_accvgpr_read_b32 v235, a135
 v_pk_mul_f32 v[232:233], v[232:233], s[56:57]
 v_pk_mul_f32 v[234:235], v[234:235], s[56:57]
 v_pk_mul_f32 v[236:237], v[236:237], s[56:57]
 v_pk_mul_f32 v[238:239], v[238:239], s[56:57]
 CV 232, 232, 233
 CV 233, 234, 235
 CV 234, 236, 237
 CV 235, 238, 239
 s_add_u32 s51, s50, 0
 buffer_store_dwordx4 v[232:235], v52, s[28:31], s51 offen offset:1024 sc1
 ds_write_b128 v51, v[232:235] offset:1024
 v_accvgpr_read_b32 v240, a136
 v_accvgpr_read_b32 v241, a137
 v_accvgpr_read_b32 v242, a138
 v_accvgpr_read_b32 v243, a139
 v_pk_mul_f32 v[240:241], v[240:241], s[56:57]
 v_pk_mul_f32 v[242:243], v[242:243], s[56:57]
 v_pk_mul_f32 v[244:245], v[244:245], s[56:57]
 v_pk_mul_f32 v[246:247], v[246:247], s[56:57]
 CV 240, 240, 241
 CV 241, 242, 243
 CV 242, 244, 245
 CV 243, 246, 247
 s_add_u32 s51, s50, 0
 buffer_store_dwordx4 v[240:243], v52, s[28:31], s51 offen offset:3072 sc1
 ds_write_b128 v51, v[240:243] offset:3072
 v_add_u32 v51, 49152, v52
 v_accvgpr_read_b32 v80, a200
 v_accvgpr_read_b32 v81, a201
 v_accvgpr_read_b32 v82, a202
 v_accvgpr_read_b32 v83, a203
 v_mul_f32 v56, s55, v80
 v_mul_f32 v57, s55, v81
 v_mul_f32 v58, s55, v82
 v_mul_f32 v59, s55, v83
 v_mul_f32 v60, s55, v84
 v_mul_f32 v61, s55, v85
 v_mul_f32 v62, s55, v86
 v_mul_f32 v63, s55, v87
 v_exp_f32 v56, v56 clamp
 v_exp_f32 v57, v57 clamp
 v_exp_f32 v58, v58 clamp
 v_exp_f32 v59, v59 clamp
 v_exp_f32 v60, v60 clamp
 v_exp_f32 v61, v61 clamp
 v_exp_f32 v62, v62 clamp
 v_exp_f32 v63, v63 clamp
 v_max_f32 v80, s80, v80
 v_max_f32 v81, s80, v81
 v_max_f32 v82, s80, v82
 v_max_f32 v83, s80, v83
 v_max_f32 v84, s80, v84
 v_max_f32 v85, s80, v85
 v_max_f32 v86, s80, v86
 v_max_f32 v87, s80, v87
 v_add_f32 v80, v80, v56
 v_add_f32 v81, v81, v57
 v_add_f32 v82, v82, v58
 v_add_f32 v83, v83, v59
 v_add_f32 v84, v84, v60
 v_add_f32 v85, v85, v61
 v_add_f32 v86, v86, v62
 v_add_f32 v87, v87, v63
 CV 80, 80, 81
 CV 81, 82, 83
 CV 82, 84, 85
 CV 83, 86, 87
 ds_write_b128 v51, v[80:83] offset:0
 v_accvgpr_read_b32 v104, a212
 v_accvgpr_read_b32 v105, a213
 v_accvgpr_read_b32 v106, a214
 v_accvgpr_read_b32 v107, a215
 v_mul_f32 v56, s55, v104
 v_mul_f32 v57, s55, v105
 v_mul_f32 v58, s55, v106
 v_mul_f32 v59, s55, v107
 v_mul_f32 v60, s55, v108
 v_mul_f32 v61, s55, v109
 v_mul_f32 v62, s55, v110
 v_mul_f32 v63, s55, v111
 v_exp_f32 v56, v56 clamp
 v_exp_f32 v57, v57 clamp
 v_exp_f32 v58, v58 clamp
 v_exp_f32 v59, v59 clamp
 v_exp_f32 v60, v60 clamp
 v_exp_f32 v61, v61 clamp
 v_exp_f32 v62, v62 clamp
 v_exp_f32 v63, v63 clamp
 v_max_f32 v104, s80, v104
 v_max_f32 v105, s80, v105
 v_max_f32 v106, s80, v106
 v_max_f32 v107, s80, v107
 v_max_f32 v108, s80, v108
 v_max_f32 v109, s80, v109
 v_max_f32 v110, s80, v110
 v_max_f32 v111, s80, v111
 v_add_f32 v104, v104, v56
 v_add_f32 v105, v105, v57
 v_add_f32 v106, v106, v58
 v_add_f32 v107, v107, v59
 v_add_f32 v108, v108, v60
 v_add_f32 v109, v109, v61
 v_add_f32 v110, v110, v62
 v_add_f32 v111, v111, v63
 CV 104, 104, 105
 CV 105, 106, 107
 CV 106, 108, 109
 CV 107, 110, 111
 ds_write_b128 v51, v[104:107] offset:2048
 v_accvgpr_read_b32 v128, a224
 v_accvgpr_read_b32 v129, a225
 v_accvgpr_read_b32 v130, a226
 v_accvgpr_read_b32 v131, a227
 v_mul_f32 v56, s55, v128
 v_mul_f32 v57, s55, v129
 v_mul_f32 v58, s55, v130
 v_mul_f32 v59, s55, v131
 v_mul_f32 v60, s55, v132
 v_mul_f32 v61, s55, v133
 v_mul_f32 v62, s55, v134
 v_mul_f32 v63, s55, v135
 v_exp_f32 v56, v56 clamp
 v_exp_f32 v57, v57 clamp
 v_exp_f32 v58, v58 clamp
 v_exp_f32 v59, v59 clamp
 v_exp_f32 v60, v60 clamp
 v_exp_f32 v61, v61 clamp
 v_exp_f32 v62, v62 clamp
 v_exp_f32 v63, v63 clamp
 v_max_f32 v128, s80, v128
 v_max_f32 v129, s80, v129
 v_max_f32 v130, s80, v130
 v_max_f32 v131, s80, v131
 v_max_f32 v132, s80, v132
 v_max_f32 v133, s80, v133
 v_max_f32 v134, s80, v134
 v_max_f32 v135, s80, v135
 v_add_f32 v128, v128, v56
 v_add_f32 v129, v129, v57
 v_add_f32 v130, v130, v58
 v_add_f32 v131, v131, v59
 v_add_f32 v132, v132, v60
 v_add_f32 v133, v133, v61
 v_add_f32 v134, v134, v62
 v_add_f32 v135, v135, v63
 CV 128, 128, 129
 CV 129, 130, 131
 CV 130, 132, 133
 CV 131, 134, 135
 ds_write_b128 v51, v[128:131] offset:4096
 v_accvgpr_read_b32 v152, a236
 v_accvgpr_read_b32 v153, a237
 v_accvgpr_read_b32 v154, a238
 v_accvgpr_read_b32 v155, a239
 v_mul_f32 v56, s55, v152
 v_mul_f32 v57, s55, v153
 v_mul_f32 v58, s55, v154
 v_mul_f32 v59, s55, v155
 v_mul_f32 v60, s55, v156
 v_mul_f32 v61, s55, v157
 v_mul_f32 v62, s55, v158
 v_mul_f32 v63, s55, v159
 v_exp_f32 v56, v56 clamp
 v_exp_f32 v57, v57 clamp
 v_exp_f32 v58, v58 clamp
 v_exp_f32 v59, v59 clamp
 v_exp_f32 v60, v60 clamp
 v_exp_f32 v61, v61 clamp
 v_exp_f32 v62, v62 clamp
 v_exp_f32 v63, v63 clamp
 v_max_f32 v152, s80, v152
 v_max_f32 v153, s80, v153
 v_max_f32 v154, s80, v154
 v_max_f32 v155, s80, v155
 v_max_f32 v156, s80, v156
 v_max_f32 v157, s80, v157
 v_max_f32 v158, s80, v158
 v_max_f32 v159, s80, v159
 v_add_f32 v152, v152, v56
 v_add_f32 v153, v153, v57
 v_add_f32 v154, v154, v58
 v_add_f32 v155, v155, v59
 v_add_f32 v156, v156, v60
 v_add_f32 v157, v157, v61
 v_add_f32 v158, v158, v62
 v_add_f32 v159, v159, v63
 CV 152, 152, 153
 CV 153, 154, 155
 CV 154, 156, 157
 CV 155, 158, 159
 ds_write_b128 v51, v[152:155] offset:6144
 v_accvgpr_read_b32 v176, a248
 v_accvgpr_read_b32 v177, a249
 v_accvgpr_read_b32 v178, a250
 v_accvgpr_read_b32 v179, a251
 v_mul_f32 v56, s55, v176
 v_mul_f32 v57, s55, v177
 v_mul_f32 v58, s55, v178
 v_mul_f32 v59, s55, v179
 v_mul_f32 v60, s55, v180
 v_mul_f32 v61, s55, v181
 v_mul_f32 v62, s55, v182
 v_mul_f32 v63, s55, v183
 v_exp_f32 v56, v56 clamp
 v_exp_f32 v57, v57 clamp
 v_exp_f32 v58, v58 clamp
 v_exp_f32 v59, v59 clamp
 v_exp_f32 v60, v60 clamp
 v_exp_f32 v61, v61 clamp
 v_exp_f32 v62, v62 clamp
 v_exp_f32 v63, v63 clamp
 v_max_f32 v176, s80, v176
 v_max_f32 v177, s80, v177
 v_max_f32 v178, s80, v178
 v_max_f32 v179, s80, v179
 v_max_f32 v180, s80, v180
 v_max_f32 v181, s80, v181
 v_max_f32 v182, s80, v182
 v_max_f32 v183, s80, v183
 v_add_f32 v176, v176, v56
 v_add_f32 v177, v177, v57
 v_add_f32 v178, v178, v58
 v_add_f32 v179, v179, v59
 v_add_f32 v180, v180, v60
 v_add_f32 v181, v181, v61
 v_add_f32 v182, v182, v62
 v_add_f32 v183, v183, v63
 CV 176, 176, 177
 CV 177, 178, 179
 CV 178, 180, 181
 CV 179, 182, 183
 ds_write_b128 v51, v[176:179] offset:7168
 v_accvgpr_read_b32 v200, a60
 v_accvgpr_read_b32 v201, a61
 v_accvgpr_read_b32 v202, a62
 v_accvgpr_read_b32 v203, a63
 v_mul_f32 v56, s55, v200
 v_mul_f32 v57, s55, v201
 v_mul_f32 v58, s55, v202
 v_mul_f32 v59, s55, v203
 v_mul_f32 v60, s55, v204
 v_mul_f32 v61, s55, v205
 v_mul_f32 v62, s55, v206
 v_mul_f32 v63, s55, v207
 v_exp_f32 v56, v56 clamp
 v_exp_f32 v57, v57 clamp
 v_exp_f32 v58, v58 clamp
 v_exp_f32 v59, v59 clamp
 v_exp_f32 v60, v60 clamp
 v_exp_f32 v61, v61 clamp
 v_exp_f32 v62, v62 clamp
 v_exp_f32 v63, v63 clamp
 v_max_f32 v200, s80, v200
 v_max_f32 v201, s80, v201
 v_max_f32 v202, s80, v202
 v_max_f32 v203, s80, v203
 v_max_f32 v204, s80, v204
 v_max_f32 v205, s80, v205
 v_max_f32 v206, s80, v206
 v_max_f32 v207, s80, v207
 v_add_f32 v200, v200, v56
 v_add_f32 v201, v201, v57
 v_add_f32 v202, v202, v58
 v_add_f32 v203, v203, v59
 v_add_f32 v204, v204, v60
 v_add_f32 v205, v205, v61
 v_add_f32 v206, v206, v62
 v_add_f32 v207, v207, v63
 CV 200, 200, 201
 CV 201, 202, 203
 CV 202, 204, 205
 CV 203, 206, 207
 ds_write_b128 v51, v[200:203] offset:5120
 v_accvgpr_read_b32 v224, a128
 v_accvgpr_read_b32 v225, a129
 v_accvgpr_read_b32 v226, a130
 v_accvgpr_read_b32 v227, a131
 v_mul_f32 v56, s55, v224
 v_mul_f32 v57, s55, v225
 v_mul_f32 v58, s55, v226
 v_mul_f32 v59, s55, v227
 v_mul_f32 v60, s55, v228
 v_mul_f32 v61, s55, v229
 v_mul_f32 v62, s55, v230
 v_mul_f32 v63, s55, v231
 v_exp_f32 v56, v56 clamp
 v_exp_f32 v57, v57 clamp
 v_exp_f32 v58, v58 clamp
 v_exp_f32 v59, v59 clamp
 v_exp_f32 v60, v60 clamp
 v_exp_f32 v61, v61 clamp
 v_exp_f32 v62, v62 clamp
 v_exp_f32 v63, v63 clamp
 v_max_f32 v224, s80, v224
 v_max_f32 v225, s80, v225
 v_max_f32 v226, s80, v226
 v_max_f32 v227, s80, v227
 v_max_f32 v228, s80, v228
 v_max_f32 v229, s80, v229
 v_max_f32 v230, s80, v230
 v_max_f32 v231, s80, v231
 v_add_f32 v224, v224, v56
 v_add_f32 v225, v225, v57
 v_add_f32 v226, v226, v58
 v_add_f32 v227, v227, v59
 v_add_f32 v228, v228, v60
 v_add_f32 v229, v229, v61
 v_add_f32 v230, v230, v62
 v_add_f32 v231, v231, v63
 CV 224, 224, 225
 CV 225, 226, 227
 CV 226, 228, 229
 CV 227, 230, 231
 ds_write_b128 v51, v[224:227] offset:3072
 v_accvgpr_read_b32 v248, a140
 v_accvgpr_read_b32 v249, a141
 v_accvgpr_read_b32 v250, a142
 v_accvgpr_read_b32 v251, a143
 v_mul_f32 v56, s55, v248
 v_mul_f32 v57, s55, v249
 v_mul_f32 v58, s55, v250
 v_mul_f32 v59, s55, v251
 v_mul_f32 v60, s55, v252
 v_mul_f32 v61, s55, v253
 v_mul_f32 v62, s55, v254
 v_mul_f32 v63, s55, v255
 v_exp_f32 v56, v56 clamp
 v_exp_f32 v57, v57 clamp
 v_exp_f32 v58, v58 clamp
 v_exp_f32 v59, v59 clamp
 v_exp_f32 v60, v60 clamp
 v_exp_f32 v61, v61 clamp
 v_exp_f32 v62, v62 clamp
 v_exp_f32 v63, v63 clamp
 v_max_f32 v248, s80, v248
 v_max_f32 v249, s80, v249
 v_max_f32 v250, s80, v250
 v_max_f32 v251, s80, v251
 v_max_f32 v252, s80, v252
 v_max_f32 v253, s80, v253
 v_max_f32 v254, s80, v254
 v_max_f32 v255, s80, v255
 v_add_f32 v248, v248, v56
 v_add_f32 v249, v249, v57
 v_add_f32 v250, v250, v58
 v_add_f32 v251, v251, v59
 v_add_f32 v252, v252, v60
 v_add_f32 v253, v253, v61
 v_add_f32 v254, v254, v62
 v_add_f32 v255, v255, v63
 CV 248, 248, 249
 CV 249, 250, 251
 CV 250, 252, 253
 CV 251, 254, 255
 ds_write_b128 v51, v[248:251] offset:1024
 s_branch P1_DONE
P1_B2:
 RT 32, 42, 0
 RT 34, 42, 1024
 RA 0, 10, 0
 RA 4, 10, 2048
 RA 8, 10, 4096
 RA 12, 10, 6144
 RA 16, 10, 8192
 RA 20, 10, 10240
 RA 24, 10, 12288
 RA 28, 10, 14336
 RT 36, 43, 0
 RT 38, 43, 1024
 RT 40, 44, 0
 RT 42, 44, 1024
 RT 44, 45, 0
 RT 46, 45, 1024
 s_waitcnt vmcnt(15) lgkmcnt(0)
 MVZ 196, 0, 32
 s_barrier
 MVZ 68, 4, 32
 RT 96, 42, 8192
 s_add_u32 m0, s42, 0
 MVZ 204, 8, 32
 DMA 24, 20, 78, 0
 MVZ 76, 12, 32
 RT 98, 42, 9216
 v_accvgpr_read_b32 v2, a152
 MVZ 212, 16, 32
 v_accvgpr_read_b32 v3, a153
 v_accvgpr_read_b32 v4, a154
 MVZ 84, 20, 32
 RA 64, 11, 0
 v_accvgpr_read_b32 v5, a155
 MVZ 220, 24, 32
 DMA 25, 20, 78, 1024
 v_accvgpr_read_b32 v6, a156
 MVZ 92, 28, 32
 RA 68, 11, 2048
 v_accvgpr_read_b32 v7, a157
 MVZ 124, 28, 36
 v_accvgpr_read_b32 v8, a158
 v_accvgpr_read_b32 v9, a159
 MVZ 252, 24, 36
 RA 72, 11, 4096
 CV 2, 2, 3
 MVZ 116, 20, 36
 DMA 26, 20, 78, 2048
 CV 3, 4, 5
 MVZ 244, 16, 36
 RA 76, 11, 6144
 CV 4, 6, 7
 MVZ 108, 12, 36
 CV 5, 8, 9
 buffer_store_dwordx4 v[2:5], v52, s[28:31], s50 offen offset:3072 sc1
 MVZ 236, 8, 36
 RA 80, 11, 8192
 MVZ 100, 4, 36
 DMA 27, 20, 78, 3072
 MVZ 228, 0, 36
 RA 84, 11, 10240
 MAZ 48, 0, 40
 MVZ 132, 4, 40
 RA 88, 11, 12288
 s_add_u32 s3, s42, 16384
 s_add_u32 m0, s3, s61
 MAZ 52, 8, 40
 DMAS 52, 28, 77, 0
 MVZ 140, 12, 40
 RA 92, 11, 14336
 MAZ 56, 16, 40
 MVZ 148, 20, 40
 RT 100, 43, 8192
 MAZ 60, 24, 40
 DMAS 52, 28, 77, 1024
 MVZ 156, 28, 40
 RT 102, 43, 9216
 v_accvgpr_read_b32 v56, a160
 MVZ 188, 28, 44
 v_accvgpr_read_b32 v57, a161
 v_accvgpr_read_b32 v58, a162
 MAZ 124, 24, 44
 RT 104, 44, 8192
 v_accvgpr_read_b32 v59, a163
 MVZ 180, 20, 44
 DMAS 52, 28, 77, 2048
 v_accvgpr_read_b32 v60, a164
 MAZ 120, 16, 44
 RT 106, 44, 9216
 v_accvgpr_read_b32 v61, a165
 MVZ 172, 12, 44
 v_accvgpr_read_b32 v62, a166
 v_accvgpr_read_b32 v63, a167
 MAZ 116, 8, 44
 RT 108, 45, 8192
 CV 56, 56, 57
 MVZ 164, 4, 44
 DMAS 52, 28, 77, 3072
 CV 57, 58, 59
 MAZ 112, 0, 44
 RT 110, 45, 9216
 CV 58, 60, 61
 MAZ 248, 192, 0
 CV 59, 62, 63
 s_add_u32 s50, s48, 37888
 MAZ 252, 192, 4
 buffer_store_dwordx4 v[56:59], v52, s[28:31], s50 offen offset:0 sc1
 MAZ 128, 192, 8
 s_add_u32 s78, s78, 262144
 s_mov_b32 s61, s60
 s_add_u32 s60, s60, 32768
 MAZ 132, 192, 12
 s_add_u32 s77, s77, 16384
 s_cmp_eq_u32 s60, 163840
 s_cselect_b32 s60, 65536, s60
 MAZ 136, 192, 16
 v_add_u32 v10, s60, v40
 v_add_u32 v11, s60, v41
 MAZ 140, 192, 20
 v_add_u32 v42, 32768, v42
 v_add_u32 v43, 32768, v43
 MAZ 144, 192, 24
 v_add_u32 v44, 32768, v44
 v_add_u32 v45, 32768, v45
 MAZ 148, 192, 28
 s_waitcnt vmcnt(14) lgkmcnt(0)
 MVA 196, 64, 96
 s_barrier
 MVA 68, 68, 96
 RT 32, 42, 0
 s_add_u32 m0, s42, 16384
 MVA 204, 72, 96
 DMA 24, 20, 78, 0
 MVA 76, 76, 96
 RT 34, 42, 1024
 v_accvgpr_read_b32 v2, a168
 MVA 212, 80, 96
 v_accvgpr_read_b32 v3, a169
 v_accvgpr_read_b32 v4, a170
 MVA 84, 84, 96
 RA 0, 10, 0
 v_accvgpr_read_b32 v5, a171
 MVA 220, 88, 96
 DMA 25, 20, 78, 1024
 v_accvgpr_read_b32 v6, a172
 MVA 92, 92, 96
 RA 4, 10, 2048
 v_accvgpr_read_b32 v7, a173
 MVA 124, 92, 100
 v_accvgpr_read_b32 v8, a174
 v_accvgpr_read_b32 v9, a175
 MVA 252, 88, 100
 RA 8, 10, 4096
 CV 2, 2, 3
 MVA 116, 84, 100
 DMA 26, 20, 78, 2048
 CV 3, 4, 5
 MVA 244, 80, 100
 RA 12, 10, 6144
 CV 4, 6, 7
 MVA 108, 76, 100
 CV 5, 8, 9
 buffer_store_dwordx4 v[2:5], v52, s[28:31], s50 offen offset:1024 sc1
 MVA 236, 72, 100
 RA 16, 10, 8192
 MVA 100, 68, 100
 DMA 27, 20, 78, 3072
 MVA 228, 64, 100
 RA 20, 10, 10240
 MAA 48, 64, 104
 MVA 132, 68, 104
 RA 24, 10, 12288
 s_add_u32 m0, s42, s61
 MAA 52, 72, 104
 DMA 28, 16, 76, 0
 MVA 140, 76, 104
 RA 28, 10, 14336
 MAA 56, 80, 104
 MVA 148, 84, 104
 RT 36, 43, 0
 MAA 60, 88, 104
 DMA 29, 16, 76, 1024
 MVA 156, 92, 104
 RT 38, 43, 1024
 v_accvgpr_read_b32 v56, a176
 MVA 188, 92, 108
 v_accvgpr_read_b32 v57, a177
 v_accvgpr_read_b32 v58, a178
 MAA 124, 88, 108
 RT 40, 44, 0
 v_accvgpr_read_b32 v59, a179
 MVA 180, 84, 108
 DMA 30, 16, 76, 2048
 v_accvgpr_read_b32 v60, a180
 MAA 120, 80, 108
 RT 42, 44, 1024
 v_accvgpr_read_b32 v61, a181
 MVA 172, 76, 108
 v_accvgpr_read_b32 v62, a182
 v_accvgpr_read_b32 v63, a183
 MAA 116, 72, 108
 RT 44, 45, 0
 CV 56, 56, 57
 MVA 164, 68, 108
 DMA 31, 16, 76, 3072
 CV 57, 58, 59
 MAA 112, 64, 108
 RT 46, 45, 1024
 CV 58, 60, 61
 MAA 248, 196, 64
 CV 59, 62, 63
 buffer_store_dwordx4 v[56:59], v52, s[28:31], s50 offen offset:2048 sc1
 MAA 252, 196, 68
 MAA 128, 196, 72
 s_add_u32 s78, s78, 262144
 MAA 132, 196, 76
 s_add_u32 s76, s76, 128
 MAA 136, 196, 80
 MAA 140, 196, 84
 MAA 144, 196, 88
 MAA 148, 196, 92
 s_waitcnt vmcnt(20) lgkmcnt(0)
 MVA 196, 0, 32
 s_barrier
 MVA 68, 4, 32
 RT 96, 42, 8192
 s_add_u32 m0, s42, 32768
 MVA 204, 8, 32
 DMA 24, 20, 78, 0
 MVA 76, 12, 32
 RT 98, 42, 9216
 v_accvgpr_read_b32 v2, a184
 MVA 212, 16, 32
 v_accvgpr_read_b32 v3, a185
 v_accvgpr_read_b32 v4, a186
 MVA 84, 20, 32
 RA 64, 11, 0
 v_accvgpr_read_b32 v5, a187
 MVA 220, 24, 32
 DMA 25, 20, 78, 1024
 v_accvgpr_read_b32 v6, a188
 MVA 92, 28, 32
 RA 68, 11, 2048
 v_accvgpr_read_b32 v7, a189
 MVA 124, 28, 36
 v_accvgpr_read_b32 v8, a190
 v_accvgpr_read_b32 v9, a191
 MVA 252, 24, 36
 RA 72, 11, 4096
 CV 2, 2, 3
 MVA 116, 20, 36
 DMA 26, 20, 78, 2048
 CV 3, 4, 5
 MVA 244, 16, 36
 RA 76, 11, 6144
 CV 4, 6, 7
 MVA 108, 12, 36
 CV 5, 8, 9
 buffer_store_dwordx4 v[2:5], v52, s[28:31], s50 offen offset:3072 sc1
 MVA 236, 8, 36
 RA 80, 11, 8192
 MVA 100, 4, 36
 DMA 27, 20, 78, 3072
 MVA 228, 0, 36
 RA 84, 11, 10240
 MAA 48, 0, 40
 s_add_u32 s50, s48, 0
 buffer_store_dwordx4 v[192:195], v52, s[28:31], s50 offen offset:0 sc1
 MVA 132, 4, 40
 RA 88, 11, 12288
 s_add_u32 s3, s42, 16384
 s_add_u32 m0, s3, s61
 MAA 52, 8, 40
 DMAS 52, 28, 77, 0
 MVA 140, 12, 40
 RA 92, 11, 14336
 MAA 56, 16, 40
 MVA 148, 20, 40
 RT 100, 43, 8192
 MAA 60, 24, 40
 DMAS 52, 28, 77, 1024
 MVA 156, 28, 40
 RT 102, 43, 9216
 MVA 188, 28, 44
 MAA 124, 24, 44
 RT 104, 44, 8192
 MVA 180, 20, 44
 DMAS 52, 28, 77, 2048
 MAA 120, 16, 44
 RT 106, 44, 9216
 MVA 172, 12, 44
 MAA 116, 8, 44
 RT 108, 45, 8192
 buffer_store_dwordx4 v[200:203], v52, s[28:31], s50 offen offset:1024 sc1
 MVA 164, 4, 44
 DMAS 52, 28, 77, 3072
 MAA 112, 0, 44
 RT 110, 45, 9216
 MAA 248, 200, 0
 MAA 252, 200, 4
 MAA 128, 200, 8
 s_add_u32 s78, s78, 262144
 s_mov_b32 s61, s60
 s_add_u32 s60, s60, 32768
 MAA 132, 200, 12
 s_add_u32 s77, s77, 16384
 s_cmp_eq_u32 s60, 163840
 s_cselect_b32 s60, 65536, s60
 MAA 136, 200, 16
 v_add_u32 v10, s60, v40
 v_add_u32 v11, s60, v41
 MAA 140, 200, 20
 v_add_u32 v42, 4294901760, v42
 v_add_u32 v43, 4294901760, v43
 MAA 144, 200, 24
 v_add_u32 v44, 4294901760, v44
 v_add_u32 v45, 4294901760, v45
 MAA 148, 200, 28
 s_waitcnt vmcnt(21) lgkmcnt(0)
 MVA 196, 64, 96
 s_barrier
 MVA 68, 68, 96
 RT 32, 42, 0
 s_add_u32 m0, s42, 49152
 MVA 204, 72, 96
 DMA 24, 20, 78, 0
 MVA 76, 76, 96
 RT 34, 42, 1024
 buffer_store_dwordx4 v[208:211], v52, s[28:31], s50 offen offset:2048 sc1
 MVA 212, 80, 96
 MVA 84, 84, 96
 RA 0, 10, 0
 MVA 220, 88, 96
 DMA 25, 20, 78, 1024
 MVA 92, 92, 96
 RA 4, 10, 2048
 MVA 124, 92, 100
 MVA 252, 88, 100
 RA 8, 10, 4096
 MVA 116, 84, 100
 DMA 26, 20, 78, 2048
 MVA 244, 80, 100
 RA 12, 10, 6144
 MVA 108, 76, 100
 MVA 236, 72, 100
 RA 16, 10, 8192
 MVA 100, 68, 100
 DMA 27, 20, 78, 3072
 MVA 228, 64, 100
 RA 20, 10, 10240
 MAA 48, 64, 104
 buffer_store_dwordx4 v[216:219], v52, s[28:31], s50 offen offset:3072 sc1
 MVA 132, 68, 104
 RA 24, 10, 12288
 s_add_u32 m0, s42, s61
 MAA 52, 72, 104
 DMA 28, 16, 76, 0
 MVA 140, 76, 104
 RA 28, 10, 14336
 MAA 56, 80, 104
 MVA 148, 84, 104
 RT 36, 43, 0
 MAA 60, 88, 104
 DMA 29, 16, 76, 1024
 MVA 156, 92, 104
 RT 38, 43, 1024
 MVA 188, 92, 108
 MAA 124, 88, 108
 RT 40, 44, 0
 MVA 180, 84, 108
 DMA 30, 16, 76, 2048
 MAA 120, 80, 108
 RT 42, 44, 1024
 MVA 172, 76, 108
 MAA 116, 72, 108
 RT 44, 45, 0
 s_add_u32 s50, s48, 4096
 MVA 164, 68, 108
 DMA 31, 16, 76, 3072
 buffer_store_dwordx4 v[224:227], v52, s[28:31], s50 offen offset:0 sc1
 MAA 112, 64, 108
 RT 46, 45, 1024
 MAA 248, 204, 64
 MAA 252, 204, 68
 MAA 128, 204, 72
 s_add_u32 s78, s78, 262144
 MAA 132, 204, 76
 s_add_u32 s76, s76, 128
 MAA 136, 204, 80
 MAA 140, 204, 84
 MAA 144, 204, 88
 MAA 148, 204, 92
 s_waitcnt vmcnt(22) lgkmcnt(0)
 MVA 196, 0, 32
 s_barrier
 MVA 68, 4, 32
 RT 96, 42, 8192
 s_add_u32 m0, s42, 0
 MVA 204, 8, 32
 DMA 24, 20, 78, 0
 MVA 76, 12, 32
 RT 98, 42, 9216
 buffer_store_dwordx4 v[232:235], v52, s[28:31], s50 offen offset:1024 sc1
 MVA 212, 16, 32
 MVA 84, 20, 32
 RA 64, 11, 0
 MVA 220, 24, 32
 DMA 25, 20, 78, 1024
 MVA 92, 28, 32
 RA 68, 11, 2048
 MVA 124, 28, 36
 MVA 252, 24, 36
 RA 72, 11, 4096
 MVA 116, 20, 36
 DMA 26, 20, 78, 2048
 MVA 244, 16, 36
 RA 76, 11, 6144
 MVA 108, 12, 36
 MVA 236, 8, 36
 RA 80, 11, 8192
 MVA 100, 4, 36
 DMA 27, 20, 78, 3072
 MVA 228, 0, 36
 RA 84, 11, 10240
 MAA 48, 0, 40
 buffer_store_dwordx4 v[240:243], v52, s[28:31], s50 offen offset:2048 sc1
 MVA 132, 4, 40
 RA 88, 11, 12288
 s_add_u32 s3, s42, 16384
 s_add_u32 m0, s3, s61
 MAA 52, 8, 40
 DMAS 52, 28, 77, 0
 MVA 140, 12, 40
 RA 92, 11, 14336
 MAA 56, 16, 40
 MVA 148, 20, 40
 RT 100, 43, 8192
 MAA 60, 24, 40
 DMAS 52, 28, 77, 1024
 MVA 156, 28, 40
 RT 102, 43, 9216
 MVA 188, 28, 44
 MAA 124, 24, 44
 RT 104, 44, 8192
 MVA 180, 20, 44
 DMAS 52, 28, 77, 2048
 MAA 120, 16, 44
 RT 106, 44, 9216
 MVA 172, 12, 44
 MAA 116, 8, 44
 RT 108, 45, 8192
 buffer_store_dwordx4 v[248:251], v52, s[28:31], s50 offen offset:3072 sc1
 MVA 164, 4, 44
 DMAS 52, 28, 77, 3072
 MAA 112, 0, 44
 RT 110, 45, 9216
 MAA 248, 208, 0
 MAA 252, 208, 4
 MAA 128, 208, 8
 s_add_u32 s78, s78, 262144
 s_mov_b32 s61, s60
 s_add_u32 s60, s60, 32768
 MAA 132, 208, 12
 s_add_u32 s77, s77, 16384
 s_cmp_eq_u32 s60, 163840
 s_cselect_b32 s60, 65536, s60
 MAA 136, 208, 16
 v_add_u32 v10, s60, v40
 v_add_u32 v11, s60, v41
 MAA 140, 208, 20
 v_add_u32 v42, 32768, v42
 v_add_u32 v43, 32768, v43
 MAA 144, 208, 24
 v_add_u32 v44, 32768, v44
 v_add_u32 v45, 32768, v45
 MAA 148, 208, 28
 s_waitcnt vmcnt(22) lgkmcnt(0)
 MVA 196, 64, 96
 s_barrier
 MVA 68, 68, 96
 RT 32, 42, 0
 s_add_u32 m0, s42, 16384
 MVA 204, 72, 96
 DMA 24, 20, 78, 0
 MVA 76, 76, 96
 RT 34, 42, 1024
 s_add_u32 s50, s74, 0
 MVA 212, 80, 96
 buffer_store_dwordx4 v[64:67], v52, s[28:31], s50 offen offset:0 sc1
 MVA 84, 84, 96
 RA 0, 10, 0
 MVA 220, 88, 96
 DMA 25, 20, 78, 1024
 MVA 92, 92, 96
 RA 4, 10, 2048
 MVA 124, 92, 100
 MVA 252, 88, 100
 RA 8, 10, 4096
 MVA 116, 84, 100
 DMA 26, 20, 78, 2048
 MVA 244, 80, 100
 RA 12, 10, 6144
 MVA 108, 76, 100
 MVA 236, 72, 100
 RA 16, 10, 8192
 MVA 100, 68, 100
 DMA 27, 20, 78, 3072
 MVA 228, 64, 100
 RA 20, 10, 10240
 MAA 48, 64, 104
 buffer_store_dwordx4 v[72:75], v52, s[28:31], s50 offen offset:1024 sc1
 MVA 132, 68, 104
 RA 24, 10, 12288
 s_add_u32 m0, s42, s61
 MAA 52, 72, 104
 DMA 28, 16, 76, 0
 MVA 140, 76, 104
 RA 28, 10, 14336
 MAA 56, 80, 104
 MVA 148, 84, 104
 RT 36, 43, 0
 MAA 60, 88, 104
 DMA 29, 16, 76, 1024
 MVA 156, 92, 104
 RT 38, 43, 1024
 MVA 188, 92, 108
 MAA 124, 88, 108
 RT 40, 44, 0
 MVA 180, 84, 108
 DMA 30, 16, 76, 2048
 MAA 120, 80, 108
 RT 42, 44, 1024
 MVA 172, 76, 108
 MAA 116, 72, 108
 RT 44, 45, 0
 buffer_store_dwordx4 v[80:83], v52, s[28:31], s50 offen offset:2048 sc1
 MVA 164, 68, 108
 DMA 31, 16, 76, 3072
 MAA 112, 64, 108
 RT 46, 45, 1024
 MAA 248, 212, 64
 MAA 252, 212, 68
 MAA 128, 212, 72
 s_add_u32 s78, s78, 262144
 MAA 132, 212, 76
 s_add_u32 s76, s76, 128
 MAA 136, 212, 80
 MAA 140, 212, 84
 MAA 144, 212, 88
 MAA 148, 212, 92
 s_waitcnt vmcnt(22) lgkmcnt(0)
 MVA 196, 0, 32
 s_barrier
 MVA 68, 4, 32
 RT 96, 42, 8192
 s_add_u32 m0, s42, 32768
 MVA 204, 8, 32
 DMA 24, 20, 78, 0
 MVA 76, 12, 32
 RT 98, 42, 9216
 buffer_store_dwordx4 v[88:91], v52, s[28:31], s50 offen offset:3072 sc1
 MVA 212, 16, 32
 MVA 84, 20, 32
 RA 64, 11, 0
 MVA 220, 24, 32
 DMA 25, 20, 78, 1024
 MVA 92, 28, 32
 RA 68, 11, 2048
 MVA 124, 28, 36
 MVA 252, 24, 36
 RA 72, 11, 4096
 MVA 116, 20, 36
 DMA 26, 20, 78, 2048
 MVA 244, 16, 36
 RA 76, 11, 6144
 MVA 108, 12, 36
 MVA 236, 8, 36
 RA 80, 11, 8192
 MVA 100, 4, 36
 DMA 27, 20, 78, 3072
 MVA 228, 0, 36
 RA 84, 11, 10240
 MAA 48, 0, 40
 s_add_u32 s50, s74, 4096
 buffer_store_dwordx4 v[96:99], v52, s[28:31], s50 offen offset:0 sc1
 MVA 132, 4, 40
 RA 88, 11, 12288
 s_add_u32 s3, s42, 16384
 s_add_u32 m0, s3, s61
 MAA 52, 8, 40
 DMAS 52, 28, 77, 0
 MVA 140, 12, 40
 RA 92, 11, 14336
 MAA 56, 16, 40
 MVA 148, 20, 40
 RT 100, 43, 8192
 MAA 60, 24, 40
 DMAS 52, 28, 77, 1024
 MVA 156, 28, 40
 RT 102, 43, 9216
 MVA 188, 28, 44
 MAA 124, 24, 44
 RT 104, 44, 8192
 MVA 180, 20, 44
 DMAS 52, 28, 77, 2048
 MAA 120, 16, 44
 RT 106, 44, 9216
 MVA 172, 12, 44
 MAA 116, 8, 44
 RT 108, 45, 8192
 buffer_store_dwordx4 v[104:107], v52, s[28:31], s50 offen offset:1024 sc1
 MVA 164, 4, 44
 DMAS 52, 28, 77, 3072
 MAA 112, 0, 44
 RT 110, 45, 9216
 MAA 248, 216, 0
 MAA 252, 216, 4
 MAA 128, 216, 8
 s_add_u32 s78, s78, 262144
 s_mov_b32 s61, s60
 s_add_u32 s60, s60, 32768
 MAA 132, 216, 12
 s_add_u32 s77, s77, 16384
 s_cmp_eq_u32 s60, 163840
 s_cselect_b32 s60, 65536, s60
 MAA 136, 216, 16
 v_add_u32 v10, s60, v40
 v_add_u32 v11, s60, v41
 MAA 140, 216, 20
 v_add_u32 v42, 32768, v42
 v_add_u32 v43, 32768, v43
 MAA 144, 216, 24
 v_add_u32 v44, 32768, v44
 v_add_u32 v45, 32768, v45
 MAA 148, 216, 28
 s_waitcnt vmcnt(22) lgkmcnt(0)
 MVA 196, 64, 96
 s_barrier
 MVA 68, 68, 96
 RT 32, 42, 0
 s_add_u32 m0, s42, 49152
 MVA 204, 72, 96
 DMA 24, 20, 78, 0
 MVA 76, 76, 96
 RT 34, 42, 1024
 buffer_store_dwordx4 v[112:115], v52, s[28:31], s50 offen offset:2048 sc1
 MVA 212, 80, 96
 MVA 84, 84, 96
 RA 0, 10, 0
 MVA 220, 88, 96
 DMA 25, 20, 78, 1024
 MVA 92, 92, 96
 RA 4, 10, 2048
 MVA 124, 92, 100
 MVA 252, 88, 100
 RA 8, 10, 4096
 MVA 116, 84, 100
 DMA 26, 20, 78, 2048
 MVA 244, 80, 100
 RA 12, 10, 6144
 MVA 108, 76, 100
 MVA 236, 72, 100
 RA 16, 10, 8192
 MVA 100, 68, 100
 DMA 27, 20, 78, 3072
 MVA 228, 64, 100
 RA 20, 10, 10240
 MAA 48, 64, 104
 buffer_store_dwordx4 v[120:123], v52, s[28:31], s50 offen offset:3072 sc1
 MVA 132, 68, 104
 RA 24, 10, 12288
 s_add_u32 m0, s42, s61
 MAA 52, 72, 104
 DMA 28, 16, 76, 0
 MVA 140, 76, 104
 RA 28, 10, 14336
 MAA 56, 80, 104
 MVA 148, 84, 104
 RT 36, 43, 0
 MAA 60, 88, 104
 DMA 29, 16, 76, 1024
 MVA 156, 92, 104
 RT 38, 43, 1024
 MVA 188, 92, 108
 MAA 124, 88, 108
 RT 40, 44, 0
 MVA 180, 84, 108
 DMA 30, 16, 76, 2048
 MAA 120, 80, 108
 RT 42, 44, 1024
 MVA 172, 76, 108
 MAA 116, 72, 108
 RT 44, 45, 0
 s_add_u32 s50, s81, 0
 MVA 164, 68, 108
 DMA 31, 16, 76, 3072
 buffer_store_dwordx4 v[128:131], v52, s[28:31], s50 offen offset:0 sc1
 MAA 112, 64, 108
 RT 46, 45, 1024
 MAA 248, 220, 64
 MAA 252, 220, 68
 MAA 128, 220, 72
 s_add_u32 s78, s78, 262144
 MAA 132, 220, 76
 s_add_u32 s76, s76, 128
 MAA 136, 220, 80
 MAA 140, 220, 84
 MAA 144, 220, 88
 MAA 148, 220, 92
 s_waitcnt vmcnt(22) lgkmcnt(0)
 MVA 196, 0, 32
 s_barrier
 MVA 68, 4, 32
 RT 96, 42, 8192
 s_add_u32 m0, s42, 0
 MVA 204, 8, 32
 DMA 24, 20, 78, 0
 MVA 76, 12, 32
 RT 98, 42, 9216
 buffer_store_dwordx4 v[136:139], v52, s[28:31], s50 offen offset:1024 sc1
 MVA 212, 16, 32
 MVA 84, 20, 32
 RA 64, 11, 0
 MVA 220, 24, 32
 DMA 25, 20, 78, 1024
 MVA 92, 28, 32
 RA 68, 11, 2048
 MVA 124, 28, 36
 MVA 252, 24, 36
 RA 72, 11, 4096
 MVA 116, 20, 36
 DMA 26, 20, 78, 2048
 MVA 244, 16, 36
 RA 76, 11, 6144
 MVA 108, 12, 36
 MVA 236, 8, 36
 RA 80, 11, 8192
 MVA 100, 4, 36
 DMA 27, 20, 78, 3072
 MVA 228, 0, 36
 RA 84, 11, 10240
 MAA 48, 0, 40
 buffer_store_dwordx4 v[144:147], v52, s[28:31], s50 offen offset:2048 sc1
 MVA 132, 4, 40
 RA 88, 11, 12288
 s_add_u32 s3, s42, 16384
 s_add_u32 m0, s3, s61
 MAA 52, 8, 40
 DMAS 52, 28, 77, 0
 MVA 140, 12, 40
 RA 92, 11, 14336
 MAA 56, 16, 40
 MVA 148, 20, 40
 RT 100, 43, 8192
 MAA 60, 24, 40
 DMAS 52, 28, 77, 1024
 MVA 156, 28, 40
 RT 102, 43, 9216
 MVA 188, 28, 44
 MAA 124, 24, 44
 RT 104, 44, 8192
 MVA 180, 20, 44
 DMAS 52, 28, 77, 2048
 MAA 120, 16, 44
 RT 106, 44, 9216
 MVA 172, 12, 44
 MAA 116, 8, 44
 RT 108, 45, 8192
 buffer_store_dwordx4 v[152:155], v52, s[28:31], s50 offen offset:3072 sc1
 MVA 164, 4, 44
 DMAS 52, 28, 77, 3072
 MAA 112, 0, 44
 RT 110, 45, 9216
 MAA 248, 224, 0
 MAA 252, 224, 4
 MAA 128, 224, 8
 s_add_u32 s78, s78, 262144
 s_mov_b32 s61, s60
 s_add_u32 s60, s60, 32768
 MAA 132, 224, 12
 s_add_u32 s77, s77, 16384
 s_cmp_eq_u32 s60, 163840
 s_cselect_b32 s60, 65536, s60
 MAA 136, 224, 16
 v_add_u32 v10, s60, v40
 v_add_u32 v11, s60, v41
 MAA 140, 224, 20
 v_add_u32 v42, 4294901760, v42
 v_add_u32 v43, 4294901760, v43
 MAA 144, 224, 24
 v_add_u32 v44, 4294901760, v44
 v_add_u32 v45, 4294901760, v45
 MAA 148, 224, 28
 s_waitcnt vmcnt(22) lgkmcnt(0)
 MVA 196, 64, 96
 s_barrier
 MVA 68, 68, 96
 RT 32, 42, 0
 s_add_u32 m0, s42, 16384
 MVA 204, 72, 96
 DMA 24, 20, 78, 0
 MVA 76, 76, 96
 RT 34, 42, 1024
 s_add_u32 s50, s81, 4096
 MVA 212, 80, 96
 buffer_store_dwordx4 v[160:163], v52, s[28:31], s50 offen offset:0 sc1
 MVA 84, 84, 96
 RA 0, 10, 0
 MVA 220, 88, 96
 DMA 25, 20, 78, 1024
 MVA 92, 92, 96
 RA 4, 10, 2048
 MVA 124, 92, 100
 MVA 252, 88, 100
 RA 8, 10, 4096
 MVA 116, 84, 100
 DMA 26, 20, 78, 2048
 MVA 244, 80, 100
 RA 12, 10, 6144
 MVA 108, 76, 100
 MVA 236, 72, 100
 RA 16, 10, 8192
 MVA 100, 68, 100
 DMA 27, 20, 78, 3072
 MVA 228, 64, 100
 RA 20, 10, 10240
 MAA 48, 64, 104
 MVA 132, 68, 104
 RA 24, 10, 12288
 MAA 52, 72, 104
 s_add_u32 s78, s78, 262144
 MVA 140, 76, 104
 RA 28, 10, 14336
 MAA 56, 80, 104
 MVA 148, 84, 104
 RT 36, 43, 0
 MAA 60, 88, 104
 MVA 156, 92, 104
 RT 38, 43, 1024
 buffer_store_dwordx4 v[168:171], v52, s[28:31], s50 offen offset:1024 sc1
 MVA 188, 92, 108
 MAA 124, 88, 108
 RT 40, 44, 0
 MVA 180, 84, 108
 MAA 120, 80, 108
 RT 42, 44, 1024
 MVA 172, 76, 108
 MAA 116, 72, 108
 RT 44, 45, 0
 MVA 164, 68, 108
 MAA 112, 64, 108
 RT 46, 45, 1024
 MAA 248, 228, 64
 MAA 252, 228, 68
 MAA 128, 228, 72
 MAA 132, 228, 76
 MAA 136, 228, 80
 MAA 140, 228, 84
 MAA 144, 228, 88
 MAA 148, 228, 92
 s_waitcnt vmcnt(17) lgkmcnt(0)
 MVA 196, 0, 32
 s_barrier
 v_readfirstlane_b32 s3, v37
 s_nop 0
 s_cmpk_lg_u32 s3, 256
 s_cbranch_scc1 P1_NEF
 buffer_store_dword v36, v39, s[28:31], s73 offen sc1
P1_NEF:
 MVA 68, 4, 32
 RT 96, 42, 8192
 MVA 204, 8, 32
 MVA 76, 12, 32
 RT 98, 42, 9216
 buffer_store_dwordx4 v[176:179], v52, s[28:31], s50 offen offset:2048 sc1
 MVA 212, 16, 32
 MVA 84, 20, 32
 RA 64, 11, 0
 MVA 220, 24, 32
 MVA 92, 28, 32
 RA 68, 11, 2048
 MVA 124, 28, 36
 MVA 252, 24, 36
 RA 72, 11, 4096
 MVA 116, 20, 36
 MVA 244, 16, 36
 RA 76, 11, 6144
 MVA 108, 12, 36
 MVA 236, 8, 36
 RA 80, 11, 8192
 MVA 100, 4, 36
 MVA 228, 0, 36
 RA 84, 11, 10240
 MAA 48, 0, 40
 MVA 132, 4, 40
 RA 88, 11, 12288
 MAA 52, 8, 40
 MVA 140, 12, 40
 RA 92, 11, 14336
 MAA 56, 16, 40
 MVA 148, 20, 40
 RT 100, 43, 8192
 MAA 60, 24, 40
 MVA 156, 28, 40
 RT 102, 43, 9216
 buffer_store_dwordx4 v[184:187], v52, s[28:31], s50 offen offset:3072 sc1
 MVA 188, 28, 44
 MAA 124, 24, 44
 RT 104, 44, 8192
 MVA 180, 20, 44
 MAA 120, 16, 44
 RT 106, 44, 9216
 MVA 172, 12, 44
 MAA 116, 8, 44
 RT 108, 45, 8192
 MVA 164, 4, 44
 MAA 112, 0, 44
 RT 110, 45, 9216
 MAA 248, 232, 0
 MAA 252, 232, 4
 MAA 128, 232, 8
 s_mov_b32 s61, s60
 s_add_u32 s60, s60, 32768
 MAA 132, 232, 12
 s_cmp_eq_u32 s60, 163840
 s_cselect_b32 s60, 65536, s60
 MAA 136, 232, 16
 v_add_u32 v10, s60, v40
 v_add_u32 v11, s60, v41
 MAA 140, 232, 20
 v_add_u32 v42, 32768, v42
 v_add_u32 v43, 32768, v43
 MAA 144, 232, 24
 v_add_u32 v44, 32768, v44
 v_add_u32 v45, 32768, v45
 MAA 148, 232, 28
 s_waitcnt vmcnt(8) lgkmcnt(0)
 MVA 196, 64, 96
 s_barrier
 MVA 68, 68, 96
 RT 32, 42, 0
 MVA 204, 72, 96
 MVA 76, 76, 96
 RT 34, 42, 1024
 MVA 212, 80, 96
 MVA 84, 84, 96
 RA 0, 10, 0
 MVA 220, 88, 96
 MVA 92, 92, 96
 RA 4, 10, 2048
 MVA 124, 92, 100
 MVA 252, 88, 100
 RA 8, 10, 4096
 MVA 116, 84, 100
 MVA 244, 80, 100
 RA 12, 10, 6144
 MVA 108, 76, 100
 MVA 236, 72, 100
 RA 16, 10, 8192
 MVA 100, 68, 100
 MVA 228, 64, 100
 RA 20, 10, 10240
 MAA 48, 64, 104
 MVA 132, 68, 104
 RA 24, 10, 12288
 MAA 52, 72, 104
 MVA 140, 76, 104
 RA 28, 10, 14336
 MAA 56, 80, 104
 MVA 148, 84, 104
 RT 36, 43, 0
 MAA 60, 88, 104
 MVA 156, 92, 104
 RT 38, 43, 1024
 MVA 188, 92, 108
 MAA 124, 88, 108
 RT 40, 44, 0
 MVA 180, 84, 108
 MAA 120, 80, 108
 RT 42, 44, 1024
 MVA 172, 76, 108
 MAA 116, 72, 108
 RT 44, 45, 0
 MVA 164, 68, 108
 MAA 112, 64, 108
 RT 46, 45, 1024
 MAA 248, 236, 64
 MAA 252, 236, 68
 MAA 128, 236, 72
 MAA 132, 236, 76
 MAA 136, 236, 80
 MAA 140, 236, 84
 MAA 144, 236, 88
 MAA 148, 236, 92
 s_waitcnt vmcnt(2) lgkmcnt(0)
 MVA 196, 0, 32
 s_barrier
 MVA 68, 4, 32
 RT 96, 42, 8192
 MVA 204, 8, 32
 MVA 76, 12, 32
 RT 98, 42, 9216
 MVA 212, 16, 32
 MVA 84, 20, 32
 RA 64, 11, 0
 MVA 220, 24, 32
 MVA 92, 28, 32
 RA 68, 11, 2048
 MVA 124, 28, 36
 MVA 252, 24, 36
 RA 72, 11, 4096
 MVA 116, 20, 36
 MVA 244, 16, 36
 RA 76, 11, 6144
 MVA 108, 12, 36
 MVA 236, 8, 36
 RA 80, 11, 8192
 MVA 100, 4, 36
 MVA 228, 0, 36
 RA 84, 11, 10240
 MAA 48, 0, 40
 MVA 132, 4, 40
 RA 88, 11, 12288
 MAA 52, 8, 40
 MVA 140, 12, 40
 RA 92, 11, 14336
 MAA 56, 16, 40
 MVA 148, 20, 40
 RT 100, 43, 8192
 MAA 60, 24, 40
 MVA 156, 28, 40
 RT 102, 43, 9216
 MVA 188, 28, 44
 MAA 124, 24, 44
 RT 104, 44, 8192
 MVA 180, 20, 44
 MAA 120, 16, 44
 RT 106, 44, 9216
 MVA 172, 12, 44
 MAA 116, 8, 44
 RT 108, 45, 8192
 MVA 164, 4, 44
 MAA 112, 0, 44
 RT 110, 45, 9216
 MAA 248, 240, 0
 MAA 252, 240, 4
 MAA 128, 240, 8
 MAA 132, 240, 12
 MAA 136, 240, 16
 MAA 140, 240, 20
 MAA 144, 240, 24
 MAA 148, 240, 28
 s_waitcnt lgkmcnt(0)
 buffer_load_dword v38, v55, s[28:31], s49 offen sc1
 MVA 196, 64, 96
 MVA 68, 68, 96
 MVA 204, 72, 96
 MVA 76, 76, 96
 MVA 212, 80, 96
 MVA 84, 84, 96
 MVA 220, 88, 96
 MVA 92, 92, 96
 MVA 124, 92, 100
 MVA 252, 88, 100
 MVA 116, 84, 100
 MVA 244, 80, 100
 MVA 108, 76, 100
 MVA 236, 72, 100
 MVA 100, 68, 100
 MVA 228, 64, 100
 MAA 48, 64, 104
 MVA 132, 68, 104
 MAA 52, 72, 104
 MVA 140, 76, 104
 MAA 56, 80, 104
 MVA 148, 84, 104
 MAA 60, 88, 104
 MVA 156, 92, 104
 MVA 188, 92, 108
 MAA 124, 88, 108
 MVA 180, 84, 108
 MAA 120, 80, 108
 MVA 172, 76, 108
 MAA 116, 72, 108
 MVA 164, 68, 108
 MAA 112, 64, 108
 MAA 248, 244, 64
 MAA 252, 244, 68
 MAA 128, 244, 72
 MAA 132, 244, 76
 MAA 136, 244, 80
 MAA 140, 244, 84
 MAA 144, 244, 88
 MAA 148, 244, 92
 s_mov_b32 s79, 1
P1_CHK2:
 s_waitcnt vmcnt(0)
 v_readfirstlane_b32 s3, v37
 v_cmp_eq_u32 vcc, 0, v38
 s_cmpk_eq_u32 s3, 256
 s_cbranch_scc1 P1_CHKOK2
 s_mov_b32 s79, 0
 s_sleep 4
 buffer_load_dword v37, v39, s[68:71], 0 offen sc1
 s_branch P1_CHK2
P1_CHKOK2:
 s_cmp_eq_u64 vcc, 0
 s_cselect_b32 s79, s79, 0
 s_barrier
 buffer_store_dword v36, v39, s[28:31], s73 offen sc1
 s_cmp_eq_u32 s79, 0
 s_cbranch_scc1 P1_KD200
 s_add_u32 m0, s42, 0
 s_add_u32 s3, s39, 0
 DMAS 52, 28, 3, 0
 DMAS 52, 28, 3, 1024
 DMAS 52, 28, 3, 2048
 DMAS 52, 28, 3, 3072
P1_KD200:
 v_accvgpr_read_b32 v2, a248
 v_accvgpr_read_b32 v4, a252
 v_accvgpr_read_b32 v6, a128
 v_accvgpr_read_b32 v8, a132
 v_accvgpr_read_b32 v9, a136
 v_accvgpr_read_b32 v7, a140
 v_accvgpr_read_b32 v5, a144
 v_accvgpr_read_b32 v3, a148
 v_mul_f32 v2, s55, v2
 v_mul_f32 v3, s55, v3
 v_mul_f32 v4, s55, v4
 v_mul_f32 v5, s55, v5
 v_mul_f32 v6, s55, v6
 v_mul_f32 v7, s55, v7
 v_mul_f32 v8, s55, v8
 v_mul_f32 v9, s55, v9
 v_exp_f32 v2, -v2
 v_exp_f32 v3, -v3
 v_exp_f32 v4, -v4
 v_exp_f32 v5, -v5
 v_exp_f32 v6, -v6
 v_exp_f32 v7, -v7
 v_exp_f32 v8, -v8
 v_exp_f32 v9, -v9
 v_add_f32 v2, 1.0, v2
 v_add_f32 v3, 1.0, v3
 v_add_f32 v4, 1.0, v4
 v_add_f32 v5, 1.0, v5
 v_add_f32 v6, 1.0, v6
 v_add_f32 v7, 1.0, v7
 v_add_f32 v8, 1.0, v8
 v_add_f32 v9, 1.0, v9
 v_rcp_f32 v2, v2
 v_rcp_f32 v3, v3
 v_rcp_f32 v4, v4
 v_rcp_f32 v5, v5
 v_rcp_f32 v6, v6
 v_rcp_f32 v7, v7
 v_rcp_f32 v8, v8
 v_rcp_f32 v9, v9
 ds_write_b128 v53, v[2:5]
 ds_write_b128 v53, v[6:9] offset:16
 s_cmp_eq_u32 s79, 0
 s_cbranch_scc1 P1_KD201
 s_add_u32 m0, s42, 16384
 s_add_u32 s3, s39, 33792
 DMAS 52, 28, 3, 0
 DMAS 52, 28, 3, 1024
 DMAS 52, 28, 3, 2048
 DMAS 52, 28, 3, 3072
P1_KD201:
 v_mov_b32 v64, v196
 v_mov_b32 v65, v197
 v_mov_b32 v66, v198
 v_mov_b32 v67, v199
 v_mov_b32 v72, v204
 v_mov_b32 v73, v205
 v_mov_b32 v74, v206
 v_mov_b32 v75, v207
 v_mov_b32 v80, v212
 v_mov_b32 v81, v213
 v_mov_b32 v82, v214
 v_mov_b32 v83, v215
 v_mov_b32 v88, v220
 v_mov_b32 v89, v221
 v_mov_b32 v90, v222
 v_mov_b32 v91, v223
 v_mov_b32 v96, v228
 v_mov_b32 v97, v229
 v_mov_b32 v98, v230
 v_mov_b32 v99, v231
 v_mov_b32 v104, v236
 v_mov_b32 v105, v237
 v_mov_b32 v106, v238
 v_mov_b32 v107, v239
 v_mov_b32 v112, v244
 v_mov_b32 v113, v245
 v_mov_b32 v114, v246
 v_mov_b32 v115, v247
 v_mov_b32 v120, v252
 v_mov_b32 v121, v253
 v_mov_b32 v122, v254
 v_mov_b32 v123, v255
 v_accvgpr_read_b32 v128, a48
 v_accvgpr_read_b32 v129, a49
 v_accvgpr_read_b32 v130, a50
 v_accvgpr_read_b32 v131, a51
 v_accvgpr_read_b32 v136, a52
 v_accvgpr_read_b32 v137, a53
 v_accvgpr_read_b32 v138, a54
 v_accvgpr_read_b32 v139, a55
 v_accvgpr_read_b32 v144, a56
 v_accvgpr_read_b32 v145, a57
 v_accvgpr_read_b32 v146, a58
 v_accvgpr_read_b32 v147, a59
 v_accvgpr_read_b32 v152, a60
 v_accvgpr_read_b32 v153, a61
 v_accvgpr_read_b32 v154, a62
 v_accvgpr_read_b32 v155, a63
 v_accvgpr_read_b32 v160, a112
 v_accvgpr_read_b32 v161, a113
 v_accvgpr_read_b32 v162, a114
 v_accvgpr_read_b32 v163, a115
 v_accvgpr_read_b32 v168, a116
 v_accvgpr_read_b32 v169, a117
 v_accvgpr_read_b32 v170, a118
 v_accvgpr_read_b32 v171, a119
 v_accvgpr_read_b32 v176, a120
 v_accvgpr_read_b32 v177, a121
 v_accvgpr_read_b32 v178, a122
 v_accvgpr_read_b32 v179, a123
 v_accvgpr_read_b32 v184, a124
 v_accvgpr_read_b32 v185, a125
 v_accvgpr_read_b32 v186, a126
 v_accvgpr_read_b32 v187, a127
 s_cmp_eq_u32 s79, 0
 s_cbranch_scc1 P1_KD210
 s_add_u32 m0, s42, 65536
 s_add_u32 s3, s39, 0
 DMAS 54, 28, 3, 0
 DMAS 54, 28, 3, 1024
 DMAS 54, 28, 3, 2048
 DMAS 54, 28, 3, 3072
P1_KD210:
 v_and_b32 v240, 15, v1
 v_cmp_lt_u32 vcc, 11, v240
 v_mov_b32 v241, 0x3f803f80
 CV 128, 128, 129
 CV 129, 130, 131
 CV 130, 132, 133
 CV 131, 134, 135
 CV 136, 136, 137
 CV 137, 138, 139
 CV 138, 140, 141
 CV 139, 142, 143
 CV 144, 144, 145
 CV 145, 146, 147
 CV 146, 148, 149
 CV 147, 150, 151
 CV 152, 152, 153
 CV 153, 154, 155
 CV 154, 156, 157
 CV 155, 158, 159
 CV 160, 160, 161
 CV 161, 162, 163
 CV 162, 164, 165
 CV 163, 166, 167
 v_cndmask_b32 v160, v160, v241, vcc
 v_cndmask_b32 v161, v161, v241, vcc
 v_cndmask_b32 v162, v162, v241, vcc
 v_cndmask_b32 v163, v163, v241, vcc
 CV 168, 168, 169
 CV 169, 170, 171
 CV 170, 172, 173
 CV 171, 174, 175
 v_cndmask_b32 v168, v168, v241, vcc
 v_cndmask_b32 v169, v169, v241, vcc
 v_cndmask_b32 v170, v170, v241, vcc
 v_cndmask_b32 v171, v171, v241, vcc
 CV 176, 176, 177
 CV 177, 178, 179
 CV 178, 180, 181
 CV 179, 182, 183
 v_cndmask_b32 v176, v176, v241, vcc
 v_cndmask_b32 v177, v177, v241, vcc
 v_cndmask_b32 v178, v178, v241, vcc
 v_cndmask_b32 v179, v179, v241, vcc
 CV 184, 184, 185
 CV 185, 186, 187
 CV 186, 188, 189
 CV 187, 190, 191
 v_cndmask_b32 v184, v184, v241, vcc
 v_cndmask_b32 v185, v185, v241, vcc
 v_cndmask_b32 v186, v186, v241, vcc
 v_cndmask_b32 v187, v187, v241, vcc
 s_cmp_eq_u32 s79, 0
 s_cbranch_scc1 P1_KD202
 s_add_u32 m0, s42, 32768
 s_add_u32 s3, s39, 67584
 DMAS 52, 28, 3, 0
 DMAS 52, 28, 3, 1024
 DMAS 52, 28, 3, 2048
 DMAS 52, 28, 3, 3072
P1_KD202:
 v_mul_f32 v56, s55, v64
 v_mul_f32 v57, s55, v65
 v_mul_f32 v58, s55, v66
 v_mul_f32 v59, s55, v67
 v_mul_f32 v60, s55, v68
 v_mul_f32 v61, s55, v69
 v_mul_f32 v62, s55, v70
 v_mul_f32 v63, s55, v71
 v_exp_f32 v56, v56 clamp
 v_exp_f32 v57, v57 clamp
 v_exp_f32 v58, v58 clamp
 v_exp_f32 v59, v59 clamp
 v_exp_f32 v60, v60 clamp
 v_exp_f32 v61, v61 clamp
 v_exp_f32 v62, v62 clamp
 v_exp_f32 v63, v63 clamp
 v_max_f32 v64, s80, v64
 v_max_f32 v65, s80, v65
 v_max_f32 v66, s80, v66
 v_max_f32 v67, s80, v67
 v_max_f32 v68, s80, v68
 v_max_f32 v69, s80, v69
 v_max_f32 v70, s80, v70
 v_max_f32 v71, s80, v71
 v_add_f32 v64, v64, v56
 v_add_f32 v65, v65, v57
 v_add_f32 v66, v66, v58
 v_add_f32 v67, v67, v59
 v_add_f32 v68, v68, v60
 v_add_f32 v69, v69, v61
 v_add_f32 v70, v70, v62
 v_add_f32 v71, v71, v63
 CV 64, 64, 65
 CV 65, 66, 67
 CV 66, 68, 69
 CV 67, 70, 71
 s_cmp_eq_u32 s79, 0
 s_cbranch_scc1 P1_KD211
 s_add_u32 m0, s42, 81920
 s_add_u32 s3, s39, 33792
 DMAS 54, 28, 3, 0
 DMAS 54, 28, 3, 1024
 DMAS 54, 28, 3, 2048
 DMAS 54, 28, 3, 3072
P1_KD211:
 v_mul_f32 v56, s55, v72
 v_mul_f32 v57, s55, v73
 v_mul_f32 v58, s55, v74
 v_mul_f32 v59, s55, v75
 v_mul_f32 v60, s55, v76
 v_mul_f32 v61, s55, v77
 v_mul_f32 v62, s55, v78
 v_mul_f32 v63, s55, v79
 v_exp_f32 v56, v56 clamp
 v_exp_f32 v57, v57 clamp
 v_exp_f32 v58, v58 clamp
 v_exp_f32 v59, v59 clamp
 v_exp_f32 v60, v60 clamp
 v_exp_f32 v61, v61 clamp
 v_exp_f32 v62, v62 clamp
 v_exp_f32 v63, v63 clamp
 v_max_f32 v72, s80, v72
 v_max_f32 v73, s80, v73
 v_max_f32 v74, s80, v74
 v_max_f32 v75, s80, v75
 v_max_f32 v76, s80, v76
 v_max_f32 v77, s80, v77
 v_max_f32 v78, s80, v78
 v_max_f32 v79, s80, v79
 v_add_f32 v72, v72, v56
 v_add_f32 v73, v73, v57
 v_add_f32 v74, v74, v58
 v_add_f32 v75, v75, v59
 v_add_f32 v76, v76, v60
 v_add_f32 v77, v77, v61
 v_add_f32 v78, v78, v62
 v_add_f32 v79, v79, v63
 CV 72, 72, 73
 CV 73, 74, 75
 CV 74, 76, 77
 CV 75, 78, 79
 v_mul_f32 v56, s55, v80
 v_mul_f32 v57, s55, v81
 v_mul_f32 v58, s55, v82
 v_mul_f32 v59, s55, v83
 v_mul_f32 v60, s55, v84
 v_mul_f32 v61, s55, v85
 v_mul_f32 v62, s55, v86
 v_mul_f32 v63, s55, v87
 v_exp_f32 v56, v56 clamp
 v_exp_f32 v57, v57 clamp
 v_exp_f32 v58, v58 clamp
 v_exp_f32 v59, v59 clamp
 v_exp_f32 v60, v60 clamp
 v_exp_f32 v61, v61 clamp
 v_exp_f32 v62, v62 clamp
 v_exp_f32 v63, v63 clamp
 v_max_f32 v80, s80, v80
 v_max_f32 v81, s80, v81
 v_max_f32 v82, s80, v82
 v_max_f32 v83, s80, v83
 v_max_f32 v84, s80, v84
 v_max_f32 v85, s80, v85
 v_max_f32 v86, s80, v86
 v_max_f32 v87, s80, v87
 v_add_f32 v80, v80, v56
 v_add_f32 v81, v81, v57
 v_add_f32 v82, v82, v58
 v_add_f32 v83, v83, v59
 v_add_f32 v84, v84, v60
 v_add_f32 v85, v85, v61
 v_add_f32 v86, v86, v62
 v_add_f32 v87, v87, v63
 CV 80, 80, 81
 CV 81, 82, 83
 CV 82, 84, 85
 CV 83, 86, 87
 v_mul_f32 v56, s55, v88
 v_mul_f32 v57, s55, v89
 v_mul_f32 v58, s55, v90
 v_mul_f32 v59, s55, v91
 v_mul_f32 v60, s55, v92
 v_mul_f32 v61, s55, v93
 v_mul_f32 v62, s55, v94
 v_mul_f32 v63, s55, v95
 v_exp_f32 v56, v56 clamp
 v_exp_f32 v57, v57 clamp
 v_exp_f32 v58, v58 clamp
 v_exp_f32 v59, v59 clamp
 v_exp_f32 v60, v60 clamp
 v_exp_f32 v61, v61 clamp
 v_exp_f32 v62, v62 clamp
 v_exp_f32 v63, v63 clamp
 v_max_f32 v88, s80, v88
 v_max_f32 v89, s80, v89
 v_max_f32 v90, s80, v90
 v_max_f32 v91, s80, v91
 v_max_f32 v92, s80, v92
 v_max_f32 v93, s80, v93
 v_max_f32 v94, s80, v94
 v_max_f32 v95, s80, v95
 v_add_f32 v88, v88, v56
 v_add_f32 v89, v89, v57
 v_add_f32 v90, v90, v58
 v_add_f32 v91, v91, v59
 v_add_f32 v92, v92, v60
 v_add_f32 v93, v93, v61
 v_add_f32 v94, v94, v62
 v_add_f32 v95, v95, v63
 CV 88, 88, 89
 CV 89, 90, 91
 CV 90, 92, 93
 CV 91, 94, 95
 v_mul_f32 v56, s55, v96
 v_mul_f32 v57, s55, v97
 v_mul_f32 v58, s55, v98
 v_mul_f32 v59, s55, v99
 v_mul_f32 v60, s55, v100
 v_mul_f32 v61, s55, v101
 v_mul_f32 v62, s55, v102
 v_mul_f32 v63, s55, v103
 v_exp_f32 v56, v56 clamp
 v_exp_f32 v57, v57 clamp
 v_exp_f32 v58, v58 clamp
 v_exp_f32 v59, v59 clamp
 v_exp_f32 v60, v60 clamp
 v_exp_f32 v61, v61 clamp
 v_exp_f32 v62, v62 clamp
 v_exp_f32 v63, v63 clamp
 v_max_f32 v96, s80, v96
 v_max_f32 v97, s80, v97
 v_max_f32 v98, s80, v98
 v_max_f32 v99, s80, v99
 v_max_f32 v100, s80, v100
 v_max_f32 v101, s80, v101
 v_max_f32 v102, s80, v102
 v_max_f32 v103, s80, v103
 v_add_f32 v96, v96, v56
 v_add_f32 v97, v97, v57
 v_add_f32 v98, v98, v58
 v_add_f32 v99, v99, v59
 v_add_f32 v100, v100, v60
 v_add_f32 v101, v101, v61
 v_add_f32 v102, v102, v62
 v_add_f32 v103, v103, v63
 CV 96, 96, 97
 CV 97, 98, 99
 CV 98, 100, 101
 CV 99, 102, 103
 v_mul_f32 v56, s55, v104
 v_mul_f32 v57, s55, v105
 v_mul_f32 v58, s55, v106
 v_mul_f32 v59, s55, v107
 v_mul_f32 v60, s55, v108
 v_mul_f32 v61, s55, v109
 v_mul_f32 v62, s55, v110
 v_mul_f32 v63, s55, v111
 v_exp_f32 v56, v56 clamp
 v_exp_f32 v57, v57 clamp
 v_exp_f32 v58, v58 clamp
 v_exp_f32 v59, v59 clamp
 v_exp_f32 v60, v60 clamp
 v_exp_f32 v61, v61 clamp
 v_exp_f32 v62, v62 clamp
 v_exp_f32 v63, v63 clamp
 v_max_f32 v104, s80, v104
 v_max_f32 v105, s80, v105
 v_max_f32 v106, s80, v106
 v_max_f32 v107, s80, v107
 v_max_f32 v108, s80, v108
 v_max_f32 v109, s80, v109
 v_max_f32 v110, s80, v110
 v_max_f32 v111, s80, v111
 v_add_f32 v104, v104, v56
 v_add_f32 v105, v105, v57
 v_add_f32 v106, v106, v58
 v_add_f32 v107, v107, v59
 v_add_f32 v108, v108, v60
 v_add_f32 v109, v109, v61
 v_add_f32 v110, v110, v62
 v_add_f32 v111, v111, v63
 CV 104, 104, 105
 CV 105, 106, 107
 CV 106, 108, 109
 CV 107, 110, 111
 v_mul_f32 v56, s55, v112
 v_mul_f32 v57, s55, v113
 v_mul_f32 v58, s55, v114
 v_mul_f32 v59, s55, v115
 v_mul_f32 v60, s55, v116
 v_mul_f32 v61, s55, v117
 v_mul_f32 v62, s55, v118
 v_mul_f32 v63, s55, v119
 v_exp_f32 v56, v56 clamp
 v_exp_f32 v57, v57 clamp
 v_exp_f32 v58, v58 clamp
 v_exp_f32 v59, v59 clamp
 v_exp_f32 v60, v60 clamp
 v_exp_f32 v61, v61 clamp
 v_exp_f32 v62, v62 clamp
 v_exp_f32 v63, v63 clamp
 v_max_f32 v112, s80, v112
 v_max_f32 v113, s80, v113
 v_max_f32 v114, s80, v114
 v_max_f32 v115, s80, v115
 v_max_f32 v116, s80, v116
 v_max_f32 v117, s80, v117
 v_max_f32 v118, s80, v118
 v_max_f32 v119, s80, v119
 v_add_f32 v112, v112, v56
 v_add_f32 v113, v113, v57
 v_add_f32 v114, v114, v58
 v_add_f32 v115, v115, v59
 v_add_f32 v116, v116, v60
 v_add_f32 v117, v117, v61
 v_add_f32 v118, v118, v62
 v_add_f32 v119, v119, v63
 CV 112, 112, 113
 CV 113, 114, 115
 CV 114, 116, 117
 CV 115, 118, 119
 v_mul_f32 v56, s55, v120
 v_mul_f32 v57, s55, v121
 v_mul_f32 v58, s55, v122
 v_mul_f32 v59, s55, v123
 v_mul_f32 v60, s55, v124
 v_mul_f32 v61, s55, v125
 v_mul_f32 v62, s55, v126
 v_mul_f32 v63, s55, v127
 v_exp_f32 v56, v56 clamp
 v_exp_f32 v57, v57 clamp
 v_exp_f32 v58, v58 clamp
 v_exp_f32 v59, v59 clamp
 v_exp_f32 v60, v60 clamp
 v_exp_f32 v61, v61 clamp
 v_exp_f32 v62, v62 clamp
 v_exp_f32 v63, v63 clamp
 v_max_f32 v120, s80, v120
 v_max_f32 v121, s80, v121
 v_max_f32 v122, s80, v122
 v_max_f32 v123, s80, v123
 v_max_f32 v124, s80, v124
 v_max_f32 v125, s80, v125
 v_max_f32 v126, s80, v126
 v_max_f32 v127, s80, v127
 v_add_f32 v120, v120, v56
 v_add_f32 v121, v121, v57
 v_add_f32 v122, v122, v58
 v_add_f32 v123, v123, v59
 v_add_f32 v124, v124, v60
 v_add_f32 v125, v125, v61
 v_add_f32 v126, v126, v62
 v_add_f32 v127, v127, v63
 CV 120, 120, 121
 CV 121, 122, 123
 CV 122, 124, 125
 CV 123, 126, 127
 s_nop 1
 v_mfma_f32_16x16x32_bf16 v[208:211], v[64:67], v[128:131], 0
 v_mfma_f32_16x16x32_bf16 v[212:215], v[64:67], v[160:163], 0
 v_mfma_f32_16x16x32_bf16 v[216:219], v[96:99], v[128:131], 0
 v_mfma_f32_16x16x32_bf16 v[220:223], v[96:99], v[160:163], 0
 v_mfma_f32_16x16x32_bf16 v[208:211], v[72:75], v[136:139], v[208:211]
 v_mfma_f32_16x16x32_bf16 v[212:215], v[72:75], v[168:171], v[212:215]
 v_mfma_f32_16x16x32_bf16 v[216:219], v[104:107], v[136:139], v[216:219]
 v_mfma_f32_16x16x32_bf16 v[220:223], v[104:107], v[168:171], v[220:223]
 v_mfma_f32_16x16x32_bf16 v[208:211], v[80:83], v[144:147], v[208:211]
 v_mfma_f32_16x16x32_bf16 v[212:215], v[80:83], v[176:179], v[212:215]
 v_mfma_f32_16x16x32_bf16 v[216:219], v[112:115], v[144:147], v[216:219]
 v_mfma_f32_16x16x32_bf16 v[220:223], v[112:115], v[176:179], v[220:223]
 v_mfma_f32_16x16x32_bf16 v[208:211], v[88:91], v[152:155], v[208:211]
 v_mfma_f32_16x16x32_bf16 v[212:215], v[88:91], v[184:187], v[212:215]
 v_mfma_f32_16x16x32_bf16 v[216:219], v[120:123], v[152:155], v[216:219]
 v_mfma_f32_16x16x32_bf16 v[220:223], v[120:123], v[184:187], v[220:223]
 s_nop 7
 buffer_store_dwordx4 v[208:211], v52, s[28:31], s72 offen offset:0 sc1
 buffer_store_dwordx4 v[212:215], v52, s[28:31], s72 offen offset:1024 sc1
 buffer_store_dwordx4 v[216:219], v52, s[28:31], s72 offen offset:2048 sc1
 buffer_store_dwordx4 v[220:223], v52, s[28:31], s72 offen offset:3072 sc1
P1_DONE:
 s_load_dwordx2 s[60:61], s[0:1], 96
 s_load_dwordx2 s[62:63], s[0:1], 40
 s_load_dwordx2 s[64:65], s[0:1], 64
 s_load_dwordx2 s[66:67], s[0:1], 80
 v_lshrrev_b32 v2, 6, v0
 v_and_b32 v1, 63, v0
 v_readfirstlane_b32 s4, v2
 s_and_b32 s3, s2, 7
 s_lshr_b32 s24, s2, 3
 s_and_b32 s25, s24, 1
 s_lshl_b32 s5, s3, 1
 s_add_u32 s5, s5, s25
 s_lshr_b32 s6, s24, 1
 s_and_b32 s7, s6, 7
 s_lshl_b32 s28, s5, 3
 s_add_u32 s28, s28, s7
 s_lshl_b32 s21, s4, 12
 s_mul_i32 s22, s5, 2163712
 s_add_u32 s22, s22, s21
 v_lshlrev_b32 v39, 4, v1
 v_add_u32 v38, 0x4000, v39
 s_mov_b32 s10, 268435456
 s_mov_b32 s11, 0x20000
 s_mov_b32 s27, 0
 s_lshl_b32 s24, s7, 2
 s_add_u32 s42, s24, 4
 s_sub_u32 s25, 30, s24
 s_max_i32 s25, s25, 6
 s_min_i32 s25, s25, 28
 s_cmp_eq_u32 s7, 7
 s_cselect_b32 s25, 0, s25
 s_mov_b32 s17, 0x70000000
 s_mov_b32 s29, 4
 s_mov_b32 s15, s22
 s_mov_b32 s16, 4
 s_mov_b32 s41, 1
 s_mov_b32 s43, 0
 s_cmp_ge_u32 s6, 8
 s_cbranch_scc1 P2_CONS
 s_cmp_eq_u32 s7, 7
 s_cbranch_scc1 P2_PROD7
 s_mov_b32 s12, 0
 s_sub_u32 s13, 15, s7
 s_mov_b32 s14, s25
 s_mov_b32 s17, s22
 s_mov_b32 s29, 2
 s_branch P2_ROLEDONE
P2_PROD7:
 s_mov_b32 s12, 1
 s_mov_b32 s13, s7
 s_mov_b32 s14, s42
 s_branch P2_ROLEDONE
P2_CONS:
 s_mul_i32 s3, s25, 33792
 s_add_u32 s15, s15, s3
 s_cmp_eq_u32 s7, 7
 s_cselect_b32 s12, 1, 2
 s_sub_u32 s14, 64, s24
 s_sub_u32 s14, s14, s25
 s_sub_u32 s13, 15, s7
 s_cmp_eq_u32 s7, 7
 s_cbranch_scc1 P2_ROLEDONE
 s_mov_b32 s17, s15
 s_sub_u32 s3, 60, s24
 s_mul_i32 s3, s3, 33792
 s_add_u32 s43, s22, s3
 s_add_u32 s15, s22, 1013760
 s_add_u32 s16, s24, s14
 s_sub_u32 s16, s16, 26
 s_mov_b32 s41, 8
P2_ROLEDONE:
 s_mul_i32 s40, s5, 1115136
 s_mul_i32 s3, s13, 69632
 s_add_u32 s40, s40, s3
 s_mul_i32 s3, s4, 17408
 s_add_u32 s40, s40, s3
 s_add_u32 s40, s40, 35651584
 s_waitcnt lgkmcnt(0)
 s_mov_b32 s8, s60
 s_mov_b32 s9, s61
 s_mov_b32 s44, s62
 s_mov_b32 s45, s63
 s_mov_b32 s46, 3670016
 s_mov_b32 s47, 0x20000
 s_mov_b32 s48, s64
 s_mov_b32 s49, s65
 s_mov_b32 s50, 401408
 s_mov_b32 s51, 0x20000
 v_and_b32 v2, 15, v1
 v_lshrrev_b32 v3, 4, v1
 v_lshlrev_b32 v42, 7, v2
 v_lshlrev_b32 v7, 2, v3
 v_sub_u32 v43, v2, v7
 v_mov_b32 v45, 0xff800000
 s_mov_b32 s23, 0x4e800000
 s_add_u32 s18, s21, 0
 v_mov_b32 v46, v39
 s_mov_b32 s19, 131072
 v_lshrrev_b32 v4, 5, v1
 v_bfe_u32 v5, v1, 3, 2
 v_and_b32 v6, 7, v1
 v_and_b32 v7, 2, v5
 v_xor_b32 v6, v6, v7
 v_xor_b32 v7, 4, v6
 v_lshlrev_b32 v6, 4, v6
 v_lshlrev_b32 v7, 4, v7
 v_lshl_add_u32 v4, v4, 4, v5
 v_mul_u32_u24 v4, 896, v4
 v_add_u32 v16, v4, v6
 v_add_u32 v17, v4, v7
 v_add_u32 v17, 2560, v17
 v_add_u32 v18, v4, v6
 v_add_u32 v18, 5120, v18
 v_add_u32 v19, v4, v7
 v_add_u32 v19, 7680, v19
 v_bfe_u32 v4, v1, 2, 2
 v_and_b32 v5, 3, v1
 v_and_b32 v6, 1, v3
 v_lshlrev_b32 v6, 2, v6
 v_and_b32 v7, 2, v4
 v_or_b32 v6, v6, v7
 v_lshrrev_b32 v7, 1, v5
 v_xor_b32 v6, v6, v7
 v_lshl_add_u32 v7, v3, 3, v4
 v_lshlrev_b32 v7, 7, v7
 v_and_b32 v5, 1, v5
 v_lshl_add_u32 v7, v5, 3, v7
 v_xor_b32 v5, 0, v6
 v_lshl_add_u32 v20, v5, 4, v7
 v_xor_b32 v5, 2, v6
 v_lshl_add_u32 v21, v5, 4, v7
 v_xor_b32 v5, 4, v6
 v_lshl_add_u32 v22, v5, 4, v7
 v_xor_b32 v5, 6, v6
 v_lshl_add_u32 v23, v5, 4, v7
 v_and_b32 v8, 31, v1
 v_lshlrev_b32 v8, 7, v8
 s_and_b32 s26, s2, 7
 s_lshl_b32 s26, s26, 12
 s_add_u32 s26, s26, 78839808
 v_mov_b32 v13, v8
 s_add_u32 s78, s26, 32768
 s_mov_b32 s75, 0x12000000
 s_mov_b32 s76, 0
 s_add_u32 s53, s74, 4096
 s_add_u32 s54, s81, 4096
 s_cmp_lg_u32 s79, 0
 s_cbranch_scc1 P2_ISSUED
P2_PL0:
 buffer_load_dword v9, v8, s[8:11], s26 offen sc1
 s_waitcnt vmcnt(0)
 v_cmp_eq_u32 vcc, 0, v9
 s_nop 1
 s_cbranch_vccz P2_PK0
 s_sleep 1
 s_branch P2_PL0
P2_PK0:
 s_add_u32 s3, s15, 0
 s_add_u32 m0, s21, 0
 s_nop 0
 DMAS 39, 8, 3, 0
 DMAS 39, 8, 3, 1024
 DMAS 39, 8, 3, 2048
 DMAS 39, 8, 3, 3072
 s_add_u32 s3, s15, 33792
 s_add_u32 m0, s21, 16384
 s_nop 0
 DMAS 39, 8, 3, 0
 DMAS 39, 8, 3, 1024
 DMAS 39, 8, 3, 2048
 DMAS 39, 8, 3, 3072
 s_add_u32 s3, s15, 0
 s_add_u32 m0, s21, 65536
 s_nop 0
 DMAS 38, 8, 3, 0
 DMAS 38, 8, 3, 1024
 DMAS 38, 8, 3, 2048
 DMAS 38, 8, 3, 3072
 s_add_u32 s3, s15, 67584
 s_add_u32 m0, s21, 32768
 s_nop 0
 DMAS 39, 8, 3, 0
 DMAS 39, 8, 3, 1024
 DMAS 39, 8, 3, 2048
 DMAS 39, 8, 3, 3072
 s_add_u32 s3, s15, 33792
 s_add_u32 m0, s21, 81920
 s_nop 0
 DMAS 38, 8, 3, 0
 DMAS 38, 8, 3, 1024
 DMAS 38, 8, 3, 2048
 DMAS 38, 8, 3, 3072
P2_ISSUED:
 s_add_u32 s15, s15, 101376
 s_lshl_b32 s3, s4, 14
 s_add_u32 s3, s3, 98304
 v_add_u32 v4, s3, v39
 s_lshl_b32 s3, s4, 11
 s_add_u32 s3, s3, 49152
 v_add_u32 v5, s3, v39
 s_lshl_b32 s3, s4, 3
 s_add_u32 s3, s3, 57344
 v_lshlrev_b32 v6, 5, v2
 v_add_u32 v6, s3, v6
 s_lshr_b32 s3, s2, 3
 s_lshl_b32 s3, s3, 7
 s_add_u32 s25, s26, s3
 s_add_u32 s25, s25, 32768
 v_mov_b32 v8, 0
 s_waitcnt vmcnt(0) lgkmcnt(0)
 s_barrier
 s_cmp_lg_u32 s4, 0
 s_cbranch_scc1 P2_NOFB
 buffer_store_dword v45, v8, s[8:11], s25 offen sc1
P2_NOFB:
 RA 48, 5, 0
 RA 52, 5, 1024
 ds_read_b64 v[40:41], v6
 s_cmp_eq_u32 s12, 0
 s_cbranch_scc1 P2_QPARK
 RA 192, 4, 0
 RA 196, 4, 1024
 RA 200, 4, 2048
 RA 204, 4, 3072
 RA 208, 4, 4096
 RA 212, 4, 5120
 RA 216, 4, 6144
 RA 220, 4, 7168
 RA 224, 4, 8192
 RA 228, 4, 9216
 RA 232, 4, 10240
 RA 236, 4, 11264
 RA 240, 4, 12288
 RA 244, 4, 13312
 RA 248, 4, 14336
 RA 252, 4, 15360
 s_branch P2_QRD
P2_QPARK:
 RA 128, 4, 0
 RA 132, 4, 1024
 RA 136, 4, 2048
 RA 140, 4, 3072
 RA 144, 4, 4096
 RA 148, 4, 5120
 RA 152, 4, 6144
 RA 156, 4, 7168
 RA 160, 4, 8192
 RA 164, 4, 9216
 RA 168, 4, 10240
 RA 172, 4, 11264
 RA 176, 4, 12288
 RA 180, 4, 13312
 RA 184, 4, 14336
 RA 188, 4, 15360
P2_QRD:
 s_waitcnt lgkmcnt(0)
 s_barrier
 s_cmp_ge_u32 s6, 8
 s_cbranch_scc1 P2_NOB
 s_add_u32 s3, s15, 0
 s_add_u32 m0, s21, 49152
 s_nop 0
 DMAS 39, 8, 3, 0
 DMAS 39, 8, 3, 1024
 DMAS 39, 8, 3, 2048
 DMAS 39, 8, 3, 3072
 s_add_u32 s3, s15, 4294933504
 s_add_u32 m0, s21, 98304
 s_nop 0
 DMAS 38, 8, 3, 0
 DMAS 38, 8, 3, 1024
 DMAS 38, 8, 3, 2048
 DMAS 38, 8, 3, 3072
 s_add_u32 s3, s15, 0
 s_add_u32 m0, s21, 114688
 s_nop 0
 DMAS 38, 8, 3, 0
 DMAS 38, 8, 3, 1024
 DMAS 38, 8, 3, 2048
 DMAS 38, 8, 3, 3072
 s_cmp_eq_u32 s6, 7
 s_cbranch_scc1 P2_R7
 s_add_u32 s25, s25, 2048
P2_PL1:
 buffer_load_dword v9, v8, s[8:11], s25 offen sc1
 s_waitcnt vmcnt(0)
 v_cmp_eq_u32 vcc, 0, v9
 s_nop 1
 s_cbranch_vccz P2_PK1
 s_sleep 1
 s_branch P2_PL1
P2_PK1:
 buffer_load_dwordx4 a[192:195], v39, s[8:11], s40 offen offset:0 sc1
 buffer_load_dwordx4 a[196:199], v39, s[8:11], s40 offen offset:1024 sc1
 buffer_load_dwordx4 a[200:203], v39, s[8:11], s40 offen offset:2048 sc1
 buffer_load_dwordx4 a[204:207], v39, s[8:11], s40 offen offset:3072 sc1
 s_add_u32 s40, s40, 4096
 buffer_load_dwordx4 a[208:211], v39, s[8:11], s40 offen offset:0 sc1
 buffer_load_dwordx4 a[212:215], v39, s[8:11], s40 offen offset:1024 sc1
 buffer_load_dwordx4 a[216:219], v39, s[8:11], s40 offen offset:2048 sc1
 buffer_load_dwordx4 a[220:223], v39, s[8:11], s40 offen offset:3072 sc1
 s_add_u32 s40, s40, 4096
 buffer_load_dwordx4 a[224:227], v39, s[8:11], s40 offen offset:0 sc1
 buffer_load_dwordx4 a[228:231], v39, s[8:11], s40 offen offset:1024 sc1
 buffer_load_dwordx4 a[232:235], v39, s[8:11], s40 offen offset:2048 sc1
 buffer_load_dwordx4 a[236:239], v39, s[8:11], s40 offen offset:3072 sc1
 s_add_u32 s40, s40, 4096
 buffer_load_dwordx4 a[240:243], v39, s[8:11], s40 offen offset:0 sc1
 buffer_load_dwordx4 a[244:247], v39, s[8:11], s40 offen offset:1024 sc1
 buffer_load_dwordx4 a[248:251], v39, s[8:11], s40 offen offset:2048 sc1
 buffer_load_dwordx4 a[252:255], v39, s[8:11], s40 offen offset:3072 sc1
 s_lshl_b32 s3, s6, 2
 s_add_u32 s3, s3, s4
 s_mul_i32 s24, s3, 64
 s_mul_i32 s25, s5, 1792
 s_add_u32 s24, s24, s25
 v_min_u32 v4, 63, v1
 v_add_u32 v4, s24, v4
 v_lshlrev_b32 v4, 7, v4
 buffer_load_dword v5, v4, s[44:47], 0 offen
 s_mul_i32 s24, s3, 7
 s_mul_i32 s25, s5, 196
 s_add_u32 s24, s24, s25
 v_min_u32 v4, 6, v1
 v_add_u32 v4, s24, v4
 v_lshlrev_b32 v4, 7, v4
 buffer_load_dword v5, v4, s[48:51], 0 offen
 s_waitcnt vmcnt(2)
 s_branch P2_NOB
P2_R7:
 v_lshlrev_b32 v8, 8, v2
 s_and_b32 s3, s5, 1
 s_lshl_b32 s3, s3, 7
 s_add_u32 s26, s26, s3
 s_add_u32 s26, s26, 32768
P2_PL2:
 buffer_load_dword v9, v8, s[8:11], s26 offen sc1
 s_waitcnt vmcnt(0)
 v_cmp_eq_u32 vcc, 0, v9
 s_nop 1
 s_cbranch_vccz P2_PK2
 s_sleep 1
 s_branch P2_PL2
P2_PK2:
 s_lshl_b32 s24, s5, 16
 s_lshl_b32 s3, s4, 14
 s_add_u32 s24, s24, s3
 s_add_u32 s24, s24, 77594624
 buffer_load_dwordx4 v[128:131], v39, s[8:11], s24 offen offset:0 sc1
 buffer_load_dwordx4 v[132:135], v39, s[8:11], s24 offen offset:1024 sc1
 buffer_load_dwordx4 v[136:139], v39, s[8:11], s24 offen offset:2048 sc1
 buffer_load_dwordx4 v[140:143], v39, s[8:11], s24 offen offset:3072 sc1
 s_add_u32 s24, s24, 4096
 buffer_load_dwordx4 v[144:147], v39, s[8:11], s24 offen offset:0 sc1
 buffer_load_dwordx4 v[148:151], v39, s[8:11], s24 offen offset:1024 sc1
 buffer_load_dwordx4 v[152:155], v39, s[8:11], s24 offen offset:2048 sc1
 buffer_load_dwordx4 v[156:159], v39, s[8:11], s24 offen offset:3072 sc1
 s_add_u32 s24, s24, 4096
 buffer_load_dwordx4 v[160:163], v39, s[8:11], s24 offen offset:0 sc1
 buffer_load_dwordx4 v[164:167], v39, s[8:11], s24 offen offset:1024 sc1
 buffer_load_dwordx4 v[168:171], v39, s[8:11], s24 offen offset:2048 sc1
 buffer_load_dwordx4 v[172:175], v39, s[8:11], s24 offen offset:3072 sc1
 s_add_u32 s24, s24, 4096
 buffer_load_dwordx4 v[176:179], v39, s[8:11], s24 offen offset:0 sc1
 buffer_load_dwordx4 v[180:183], v39, s[8:11], s24 offen offset:1024 sc1
 buffer_load_dwordx4 v[184:187], v39, s[8:11], s24 offen offset:2048 sc1
 buffer_load_dwordx4 v[188:191], v39, s[8:11], s24 offen offset:3072 sc1
 v_add_u32 v8, s21, v39
 v_add_u32 v8, 147456, v8
 v_add_u32 v9, 147456, v39
 s_waitcnt vmcnt(0)
 v_add_f32 v128, v128, v144
 v_add_f32 v160, v160, v176
 v_add_f32 v129, v129, v145
 v_add_f32 v161, v161, v177
 v_add_f32 v130, v130, v146
 v_add_f32 v162, v162, v178
 v_add_f32 v131, v131, v147
 v_add_f32 v163, v163, v179
 v_add_f32 v132, v132, v148
 v_add_f32 v164, v164, v180
 v_add_f32 v133, v133, v149
 v_add_f32 v165, v165, v181
 v_add_f32 v134, v134, v150
 v_add_f32 v166, v166, v182
 v_add_f32 v135, v135, v151
 v_add_f32 v167, v167, v183
 v_add_f32 v136, v136, v152
 v_add_f32 v168, v168, v184
 v_add_f32 v137, v137, v153
 v_add_f32 v169, v169, v185
 v_add_f32 v138, v138, v154
 v_add_f32 v170, v170, v186
 v_add_f32 v139, v139, v155
 v_add_f32 v171, v171, v187
 v_add_f32 v140, v140, v156
 v_add_f32 v172, v172, v188
 v_add_f32 v141, v141, v157
 v_add_f32 v173, v173, v189
 v_add_f32 v142, v142, v158
 v_add_f32 v174, v174, v190
 v_add_f32 v143, v143, v159
 v_add_f32 v175, v175, v191
 v_add_f32 v128, v128, v160
 v_add_f32 v129, v129, v161
 v_add_f32 v130, v130, v162
 v_add_f32 v131, v131, v163
 v_add_f32 v132, v132, v164
 v_add_f32 v133, v133, v165
 v_add_f32 v134, v134, v166
 v_add_f32 v135, v135, v167
 v_add_f32 v136, v136, v168
 v_add_f32 v137, v137, v169
 v_add_f32 v138, v138, v170
 v_add_f32 v139, v139, v171
 v_add_f32 v140, v140, v172
 v_add_f32 v141, v141, v173
 v_add_f32 v142, v142, v174
 v_add_f32 v143, v143, v175
 ds_write_b128 v8, v[128:131] offset:0
 ds_write_b128 v8, v[132:135] offset:1024
 ds_write_b128 v8, v[136:139] offset:2048
 ds_write_b128 v8, v[140:143] offset:3072
 s_waitcnt lgkmcnt(0)
 s_barrier
 ds_read_b128 v[128:131], v9 offset:0
 ds_read_b128 v[132:135], v9 offset:1024
 ds_read_b128 v[136:139], v9 offset:2048
 ds_read_b128 v[140:143], v9 offset:3072
 ds_read_b128 v[144:147], v9 offset:4096
 ds_read_b128 v[148:151], v9 offset:5120
 ds_read_b128 v[152:155], v9 offset:6144
 ds_read_b128 v[156:159], v9 offset:7168
 ds_read_b128 v[160:163], v9 offset:8192
 ds_read_b128 v[164:167], v9 offset:9216
 ds_read_b128 v[168:171], v9 offset:10240
 ds_read_b128 v[172:175], v9 offset:11264
 ds_read_b128 v[176:179], v9 offset:12288
 ds_read_b128 v[180:183], v9 offset:13312
 ds_read_b128 v[184:187], v9 offset:14336
 ds_read_b128 v[188:191], v9 offset:15360
 v_cmp_eq_u32 vcc, 3, v3
 s_waitcnt lgkmcnt(0)
 v_add_f32 v128, v128, v144
 v_add_f32 v160, v160, v176
 v_add_f32 v129, v129, v145
 v_add_f32 v161, v161, v177
 v_add_f32 v130, v130, v146
 v_add_f32 v162, v162, v178
 v_add_f32 v131, v131, v147
 v_add_f32 v163, v163, v179
 v_add_f32 v132, v132, v148
 v_add_f32 v164, v164, v180
 v_add_f32 v133, v133, v149
 v_add_f32 v165, v165, v181
 v_add_f32 v134, v134, v150
 v_add_f32 v166, v166, v182
 v_add_f32 v135, v135, v151
 v_add_f32 v167, v167, v183
 v_add_f32 v136, v136, v152
 v_add_f32 v168, v168, v184
 v_add_f32 v137, v137, v153
 v_add_f32 v169, v169, v185
 v_add_f32 v138, v138, v154
 v_add_f32 v170, v170, v186
 v_add_f32 v139, v139, v155
 v_add_f32 v171, v171, v187
 v_add_f32 v140, v140, v156
 v_add_f32 v172, v172, v188
 v_add_f32 v141, v141, v157
 v_add_f32 v173, v173, v189
 v_add_f32 v142, v142, v158
 v_add_f32 v174, v174, v190
 v_add_f32 v143, v143, v159
 v_add_f32 v175, v175, v191
 v_add_f32 v128, v128, v160
 v_add_f32 v129, v129, v161
 v_add_f32 v130, v130, v162
 v_add_f32 v131, v131, v163
 v_add_f32 v132, v132, v164
 v_add_f32 v133, v133, v165
 v_add_f32 v134, v134, v166
 v_add_f32 v135, v135, v167
 v_add_f32 v136, v136, v168
 v_add_f32 v137, v137, v169
 v_add_f32 v138, v138, v170
 v_add_f32 v139, v139, v171
 v_add_f32 v140, v140, v172
 v_add_f32 v141, v141, v173
 v_add_f32 v142, v142, v174
 v_add_f32 v143, v143, v175
 v_cndmask_b32 v136, v136, 0, vcc
 v_cndmask_b32 v137, v137, 0, vcc
 v_cndmask_b32 v138, v138, 0, vcc
 v_cndmask_b32 v139, v139, 0, vcc
 v_cndmask_b32 v140, v140, 0, vcc
 v_cndmask_b32 v141, v141, 0, vcc
 v_cndmask_b32 v142, v142, 0, vcc
 v_cndmask_b32 v143, v143, 0, vcc
 CV 100, 128, 129
 CV 101, 130, 131
 CV 102, 136, 137
 CV 103, 138, 139
 CV 104, 132, 133
 CV 105, 134, 135
 CV 106, 140, 141
 CV 107, 142, 143
 v_lshlrev_b32 v4, 6, v3
 v_add_u32 v4, 48, v4
 ds_bpermute_b32 v108, v4, v104
 ds_bpermute_b32 v109, v4, v105
 ds_bpermute_b32 v110, v4, v106
 ds_bpermute_b32 v111, v4, v107
 v_cmp_lt_u32 vcc, 11, v2
 s_waitcnt lgkmcnt(0)
 s_nop 0
 v_cndmask_b32 v104, v104, 0, vcc
 v_cndmask_b32 v105, v105, 0, vcc
 v_cndmask_b32 v106, v106, 0, vcc
 v_cndmask_b32 v107, v107, 0, vcc
 s_cmp_lg_u32 s4, 0
 s_cbranch_scc1 P2_NOB
 s_mul_i32 s24, s5, 3072
 s_add_u32 s24, s24, 79462400
 buffer_store_dwordx4 v[100:103], v39, s[8:11], s24 offen offset:0 sc1
 buffer_store_dwordx4 v[104:107], v39, s[8:11], s24 offen offset:1024 sc1
 buffer_store_dwordx4 v[108:111], v39, s[8:11], s24 offen offset:2048 sc1
 s_lshl_b32 s27, s5, 7
 s_add_u32 s27, s27, 78790656
P2_NOB:
 s_lshl_b32 s3, s4, 4
 s_and_b32 s3, s3, 16
 v_add_u32 v44, s3, v43
 s_sub_u32 s3, 16, s3
 v_add_u32 v104, s3, v43
 RA 96, 46, 0
 RA 100, 46, 2048
 RA 104, 46, 4096
 RA 108, 46, 6144
 RA 112, 46, 8192
 RA 116, 46, 10240
 RA 120, 46, 12288
 RA 124, 46, 14336
 s_cmp_lt_u32 s6, 8
 s_cbranch_scc1 P2_SEG
 s_waitcnt lgkmcnt(4)
 MVZ 64, 96, 192
 s_add_u32 s3, s15, 0
 s_add_u32 m0, s21, 49152
 MQ 64, 100, 200, 64
 MVZ 72, 96, 196
 DMAS 39, 8, 3, 0
 MQ 72, 100, 204, 72
 RA 96, 46, 1024
 MQ 72, 104, 212, 72
 DMAS 39, 8, 3, 1024
 MQ 72, 108, 220, 72
 RA 100, 46, 3072
 MQ 64, 104, 208, 64
 DMAS 39, 8, 3, 2048
 MQ 64, 108, 216, 64
 RA 104, 46, 5120
 s_waitcnt lgkmcnt(3)
 MQ 64, 112, 224, 64
 DMAS 39, 8, 3, 3072
 MQ 64, 116, 232, 64
 RA 108, 46, 7168
 MQ 72, 112, 228, 72
 s_add_u32 s3, s15, 4294933504
 s_add_u32 m0, s21, 98304
 MQ 72, 116, 236, 72
 RA 112, 46, 9216
 MQ 72, 120, 244, 72
 DMAS 38, 8, 3, 0
 MQ 72, 124, 252, 72
 RA 116, 46, 11264
 MQ 64, 120, 240, 64
 DMAS 38, 8, 3, 1024
 MQ 64, 124, 248, 64
 RA 120, 46, 13312
 s_waitcnt lgkmcnt(3)
 MVZ 68, 96, 192
 MQ 68, 100, 200, 68
 RA 124, 46, 15360
 DMAS 38, 8, 3, 2048
 MVZ 76, 96, 196
 MQ 76, 100, 204, 76
 DMAS 38, 8, 3, 3072
 MQ 76, 104, 212, 76
 MQ 76, 108, 220, 76
 s_add_u32 s3, s15, 0
 s_add_u32 m0, s21, 114688
 MQ 68, 104, 208, 68
 MQ 68, 108, 216, 68
 s_waitcnt lgkmcnt(0)
 DMAS 38, 8, 3, 0
 MQ 68, 112, 224, 68
 MQ 68, 116, 232, 68
 DMAS 38, 8, 3, 1024
 MQ 76, 112, 228, 76
 MQ 76, 116, 236, 76
 DMAS 38, 8, 3, 2048
 MQ 76, 120, 244, 76
 MQ 76, 124, 252, 76
 DMAS 38, 8, 3, 3072
 MQ 68, 120, 240, 68
 MQ 68, 124, 248, 68
P2_F0:
 s_waitcnt vmcnt(20)
 s_barrier
 s_add_u32 s75, s75, s75
 s_cbranch_scc1 P2_DS0
P2_DB0:
 RA 96, 46, 16384
 RA 100, 46, 18432
 RA 104, 46, 20480
 RA 108, 46, 22528
 RA 112, 46, 24576
 RA 116, 46, 26624
 RA 120, 46, 28672
 RA 124, 46, 30720
 s_add_u32 s15, s15, 33792
 s_cmp_eq_u32 s14, s16
 s_cselect_b32 s15, s17, s15
 s_cmp_eq_u32 s14, s41
 s_cselect_b32 s15, s43, s15
 s_mov_b32 m0, s18
 v_max3_f32 v36, v64, v65, v65
 v_max3_f32 v37, v72, v73, v73
 v_max3_f32 v36, v36, v66, v67
 v_max3_f32 v37, v37, v74, v75
 v_max3_f32 v36, v36, v68, v69
 v_max3_f32 v37, v37, v76, v77
 v_max3_f32 v36, v36, v70, v71
 DMAS 39, 8, 15, 0
 v_max3_f32 v37, v37, v78, v79
 v_mov_b32 v6, v36
 v_mov_b32 v7, v37
 s_nop 1
 v_permlane32_swap_b32 v6, v36
 v_permlane32_swap_b32 v7, v37
 s_nop 1
 s_add_u32 s20, s19, s21
 v_max_f32 v36, v36, v6
 v_max_f32 v37, v37, v7
 v_mov_b32 v6, v36
 v_mov_b32 v7, v37
 s_nop 1
 v_permlane16_swap_b32 v6, v36
 v_permlane16_swap_b32 v7, v37
 s_add_u32 s19, s19, 32768
 s_nop 1
 v_max_f32 v36, v36, v6
 v_max_f32 v37, v37, v7
 v_sub_f32 v96, 0, v36
 v_sub_f32 v97, 0, v36
 v_sub_f32 v98, 0, v36
 v_sub_f32 v99, 0, v36
 DMAS 39, 8, 15, 1024
 v_sub_f32 v100, 0, v37
 v_sub_f32 v101, 0, v37
 v_sub_f32 v102, 0, v37
 v_sub_f32 v103, 0, v37
 v_sub_f32 v64, v64, v36
 v_sub_f32 v65, v65, v36
 v_sub_f32 v66, v66, v36
 s_cmp_eq_u32 s19, 163840
 s_cselect_b32 s19, 65536, s19
 v_sub_f32 v67, v67, v36
 v_sub_f32 v68, v68, v36
 v_sub_f32 v69, v69, v36
 v_sub_f32 v70, v70, v36
 v_sub_f32 v71, v71, v36
 v_sub_f32 v72, v72, v37
 v_sub_f32 v73, v73, v37
 DMAS 39, 8, 15, 2048
 v_sub_f32 v74, v74, v37
 v_sub_f32 v75, v75, v37
 v_sub_f32 v76, v76, v37
 v_sub_f32 v77, v77, v37
 v_sub_f32 v78, v78, v37
 v_sub_f32 v79, v79, v37
 v_mov_b32 v34, 0
 v_mov_b32 v35, 0
 s_waitcnt lgkmcnt(4)
 MQ 80, 96, 192, 96
 v_exp_f32 v48, v64
 v_exp_f32 v49, v65
 MQ 80, 100, 200, 80
 v_add_f32 v32, v34, v48
 MQ 88, 96, 196, 100
 DMAS 39, 8, 15, 3072
 v_exp_f32 v50, v66
 v_add_f32 v32, v32, v49
 MQ 88, 100, 204, 88
 RA 96, 46, 17408
 CV 112, 48, 49
 MQ 88, 104, 212, 88
 v_exp_f32 v51, v67
 MQ 88, 108, 220, 88
 RA 100, 46, 19456
 v_add_f32 v32, v32, v50
 v_exp_f32 v52, v68
 MQ 80, 104, 208, 80
 s_mov_b32 m0, s20
 v_add_f32 v32, v32, v51
 MQ 80, 108, 216, 80
 RA 104, 46, 21504
 s_waitcnt lgkmcnt(3)
 CV 113, 50, 51
 MQ 80, 112, 224, 80
 v_exp_f32 v53, v69
 v_add_f32 v32, v32, v52
 MQ 80, 116, 232, 80
 RA 108, 46, 23552
 v_exp_f32 v54, v70
 MQ 88, 112, 228, 88
 v_add_f32 v32, v32, v53
 MQ 88, 116, 236, 88
 RA 112, 46, 25600
 CV 114, 52, 53
 v_exp_f32 v55, v71
 MQ 88, 120, 244, 88
 v_add_f32 v32, v32, v54
 MQ 88, 124, 252, 88
 RA 116, 46, 27648
 v_exp_f32 v56, v72
 MQ 80, 120, 240, 80
 v_add_f32 v32, v32, v55
 CV 115, 54, 55
 MQ 80, 124, 248, 80
 RA 120, 46, 29696
 s_waitcnt lgkmcnt(3)
 v_exp_f32 v57, v73
 MQ 84, 96, 192, 96
 DMAS 38, 8, 15, 0
 v_add_u32 v47, s19, v39
 v_add_f32 v33, v35, v56
 v_exp_f32 v58, v74
 MQ 84, 100, 200, 84
 RA 124, 46, 31744
 v_add_f32 v33, v33, v57
 MQ 92, 96, 196, 100
 CV 116, 56, 57
 MQ 92, 100, 204, 92
 RA 96, 47, 0
 v_exp_f32 v59, v75
 v_add_f32 v33, v33, v58
 MQ 92, 104, 212, 92
 DMAS 38, 8, 15, 1024
 v_exp_f32 v60, v76
 MQ 92, 108, 220, 92
 RA 100, 47, 1024
 v_add_f32 v33, v33, v59
 MQ 84, 104, 208, 84
 CV 117, 58, 59
 v_exp_f32 v61, v77
 MQ 84, 108, 216, 84
 RA 104, 47, 2048
 s_waitcnt lgkmcnt(3)
 v_add_f32 v33, v33, v60
 MQ 84, 112, 224, 84
 DMAS 38, 8, 15, 2048
 v_exp_f32 v62, v78
 MQ 84, 116, 232, 84
 RA 108, 47, 3072
 v_add_f32 v33, v33, v61
 CV 118, 60, 61
 MQ 92, 112, 228, 92
 v_exp_f32 v63, v79
 MQ 92, 116, 236, 92
 RA 112, 47, 4096
 v_add_f32 v33, v33, v62
 MQ 92, 120, 244, 92
 DMAS 38, 8, 15, 3072
 v_add_f32 v33, v33, v63
 CV 119, 62, 63
 MQ 92, 124, 252, 92
 RA 116, 47, 5120
 v_max_f32 v2, v32, v33
 MQ 84, 120, 240, 84
 v_cmp_lt_f32 vcc, s23, v2
 MQ 84, 124, 248, 84
 RA 120, 47, 6144
 RA 124, 47, 7168
 s_cbranch_vccnz P2_RS0
P2_RB0:
P2_L1Z:
 s_waitcnt vmcnt(20) lgkmcnt(4)
 MPZ 128, 96, 112
 s_barrier
 s_add_u32 s15, s15, 33792
 MPZ 192, 96, 116
 RA 96, 47, 8192
 v_xor_b32 v46, 0x8000, v46
 MPZ 196, 100, 116
 MPZ 132, 100, 112
 RA 100, 47, 9216
 s_add_u32 m0, s18, 16384
 MPZ 136, 104, 112
 MPZ 200, 104, 116
 RA 104, 47, 10240
 s_xor_b32 s18, s18, 32768
 MPZ 204, 108, 116
 v_exp_f32 v48, v80
 MPZ 140, 108, 112
 RA 108, 47, 11264
 s_waitcnt lgkmcnt(4)
 MPZ 144, 112, 112
 v_exp_f32 v49, v81
 MPZ 208, 112, 116
 RA 112, 47, 12288
 v_add_f32 v34, v32, v48
 MPZ 212, 116, 116
 DMAS 39, 8, 15, 0
 MPZ 148, 116, 112
 RA 116, 47, 13312
 v_add_f32 v34, v34, v49
 MPZ 152, 120, 112
 v_exp_f32 v50, v82
 MPZ 216, 120, 116
 RA 120, 47, 14336
 CV 120, 48, 49
 MPZ 220, 124, 116
 v_exp_f32 v51, v83
 MPZ 156, 124, 112
 RA 124, 47, 15360
 s_waitcnt lgkmcnt(4)
 MPZ 160, 96, 112
 v_exp_f32 v52, v84
 MPZ 224, 96, 116
 RA 96, 46, 0
 v_add_f32 v34, v34, v50
 MPZ 228, 100, 116
 DMAS 39, 8, 15, 1024
 MPZ 164, 100, 112
 RA 100, 46, 2048
 v_add_f32 v34, v34, v51
 MPZ 168, 104, 112
 v_exp_f32 v53, v85
 MPZ 232, 104, 116
 RA 104, 46, 4096
 CV 121, 50, 51
 MPZ 236, 108, 116
 v_exp_f32 v54, v86
 MPZ 172, 108, 112
 RA 108, 46, 6144
 s_waitcnt lgkmcnt(4)
 MPZ 176, 112, 112
 v_add_f32 v34, v34, v52
 v_add_f32 v34, v34, v53
 MPZ 240, 112, 116
 RA 112, 46, 8192
 CV 122, 52, 53
 MPZ 244, 116, 116
 DMAS 39, 8, 15, 2048
 MPZ 180, 116, 112
 RA 116, 46, 10240
 v_add_f32 v34, v34, v54
 MPZ 184, 120, 112
 v_exp_f32 v55, v87
 MPZ 248, 120, 116
 RA 120, 46, 12288
 v_add_f32 v34, v34, v55
 MPZ 252, 124, 116
 v_exp_f32 v56, v88
 MPZ 188, 124, 112
 RA 124, 46, 14336
 s_waitcnt lgkmcnt(4)
 MQ 64, 96, 192, 96
 v_exp_f32 v57, v89
 MQ 64, 100, 200, 64
 CV 123, 54, 55
 v_add_f32 v35, v33, v56
 MQ 72, 96, 196, 100
 DMAS 39, 8, 15, 3072
 MQ 72, 100, 204, 72
 RA 96, 46, 1024
 s_add_u32 m0, s20, 16384
 MQ 72, 104, 212, 72
 v_exp_f32 v58, v90
 MQ 72, 108, 220, 72
 RA 100, 46, 3072
 s_sub_u32 s14, s14, 2
 MQ 64, 104, 208, 64
 v_exp_f32 v59, v91
 MQ 64, 108, 216, 64
 RA 104, 46, 5120
 s_waitcnt lgkmcnt(3)
 MQ 64, 112, 224, 64
 v_add_f32 v35, v35, v57
 CV 124, 56, 57
 MQ 64, 116, 232, 64
 RA 108, 46, 7168
 v_add_f32 v35, v35, v58
 MQ 72, 112, 228, 72
 DMAS 38, 8, 15, 0
 MQ 72, 116, 236, 72
 RA 112, 46, 9216
 v_add_f32 v35, v35, v59
 MQ 72, 120, 244, 72
 v_exp_f32 v60, v92
 MQ 72, 124, 252, 72
 RA 116, 46, 11264
 CV 125, 58, 59
 MQ 64, 120, 240, 64
 v_exp_f32 v61, v93
 MQ 64, 124, 248, 64
 RA 120, 46, 13312
 s_waitcnt lgkmcnt(3)
 MQ 68, 96, 192, 96
 v_add_f32 v35, v35, v60
 v_add_f32 v35, v35, v61
 MQ 68, 100, 200, 68
 RA 124, 46, 15360
 CV 126, 60, 61
 MQ 76, 96, 196, 100
 DMAS 38, 8, 15, 1024
 MQ 76, 100, 204, 76
 RA 96, 47, 16384
 MQ 76, 104, 212, 76
 v_exp_f32 v62, v94
 MQ 76, 108, 220, 76
 RA 100, 47, 17408
 MQ 68, 104, 208, 68
 v_exp_f32 v63, v95
 MQ 68, 108, 216, 68
 RA 104, 47, 18432
 s_waitcnt lgkmcnt(3)
 MQ 68, 112, 224, 68
 v_add_f32 v35, v35, v62
 v_add_f32 v35, v35, v63
 MQ 68, 116, 232, 68
 RA 108, 47, 19456
 CV 127, 62, 63
 MQ 76, 112, 228, 76
 DMAS 38, 8, 15, 2048
 MQ 76, 116, 236, 76
 RA 112, 47, 20480
 v_max_f32 v2, v34, v35
 MQ 76, 120, 244, 76
 v_cmp_lt_f32 vcc, s23, v2
 MQ 76, 124, 252, 76
 RA 116, 47, 21504
 MQ 68, 120, 240, 68
 DMAS 38, 8, 15, 3072
 MQ 68, 124, 248, 68
 RA 120, 47, 22528
 RA 124, 47, 23552
 s_cmp_le_u32 s14, s29
 s_cbranch_vccnz P2_RS1
P2_RB1:
 s_cbranch_scc1 P2_TAILS
.p2align 6
P2_LOOP:
 s_waitcnt vmcnt(20) lgkmcnt(4)
 MP 128, 96, 120
 s_barrier
 s_add_u32 s15, s15, 33792
 MP 192, 96, 124
 RA 96, 47, 24576
 MP 196, 100, 124
 s_add_u32 s75, s75, s75
 s_cbranch_scc1 P2_DS1
P2_DB1:
 MP 132, 100, 120
 RA 100, 47, 25600
 s_mov_b32 m0, s18
 MP 136, 104, 120
 s_cmp_eq_u32 s14, s16
 s_cselect_b32 s15, s17, s15
 MP 200, 104, 124
 RA 104, 47, 26624
 s_cmp_eq_u32 s14, s41
 s_cselect_b32 s15, s43, s15
 MP 204, 108, 124
 v_exp_f32 v48, v64
 MP 140, 108, 120
 RA 108, 47, 27648
 s_waitcnt lgkmcnt(4)
 MP 144, 112, 120
 v_exp_f32 v49, v65
 MP 208, 112, 124
 RA 112, 47, 28672
 v_add_f32 v32, v34, v48
 MP 212, 116, 124
 DMAS 39, 8, 15, 0
 MP 148, 116, 120
 RA 116, 47, 29696
 s_add_u32 s20, s19, s21
 MP 152, 120, 120
 v_exp_f32 v50, v66
 MP 216, 120, 124
 RA 120, 47, 30720
 s_add_u32 s19, s19, 32768
 MP 220, 124, 124
 v_exp_f32 v51, v67
 MP 156, 124, 120
 RA 124, 47, 31744
 s_waitcnt lgkmcnt(4)
 MP 160, 96, 120
 v_exp_f32 v52, v68
 MP 224, 96, 124
 RA 96, 46, 16384
 v_add_f32 v32, v32, v49
 MP 228, 100, 124
 DMAS 39, 8, 15, 1024
 MP 164, 100, 120
 RA 100, 46, 18432
 CV 112, 48, 49
 MP 168, 104, 120
 v_exp_f32 v53, v69
 MP 232, 104, 124
 RA 104, 46, 20480
 v_add_f32 v32, v32, v50
 MP 236, 108, 124
 v_exp_f32 v54, v70
 MP 172, 108, 120
 RA 108, 46, 22528
 s_waitcnt lgkmcnt(4)
 MP 176, 112, 120
 s_cmp_eq_u32 s19, 163840
 s_cselect_b32 s19, 65536, s19
 MP 240, 112, 124
 RA 112, 46, 24576
 v_add_f32 v32, v32, v51
 MP 244, 116, 124
 DMAS 39, 8, 15, 2048
 MP 180, 116, 120
 RA 116, 46, 26624
 CV 113, 50, 51
 MP 184, 120, 120
 v_exp_f32 v55, v71
 MP 248, 120, 124
 RA 120, 46, 28672
 v_add_f32 v32, v32, v52
 MP 252, 124, 124
 v_exp_f32 v56, v72
 MP 188, 124, 120
 RA 124, 46, 30720
 s_waitcnt lgkmcnt(4)
 MQ 80, 96, 192, 96
 v_exp_f32 v57, v73
 MQ 80, 100, 200, 80
 v_add_u32 v47, s19, v39
 v_add_f32 v32, v32, v53
 MQ 88, 96, 196, 100
 DMAS 39, 8, 15, 3072
 MQ 88, 100, 204, 88
 RA 96, 46, 17408
 s_mov_b32 m0, s20
 MQ 88, 104, 212, 88
 v_exp_f32 v58, v74
 MQ 88, 108, 220, 88
 RA 100, 46, 19456
 CV 114, 52, 53
 MQ 80, 104, 208, 80
 v_exp_f32 v59, v75
 MQ 80, 108, 216, 80
 RA 104, 46, 21504
 s_waitcnt lgkmcnt(3)
 MQ 80, 112, 224, 80
 v_add_f32 v32, v32, v54
 v_add_f32 v32, v32, v55
 MQ 80, 116, 232, 80
 RA 108, 46, 23552
 CV 115, 54, 55
 MQ 88, 112, 228, 88
 DMAS 38, 8, 15, 0
 MQ 88, 116, 236, 88
 RA 112, 46, 25600
 v_add_f32 v33, v35, v56
 MQ 88, 120, 244, 88
 v_exp_f32 v60, v76
 MQ 88, 124, 252, 88
 RA 116, 46, 27648
 v_add_f32 v33, v33, v57
 MQ 80, 120, 240, 80
 v_exp_f32 v61, v77
 MQ 80, 124, 248, 80
 RA 120, 46, 29696
 s_waitcnt lgkmcnt(3)
 MQ 84, 96, 192, 96
 CV 116, 56, 57
 v_add_f32 v33, v33, v58
 MQ 84, 100, 200, 84
 RA 124, 46, 31744
 v_add_f32 v33, v33, v59
 MQ 92, 96, 196, 100
 DMAS 38, 8, 15, 1024
 MQ 92, 100, 204, 92
 RA 96, 47, 0
 CV 117, 58, 59
 MQ 92, 104, 212, 92
 v_exp_f32 v62, v78
 MQ 92, 108, 220, 92
 RA 100, 47, 1024
 v_add_f32 v33, v33, v60
 MQ 84, 104, 208, 84
 v_exp_f32 v63, v79
 MQ 84, 108, 216, 84
 RA 104, 47, 2048
 s_waitcnt lgkmcnt(3)
 MQ 84, 112, 224, 84
 v_add_f32 v33, v33, v61
 CV 118, 60, 61
 MQ 84, 116, 232, 84
 RA 108, 47, 3072
 v_add_f32 v33, v33, v62
 MQ 92, 112, 228, 92
 DMAS 38, 8, 15, 2048
 MQ 92, 116, 236, 92
 RA 112, 47, 4096
 v_add_f32 v33, v33, v63
 MQ 92, 120, 244, 92
 CV 119, 62, 63
 v_max_f32 v2, v32, v33
 MQ 92, 124, 252, 92
 RA 116, 47, 5120
 v_cmp_lt_f32 vcc, s23, v2
 MQ 84, 120, 240, 84
 DMAS 38, 8, 15, 3072
 MQ 84, 124, 248, 84
 RA 120, 47, 6144
 RA 124, 47, 7168
 s_cbranch_vccnz P2_RS2
P2_RB2:
 s_waitcnt vmcnt(20) lgkmcnt(4)
 MP 128, 96, 112
 s_barrier
 s_add_u32 s15, s15, 33792
 MP 192, 96, 116
 RA 96, 47, 8192
 v_xor_b32 v46, 0x8000, v46
 MP 196, 100, 116
 s_cmp_lg_u32 s27, 0
 s_cbranch_scc1 P2_LFS
P2_LFB:
 MP 132, 100, 112
 RA 100, 47, 9216
 s_add_u32 m0, s18, 16384
 MP 136, 104, 112
 MP 200, 104, 116
 RA 104, 47, 10240
 s_xor_b32 s18, s18, 32768
 MP 204, 108, 116
 v_exp_f32 v48, v80
 MP 140, 108, 112
 RA 108, 47, 11264
 s_waitcnt lgkmcnt(4)
 MP 144, 112, 112
 v_exp_f32 v49, v81
 MP 208, 112, 116
 RA 112, 47, 12288
 v_add_f32 v34, v32, v48
 MP 212, 116, 116
 DMAS 39, 8, 15, 0
 MP 148, 116, 112
 RA 116, 47, 13312
 v_add_f32 v34, v34, v49
 MP 152, 120, 112
 v_exp_f32 v50, v82
 MP 216, 120, 116
 RA 120, 47, 14336
 CV 120, 48, 49
 MP 220, 124, 116
 v_exp_f32 v51, v83
 MP 156, 124, 112
 RA 124, 47, 15360
 s_waitcnt lgkmcnt(4)
 MP 160, 96, 112
 v_exp_f32 v52, v84
 MP 224, 96, 116
 RA 96, 46, 0
 v_add_f32 v34, v34, v50
 MP 228, 100, 116
 DMAS 39, 8, 15, 1024
 MP 164, 100, 112
 RA 100, 46, 2048
 v_add_f32 v34, v34, v51
 MP 168, 104, 112
 v_exp_f32 v53, v85
 MP 232, 104, 116
 RA 104, 46, 4096
 CV 121, 50, 51
 MP 236, 108, 116
 v_exp_f32 v54, v86
 MP 172, 108, 112
 RA 108, 46, 6144
 s_waitcnt lgkmcnt(4)
 MP 176, 112, 112
 v_add_f32 v34, v34, v52
 v_add_f32 v34, v34, v53
 MP 240, 112, 116
 RA 112, 46, 8192
 CV 122, 52, 53
 MP 244, 116, 116
 DMAS 39, 8, 15, 2048
 MP 180, 116, 112
 RA 116, 46, 10240
 v_add_f32 v34, v34, v54
 MP 184, 120, 112
 v_exp_f32 v55, v87
 MP 248, 120, 116
 RA 120, 46, 12288
 v_add_f32 v34, v34, v55
 MP 252, 124, 116
 v_exp_f32 v56, v88
 MP 188, 124, 112
 RA 124, 46, 14336
 s_waitcnt lgkmcnt(4)
 MQ 64, 96, 192, 96
 v_exp_f32 v57, v89
 MQ 64, 100, 200, 64
 CV 123, 54, 55
 v_add_f32 v35, v33, v56
 MQ 72, 96, 196, 100
 DMAS 39, 8, 15, 3072
 MQ 72, 100, 204, 72
 RA 96, 46, 1024
 s_add_u32 m0, s20, 16384
 MQ 72, 104, 212, 72
 v_exp_f32 v58, v90
 MQ 72, 108, 220, 72
 RA 100, 46, 3072
 s_sub_u32 s14, s14, 2
 MQ 64, 104, 208, 64
 v_exp_f32 v59, v91
 MQ 64, 108, 216, 64
 RA 104, 46, 5120
 s_waitcnt lgkmcnt(3)
 MQ 64, 112, 224, 64
 v_add_f32 v35, v35, v57
 CV 124, 56, 57
 MQ 64, 116, 232, 64
 RA 108, 46, 7168
 v_add_f32 v35, v35, v58
 MQ 72, 112, 228, 72
 DMAS 38, 8, 15, 0
 MQ 72, 116, 236, 72
 RA 112, 46, 9216
 v_add_f32 v35, v35, v59
 MQ 72, 120, 244, 72
 v_exp_f32 v60, v92
 MQ 72, 124, 252, 72
 RA 116, 46, 11264
 CV 125, 58, 59
 MQ 64, 120, 240, 64
 v_exp_f32 v61, v93
 MQ 64, 124, 248, 64
 RA 120, 46, 13312
 s_waitcnt lgkmcnt(3)
 MQ 68, 96, 192, 96
 v_add_f32 v35, v35, v60
 v_add_f32 v35, v35, v61
 MQ 68, 100, 200, 68
 RA 124, 46, 15360
 CV 126, 60, 61
 MQ 76, 96, 196, 100
 DMAS 38, 8, 15, 1024
 MQ 76, 100, 204, 76
 RA 96, 47, 16384
 MQ 76, 104, 212, 76
 v_exp_f32 v62, v94
 MQ 76, 108, 220, 76
 RA 100, 47, 17408
 MQ 68, 104, 208, 68
 v_exp_f32 v63, v95
 MQ 68, 108, 216, 68
 RA 104, 47, 18432
 s_waitcnt lgkmcnt(3)
 MQ 68, 112, 224, 68
 v_add_f32 v35, v35, v62
 v_add_f32 v35, v35, v63
 MQ 68, 116, 232, 68
 RA 108, 47, 19456
 CV 127, 62, 63
 MQ 76, 112, 228, 76
 DMAS 38, 8, 15, 2048
 MQ 76, 116, 236, 76
 RA 112, 47, 20480
 v_max_f32 v2, v34, v35
 MQ 76, 120, 244, 76
 v_cmp_lt_f32 vcc, s23, v2
 MQ 76, 124, 252, 76
 RA 116, 47, 21504
 MQ 68, 120, 240, 68
 DMAS 38, 8, 15, 3072
 MQ 68, 124, 248, 68
 RA 120, 47, 22528
 RA 124, 47, 23552
 s_cmp_gt_u32 s14, s29
 s_cbranch_vccnz P2_RS3
P2_RB3:
 s_cbranch_scc1 P2_LOOP
P2_TAILS:
 s_cmp_eq_u32 s12, 0
 s_cbranch_scc1 P2_TS
 s_sub_u32 s52, s18, s21
 s_mov_b32 s53, s19
 s_xor_b32 s54, s52, 32768
 s_add_u32 s55, s53, 32768
 s_cmp_eq_u32 s55, 163840
 s_cselect_b32 s55, 65536, s55
 s_add_u32 s56, s55, 32768
 s_cmp_eq_u32 s56, 163840
 s_cselect_b32 s56, 65536, s56
 v_mov_b32 v3, 0
 s_lshl_b32 s24, s5, 7
 s_add_u32 s24, s24, 78790656
 buffer_load_dword v14, v3, s[8:11], s24 offen sc1
 s_lshl_b32 s24, s28, 7
 s_add_u32 s24, s24, 78774272
 buffer_load_dword v15, v3, s[8:11], s24 offen sc1
 s_cmp_ge_u32 s4, 2
 s_cbranch_scc1 P2_TWB
 s_waitcnt vmcnt(20)
 s_barrier
 s_add_u32 s19, s19, 32768
 s_cmp_eq_u32 s19, 163840
 s_cselect_b32 s19, 65536, s19
 s_waitcnt lgkmcnt(4)
 MP 128, 96, 120
 MP 192, 96, 124
 RA 96, 47, 24576
 MP 196, 100, 124
 MP 132, 100, 120
 RA 100, 47, 25600
 MP 136, 104, 120
 v_cmp_gt_i32 s[32:33], 0, v44
 v_cmp_gt_i32 s[34:35], 1, v44
 MP 200, 104, 124
 RA 104, 47, 26624
 v_cmp_gt_i32 s[36:37], 2, v44
 MP 204, 108, 124
 v_cndmask_b32 v64, v64, v45, s[32:33]
 v_cmp_gt_i32 s[38:39], 3, v44
 MP 140, 108, 120
 RA 108, 47, 27648
 s_waitcnt lgkmcnt(4)
 v_cndmask_b32 v65, v65, v45, s[34:35]
 MP 144, 112, 120
 v_exp_f32 v48, v64
 MP 208, 112, 124
 RA 112, 47, 28672
 v_cmp_gt_i32 s[32:33], 16, v44
 v_cndmask_b32 v66, v66, v45, s[36:37]
 MP 212, 116, 124
 v_exp_f32 v49, v65
 MP 148, 116, 120
 RA 116, 47, 29696
 v_add_f32 v32, v34, v48
 MP 152, 120, 120
 v_cmp_gt_i32 s[34:35], 17, v44
 v_cndmask_b32 v67, v67, v45, s[38:39]
 MP 216, 120, 124
 RA 120, 47, 30720
 v_exp_f32 v50, v66
 MP 220, 124, 124
 v_add_f32 v32, v32, v49
 MP 156, 124, 120
 RA 124, 47, 31744
 s_waitcnt lgkmcnt(4)
 CV 112, 48, 49
 v_cmp_gt_i32 s[36:37], 18, v44
 MP 160, 96, 120
 v_cndmask_b32 v68, v68, v45, s[32:33]
 MP 224, 96, 124
 RA 96, 46, 16384
 v_exp_f32 v51, v67
 MP 228, 100, 124
 v_add_f32 v32, v32, v50
 v_cmp_gt_i32 s[38:39], 19, v44
 MP 164, 100, 120
 RA 100, 46, 18432
 v_cndmask_b32 v69, v69, v45, s[34:35]
 MP 168, 104, 120
 v_exp_f32 v52, v68
 MP 232, 104, 124
 RA 104, 46, 20480
 v_add_f32 v32, v32, v51
 CV 113, 50, 51
 MP 236, 108, 124
 v_cndmask_b32 v70, v70, v45, s[36:37]
 MP 172, 108, 120
 RA 108, 46, 22528
 s_waitcnt lgkmcnt(4)
 v_exp_f32 v53, v69
 MP 176, 112, 120
 v_add_f32 v32, v32, v52
 v_cndmask_b32 v71, v71, v45, s[38:39]
 MP 240, 112, 124
 RA 112, 46, 24576
 v_exp_f32 v54, v70
 MP 244, 116, 124
 v_add_f32 v32, v32, v53
 CV 114, 52, 53
 MP 180, 116, 120
 RA 116, 46, 26624
 v_exp_f32 v55, v71
 MP 184, 120, 120
 v_add_f32 v32, v32, v54
 MP 248, 120, 124
 RA 120, 46, 28672
 v_exp_f32 v56, v72
 v_add_f32 v32, v32, v55
 MP 252, 124, 124
 CV 115, 54, 55
 MP 188, 124, 120
 RA 124, 46, 30720
 s_waitcnt lgkmcnt(4)
 v_exp_f32 v57, v73
 MQ 88, 96, 196, 100
 RA 96, 46, 17408
 v_add_f32 v33, v35, v56
 v_exp_f32 v58, v74
 MQ 88, 100, 204, 88
 RA 100, 46, 19456
 v_add_f32 v33, v33, v57
 MQ 88, 104, 212, 88
 RA 104, 46, 21504
 CV 116, 56, 57
 MQ 88, 108, 220, 88
 RA 108, 46, 23552
 s_waitcnt lgkmcnt(4)
 v_exp_f32 v59, v75
 v_add_f32 v33, v33, v58
 MQ 88, 112, 228, 88
 RA 112, 46, 25600
 v_exp_f32 v60, v76
 MQ 88, 116, 236, 88
 RA 116, 46, 27648
 v_add_f32 v33, v33, v59
 MQ 88, 120, 244, 88
 RA 120, 46, 29696
 CV 117, 58, 59
 v_exp_f32 v61, v77
 MQ 88, 124, 252, 88
 RA 124, 46, 31744
 s_waitcnt lgkmcnt(4)
 v_add_f32 v33, v33, v60
 MQ 92, 96, 196, 100
 v_add_u32 v47, s19, v39
 RA 96, 47, 0
 v_exp_f32 v62, v78
 MQ 92, 100, 204, 92
 RA 100, 47, 1024
 v_add_f32 v33, v33, v61
 CV 118, 60, 61
 MQ 92, 104, 212, 92
 RA 104, 47, 2048
 v_exp_f32 v63, v79
 MQ 92, 108, 220, 92
 RA 108, 47, 3072
 s_waitcnt lgkmcnt(4)
 v_add_f32 v33, v33, v62
 MQ 92, 112, 228, 92
 RA 112, 47, 4096
 v_add_f32 v33, v33, v63
 CV 119, 62, 63
 MQ 92, 116, 236, 92
 RA 116, 47, 5120
 v_max_f32 v2, v32, v33
 MQ 92, 120, 244, 92
 RA 120, 47, 6144
 v_cmp_lt_f32 vcc, s23, v2
 MQ 92, 124, 252, 92
 RA 124, 47, 7168
 s_cbranch_vccnz P2_RS4
P2_RB4:
 s_waitcnt vmcnt(0)
 s_barrier
 s_cmp_eq_u32 s27, 0
 s_cbranch_scc1 P2_NF0
 s_mov_b64 exec, 1
 buffer_store_dword v45, v39, s[8:11], s27 offen sc1
 s_mov_b64 exec, -1
 s_mov_b32 s27, 0
P2_NF0:
 v_readfirstlane_b32 s64, v14
 v_readfirstlane_b32 s57, v15
 s_mul_i32 s58, s5, 229376
 s_mul_i32 s3, s4, 57344
 s_add_u32 s58, s58, s3
 s_mul_i32 s60, s5, 25088
 s_lshl_b32 s3, s4, 7
 s_add_u32 s60, s60, s3
 s_mul_i32 s61, s5, 3072
 s_add_u32 s61, s61, 79462400
 s_mul_i32 s26, s28, 66560
 s_lshl_b32 s3, s4, 14
 s_add_u32 s26, s26, s3
 s_add_u32 s26, s26, 79691776
 s_lshl_b32 s25, s28, 12
 s_lshl_b32 s3, s4, 10
 s_add_u32 s25, s25, s3
 s_add_u32 s25, s25, 78905344
 s_cmp_eq_u32 s12, 2
 s_cselect_b32 s57, s57, 0
 s_cmp_lg_u32 s57, 0
 s_cselect_b32 s62, s25, 1879048192
 s_cselect_b32 s63, s26, 1879048192
 v_xor_b32 v46, 0x8000, v46
 s_waitcnt lgkmcnt(4)
 MP 128, 96, 112
 buffer_load_dwordx4 v[8:11], v39, s[8:11], s62 offen sc1
 MP 192, 96, 116
 RA 96, 47, 8192
 MP 196, 100, 116
 buffer_load_dwordx4 a[128:131], v39, s[8:11], s63 offen offset:0 sc1
 MP 132, 100, 112
 RA 100, 47, 9216
 MP 136, 104, 112
 v_mov_b32 v80, v45
 MP 200, 104, 116
 RA 104, 47, 10240
 v_mov_b32 v81, v45
 buffer_load_dwordx4 a[132:135], v39, s[8:11], s63 offen offset:1024 sc1
 MP 204, 108, 116
 v_mov_b32 v82, v45
 MP 140, 108, 112
 RA 108, 47, 11264
 s_waitcnt lgkmcnt(4)
 MP 144, 112, 112
 v_mov_b32 v83, v45
 buffer_load_dwordx4 a[136:139], v39, s[8:11], s63 offen offset:2048 sc1
 MP 208, 112, 116
 RA 112, 47, 12288
 v_mov_b32 v84, v45
 MP 212, 116, 116
 v_mov_b32 v85, v45
 MP 148, 116, 112
 RA 116, 47, 13312
 buffer_load_dwordx4 a[140:143], v39, s[8:11], s63 offen offset:3072 sc1
 s_add_u32 s63, s63, 4096
 MP 152, 120, 112
 v_mov_b32 v86, v45
 MP 216, 120, 116
 RA 120, 47, 14336
 v_mov_b32 v87, v45
 buffer_load_dwordx4 a[144:147], v39, s[8:11], s63 offen offset:0 sc1
 MP 220, 124, 116
 MP 156, 124, 112
 RA 124, 47, 15360
 s_waitcnt lgkmcnt(4)
 v_mov_b32 v34, v32
 MP 160, 96, 112
 v_exp_f32 v56, v88
 buffer_load_dwordx4 a[148:151], v39, s[8:11], s63 offen offset:1024 sc1
 MP 224, 96, 116
 RA 96, 46, 0
 v_exp_f32 v57, v89
 MP 228, 100, 116
 MP 164, 100, 112
 RA 100, 46, 2048
 v_add_f32 v35, v33, v56
 buffer_load_dwordx4 a[152:155], v39, s[8:11], s63 offen offset:2048 sc1
 MP 168, 104, 112
 v_exp_f32 v58, v90
 MP 232, 104, 116
 RA 104, 46, 4096
 MP 236, 108, 116
 v_add_f32 v35, v35, v57
 buffer_load_dwordx4 a[156:159], v39, s[8:11], s63 offen offset:3072 sc1
 s_add_u32 s63, s63, 4096
 MP 172, 108, 112
 RA 108, 46, 6144
 s_waitcnt lgkmcnt(4)
 CV 124, 56, 57
 MP 176, 112, 112
 v_exp_f32 v59, v91
 buffer_load_dwordx4 a[160:163], v39, s[8:11], s63 offen offset:0 sc1
 MP 240, 112, 116
 RA 112, 46, 8192
 MP 244, 116, 116
 v_add_f32 v35, v35, v58
 MP 180, 116, 112
 RA 116, 46, 10240
 v_exp_f32 v60, v92
 buffer_load_dwordx4 a[164:167], v39, s[8:11], s63 offen offset:1024 sc1
 MP 184, 120, 112
 v_add_f32 v35, v35, v59
 MP 248, 120, 116
 RA 120, 46, 12288
 MP 252, 124, 116
 CV 125, 58, 59
 buffer_load_dwordx4 a[168:171], v39, s[8:11], s63 offen offset:2048 sc1
 MP 188, 124, 112
 RA 124, 46, 14336
 s_waitcnt lgkmcnt(4)
 v_exp_f32 v61, v93
 MQ 72, 96, 196, 100
 RA 96, 46, 1024
 MQ 72, 100, 204, 72
 RA 100, 46, 3072
 v_add_f32 v35, v35, v60
 buffer_load_dwordx4 a[172:175], v39, s[8:11], s63 offen offset:3072 sc1
 s_add_u32 s63, s63, 4096
 MQ 72, 104, 212, 72
 RA 104, 46, 5120
 v_exp_f32 v62, v94
 MQ 72, 108, 220, 72
 RA 108, 46, 7168
 s_waitcnt lgkmcnt(4)
 v_add_f32 v35, v35, v61
 buffer_load_dwordx4 a[176:179], v39, s[8:11], s63 offen offset:0 sc1
 MQ 72, 112, 228, 72
 RA 112, 46, 9216
 MQ 72, 116, 236, 72
 RA 116, 46, 11264
 CV 126, 60, 61
 MQ 72, 120, 244, 72
 RA 120, 46, 13312
 v_exp_f32 v63, v95
 buffer_load_dwordx4 a[180:183], v39, s[8:11], s63 offen offset:1024 sc1
 MQ 72, 124, 252, 72
 RA 124, 46, 15360
 s_waitcnt lgkmcnt(4)
 MQ 76, 96, 196, 100
 RA 96, 47, 16384
 v_add_f32 v35, v35, v62
 MQ 76, 100, 204, 76
 RA 100, 47, 17408
 v_add_f32 v35, v35, v63
 buffer_load_dwordx4 a[184:187], v39, s[8:11], s63 offen offset:2048 sc1
 MQ 76, 104, 212, 76
 RA 104, 47, 18432
 CV 127, 62, 63
 MQ 76, 108, 220, 76
 RA 108, 47, 19456
 s_waitcnt lgkmcnt(4)
 MQ 76, 112, 228, 76
 RA 112, 47, 20480
 v_max_f32 v2, v34, v35
 buffer_load_dwordx4 a[188:191], v39, s[8:11], s63 offen offset:3072 sc1
 s_add_u32 s63, s63, 4096
 MQ 76, 116, 236, 76
 RA 116, 47, 21504
 v_cmp_lt_f32 vcc, s23, v2
 MQ 76, 120, 244, 76
 RA 120, 47, 22528
 MQ 76, 124, 252, 76
 RA 124, 47, 23552
 s_cbranch_vccnz P2_RS5
P2_RB5:
 s_add_u32 s19, s19, 32768
 s_cmp_eq_u32 s19, 163840
 s_cselect_b32 s19, 65536, s19
 s_waitcnt lgkmcnt(4)
 MP 192, 96, 124
 RA 96, 47, 24576
 s_add_u32 m0, s21, s52
 s_nop 0
 MP 196, 100, 124
 RA 100, 47, 25600
 DMA 16, 48, 60, 0
 MP 200, 104, 124
 RA 104, 47, 26624
 MP 204, 108, 124
 RA 108, 47, 27648
 s_waitcnt lgkmcnt(4)
 DMA 17, 48, 60, 1024
 MP 208, 112, 124
 RA 112, 47, 28672
 v_mov_b32 v64, v45
 v_mov_b32 v65, v45
 MP 212, 116, 124
 RA 116, 47, 29696
 v_mov_b32 v66, v45
 DMA 18, 48, 60, 2048
 MP 216, 120, 124
 RA 120, 47, 30720
 v_mov_b32 v67, v45
 MP 220, 124, 124
 RA 124, 47, 31744
 s_waitcnt lgkmcnt(4)
 v_mov_b32 v68, v45
 DMA 19, 48, 60, 3072
 MP 224, 96, 124
 RA 96, 46, 16384
 v_mov_b32 v69, v45
 MP 228, 100, 124
 RA 100, 46, 18432
 v_mov_b32 v70, v45
 s_add_u32 m0, m0, 16384
 s_add_u32 s60, s60, 512
 MP 232, 104, 124
 RA 104, 46, 20480
 v_mov_b32 v71, v45
 v_mov_b32 v32, v34
 MP 236, 108, 124
 RA 108, 46, 22528
 s_waitcnt lgkmcnt(4)
 v_exp_f32 v56, v72
 DMA 16, 48, 60, 0
 MP 240, 112, 124
 RA 112, 46, 24576
 v_exp_f32 v57, v73
 MP 244, 116, 124
 RA 116, 46, 26624
 v_add_f32 v33, v35, v56
 DMA 17, 48, 60, 1024
 MP 248, 120, 124
 RA 120, 46, 28672
 v_exp_f32 v58, v74
 MP 252, 124, 124
 RA 124, 46, 30720
 s_waitcnt lgkmcnt(4)
 v_add_f32 v33, v33, v57
 DMA 18, 48, 60, 2048
 MQ 88, 96, 196, 100
 RA 96, 46, 17408
 CV 116, 56, 57
 MQ 88, 100, 204, 88
 RA 100, 46, 19456
 v_exp_f32 v59, v75
 v_add_f32 v33, v33, v58
 DMA 19, 48, 60, 3072
 MQ 88, 104, 212, 88
 RA 104, 46, 21504
 v_exp_f32 v60, v76
 MQ 88, 108, 220, 88
 RA 108, 46, 23552
 s_waitcnt lgkmcnt(4)
 v_add_f32 v33, v33, v59
 s_add_u32 s24, s58, 0
 s_lshl_b32 s3, s21, 1
 MQ 88, 112, 228, 88
 RA 112, 46, 25600
 CV 117, 58, 59
 MQ 88, 116, 236, 88
 RA 116, 46, 27648
 v_exp_f32 v61, v77
 s_add_u32 s3, s3, 0
 s_add_u32 m0, s3, s53
 s_nop 0
 MQ 88, 120, 244, 88
 RA 120, 46, 29696
 v_add_f32 v33, v33, v60
 MQ 88, 124, 252, 88
 RA 124, 46, 31744
 s_waitcnt lgkmcnt(4)
 v_exp_f32 v62, v78
 DMA 16, 44, 24, 0
 MQ 92, 96, 196, 100
 v_add_u32 v47, s19, v39
 RA 96, 47, 0
 v_add_f32 v33, v33, v61
 CV 118, 60, 61
 MQ 92, 100, 204, 92
 RA 100, 47, 1024
 v_exp_f32 v63, v79
 DMA 17, 44, 24, 1024
 MQ 92, 104, 212, 92
 RA 104, 47, 2048
 v_add_f32 v33, v33, v62
 MQ 92, 108, 220, 92
 RA 108, 47, 3072
 s_waitcnt lgkmcnt(4)
 v_add_f32 v33, v33, v63
 DMA 18, 44, 24, 2048
 MQ 92, 112, 228, 92
 RA 112, 47, 4096
 CV 119, 62, 63
 MQ 92, 116, 236, 92
 RA 116, 47, 5120
 v_max_f32 v2, v32, v33
 DMA 19, 44, 24, 3072
 MQ 92, 120, 244, 92
 RA 120, 47, 6144
 v_cmp_lt_f32 vcc, s23, v2
 MQ 92, 124, 252, 92
 RA 124, 47, 7168
 s_cbranch_vccnz P2_RS6
P2_RB6:
 v_xor_b32 v46, 0x8000, v46
 s_waitcnt lgkmcnt(4)
 MP 192, 96, 116
 RA 96, 47, 8192
 s_add_u32 s24, s58, 28672
 s_lshl_b32 s3, s21, 1
 MP 196, 100, 116
 RA 100, 47, 9216
 MP 200, 104, 116
 RA 104, 47, 10240
 s_add_u32 s3, s3, 4096
 s_add_u32 m0, s3, s53
 s_nop 0
 MP 204, 108, 116
 RA 108, 47, 11264
 s_waitcnt lgkmcnt(4)
 MP 208, 112, 116
 RA 112, 47, 12288
 v_mov_b32 v80, v45
 v_mov_b32 v81, v45
 v_mov_b32 v82, v45
 v_mov_b32 v83, v45
 v_mov_b32 v84, v45
 DMA 16, 44, 24, 0
 MP 212, 116, 116
 RA 116, 47, 13312
 v_mov_b32 v85, v45
 v_mov_b32 v86, v45
 v_mov_b32 v87, v45
 v_mov_b32 v34, v32
 MP 216, 120, 116
 RA 120, 47, 14336
 v_cmp_gt_i32 s[32:33], 0, v104
 v_cmp_gt_i32 s[34:35], 1, v104
 v_cmp_gt_i32 s[36:37], 2, v104
 v_cndmask_b32 v88, v88, v45, s[32:33]
 DMA 17, 44, 24, 1024
 MP 220, 124, 116
 RA 124, 47, 15360
 s_waitcnt lgkmcnt(4)
 v_cmp_gt_i32 s[38:39], 3, v104
 v_cndmask_b32 v89, v89, v45, s[34:35]
 v_exp_f32 v56, v88
 v_cmp_gt_i32 s[32:33], 16, v104
 v_cndmask_b32 v90, v90, v45, s[36:37]
 MP 224, 96, 116
 RA 96, 47, 16384
 v_exp_f32 v57, v89
 v_add_f32 v35, v33, v56
 v_cmp_gt_i32 s[34:35], 17, v104
 v_cndmask_b32 v91, v91, v45, s[38:39]
 DMA 18, 44, 24, 2048
 MP 228, 100, 116
 RA 100, 47, 17408
 v_exp_f32 v58, v90
 v_add_f32 v35, v35, v57
 CV 124, 56, 57
 v_cmp_gt_i32 s[36:37], 18, v104
 MP 232, 104, 116
 RA 104, 47, 18432
 v_cndmask_b32 v92, v92, v45, s[32:33]
 v_exp_f32 v59, v91
 v_add_f32 v35, v35, v58
 v_cmp_gt_i32 s[38:39], 19, v104
 DMA 19, 44, 24, 3072
 MP 236, 108, 116
 RA 108, 47, 19456
 s_waitcnt lgkmcnt(4)
 v_cndmask_b32 v93, v93, v45, s[34:35]
 v_exp_f32 v60, v92
 v_add_f32 v35, v35, v59
 CV 125, 58, 59
 v_cndmask_b32 v94, v94, v45, s[36:37]
 MP 240, 112, 116
 RA 112, 47, 20480
 v_exp_f32 v61, v93
 v_add_f32 v35, v35, v60
 v_cndmask_b32 v95, v95, v45, s[38:39]
 v_exp_f32 v62, v94
 s_cmp_lg_u32 s64, 0
 s_cselect_b32 s3, s61, 1879048192
 buffer_load_dwordx4 a[80:83], v39, s[8:11], s3 offen offset:0 sc1
 buffer_load_dwordx4 a[84:87], v39, s[8:11], s3 offen offset:1024 sc1
 buffer_load_dwordx4 a[88:91], v39, s[8:11], s3 offen offset:2048 sc1
 MP 244, 116, 116
 RA 116, 47, 21504
 v_add_f32 v35, v35, v61
 CV 126, 60, 61
 v_exp_f32 v63, v95
 v_add_f32 v35, v35, v62
 MP 248, 120, 116
 RA 120, 47, 22528
 v_add_f32 v35, v35, v63
 CV 127, 62, 63
 v_max_f32 v2, v34, v35
 v_cmp_lt_f32 vcc, s23, v2
 MP 252, 124, 116
 RA 124, 47, 23552
 s_cbranch_vccnz P2_RS7
P2_RB7:
 s_waitcnt lgkmcnt(4)
 MP 192, 96, 124
 RA 96, 47, 24576
 v_mov_b32 v2, v34
 MP 196, 100, 124
 RA 100, 47, 25600
 v_mov_b32 v3, v35
 MP 200, 104, 124
 RA 104, 47, 26624
 s_nop 0
 MP 204, 108, 124
 RA 108, 47, 27648
 v_permlane32_swap_b32 v2, v34
 s_waitcnt lgkmcnt(4)
 MP 208, 112, 124
 RA 112, 47, 28672
 v_permlane32_swap_b32 v3, v35
 MP 212, 116, 124
 RA 116, 47, 29696
 s_nop 0
 MP 216, 120, 124
 RA 120, 47, 30720
 v_add_f32 v34, v34, v2
 MP 220, 124, 124
 RA 124, 47, 31744
 v_add_f32 v35, v35, v3
 s_waitcnt lgkmcnt(4)
 MP 224, 96, 124
 v_mov_b32 v2, v34
 MP 228, 100, 124
 v_mov_b32 v3, v35
 MP 232, 104, 124
 s_nop 0
 MP 236, 108, 124
 v_permlane16_swap_b32 v2, v34
 s_waitcnt lgkmcnt(0)
 MP 240, 112, 124
 v_permlane16_swap_b32 v3, v35
 MP 244, 116, 124
 s_nop 0
 MP 248, 120, 124
 v_add_f32 v32, v34, v2
 MP 252, 124, 124
 v_add_f32 v33, v35, v3
 s_branch P2_EPI
P2_TWB:
 s_waitcnt vmcnt(20)
 s_barrier
 s_add_u32 s19, s19, 32768
 s_cmp_eq_u32 s19, 163840
 s_cselect_b32 s19, 65536, s19
 s_waitcnt lgkmcnt(4)
 MP 128, 96, 120
 MP 192, 96, 124
 RA 96, 47, 24576
 MP 196, 100, 124
 MP 132, 100, 120
 RA 100, 47, 25600
 MP 136, 104, 120
 v_exp_f32 v48, v64
 MP 200, 104, 124
 RA 104, 47, 26624
 v_exp_f32 v49, v65
 MP 204, 108, 124
 v_add_f32 v32, v34, v48
 MP 140, 108, 120
 RA 108, 47, 27648
 s_waitcnt lgkmcnt(4)
 MP 144, 112, 120
 v_exp_f32 v50, v66
 MP 208, 112, 124
 RA 112, 47, 28672
 v_add_f32 v32, v32, v49
 MP 212, 116, 124
 MP 148, 116, 120
 RA 116, 47, 29696
 CV 112, 48, 49
 MP 152, 120, 120
 v_exp_f32 v51, v67
 MP 216, 120, 124
 RA 120, 47, 30720
 v_add_f32 v32, v32, v50
 MP 220, 124, 124
 MP 156, 124, 120
 RA 124, 47, 31744
 s_waitcnt lgkmcnt(4)
 v_exp_f32 v52, v68
 MP 160, 96, 120
 v_add_f32 v32, v32, v51
 MP 224, 96, 124
 RA 96, 46, 16384
 MP 228, 100, 124
 CV 113, 50, 51
 MP 164, 100, 120
 RA 100, 46, 18432
 v_exp_f32 v53, v69
 MP 168, 104, 120
 v_add_f32 v32, v32, v52
 MP 232, 104, 124
 RA 104, 46, 20480
 MP 236, 108, 124
 v_exp_f32 v54, v70
 MP 172, 108, 120
 RA 108, 46, 22528
 s_waitcnt lgkmcnt(4)
 v_add_f32 v32, v32, v53
 MP 176, 112, 120
 MP 240, 112, 124
 RA 112, 46, 24576
 CV 114, 52, 53
 MP 244, 116, 124
 v_exp_f32 v55, v71
 MP 180, 116, 120
 RA 116, 46, 26624
 v_add_f32 v32, v32, v54
 MP 184, 120, 120
 MP 248, 120, 124
 RA 120, 46, 28672
 v_exp_f32 v56, v72
 MP 252, 124, 124
 v_add_f32 v32, v32, v55
 MP 188, 124, 120
 RA 124, 46, 30720
 s_waitcnt lgkmcnt(4)
 MQ 80, 96, 192, 96
 CV 115, 54, 55
 MQ 80, 100, 200, 80
 v_exp_f32 v57, v73
 MQ 88, 96, 196, 100
 RA 96, 46, 17408
 v_add_f32 v33, v35, v56
 MQ 88, 100, 204, 88
 RA 100, 46, 19456
 MQ 88, 104, 212, 88
 v_exp_f32 v58, v74
 MQ 88, 108, 220, 88
 v_add_f32 v33, v33, v57
 MQ 80, 104, 208, 80
 RA 104, 46, 21504
 MQ 80, 108, 216, 80
 RA 108, 46, 23552
 s_waitcnt lgkmcnt(4)
 CV 116, 56, 57
 MQ 80, 112, 224, 80
 v_exp_f32 v59, v75
 MQ 80, 116, 232, 80
 v_add_f32 v33, v33, v58
 MQ 88, 112, 228, 88
 RA 112, 46, 25600
 MQ 88, 116, 236, 88
 RA 116, 46, 27648
 v_exp_f32 v60, v76
 MQ 88, 120, 244, 88
 v_add_f32 v33, v33, v59
 MQ 88, 124, 252, 88
 MQ 80, 120, 240, 80
 RA 120, 46, 29696
 CV 117, 58, 59
 MQ 80, 124, 248, 80
 RA 124, 46, 31744
 s_waitcnt lgkmcnt(4)
 v_exp_f32 v61, v77
 MQ 84, 96, 192, 96
 v_add_f32 v33, v33, v60
 MQ 84, 100, 200, 84
 MQ 92, 96, 196, 100
 v_add_u32 v47, s19, v39
 RA 96, 47, 0
 v_exp_f32 v62, v78
 MQ 92, 100, 204, 92
 RA 100, 47, 1024
 v_add_f32 v33, v33, v61
 MQ 92, 104, 212, 92
 MQ 92, 108, 220, 92
 CV 118, 60, 61
 MQ 84, 104, 208, 84
 RA 104, 47, 2048
 v_exp_f32 v63, v79
 MQ 84, 108, 216, 84
 RA 108, 47, 3072
 s_waitcnt lgkmcnt(4)
 v_add_f32 v33, v33, v62
 MQ 84, 112, 224, 84
 MQ 84, 116, 232, 84
 v_add_f32 v33, v33, v63
 MQ 92, 112, 228, 92
 RA 112, 47, 4096
 CV 119, 62, 63
 MQ 92, 116, 236, 92
 RA 116, 47, 5120
 MQ 92, 120, 244, 92
 v_max_f32 v2, v32, v33
 MQ 92, 124, 252, 92
 v_cmp_lt_f32 vcc, s23, v2
 MQ 84, 120, 240, 84
 RA 120, 47, 6144
 MQ 84, 124, 248, 84
 RA 124, 47, 7168
 s_cbranch_vccnz P2_RS8
P2_RB8:
 s_waitcnt vmcnt(0)
 s_barrier
 s_cmp_eq_u32 s27, 0
 s_cbranch_scc1 P2_NF0b
 s_mov_b64 exec, 1
 buffer_store_dword v45, v39, s[8:11], s27 offen sc1
 s_mov_b64 exec, -1
 s_mov_b32 s27, 0
P2_NF0b:
 v_readfirstlane_b32 s64, v14
 v_readfirstlane_b32 s57, v15
 s_mul_i32 s58, s5, 229376
 s_mul_i32 s3, s4, 57344
 s_add_u32 s58, s58, s3
 s_mul_i32 s60, s5, 25088
 s_lshl_b32 s3, s4, 7
 s_add_u32 s60, s60, s3
 s_mul_i32 s61, s5, 3072
 s_add_u32 s61, s61, 79462400
 s_mul_i32 s26, s28, 66560
 s_lshl_b32 s3, s4, 14
 s_add_u32 s26, s26, s3
 s_add_u32 s26, s26, 79691776
 s_lshl_b32 s25, s28, 12
 s_lshl_b32 s3, s4, 10
 s_add_u32 s25, s25, s3
 s_add_u32 s25, s25, 78905344
 s_cmp_eq_u32 s12, 2
 s_cselect_b32 s57, s57, 0
 s_cmp_lg_u32 s57, 0
 s_cselect_b32 s62, s25, 1879048192
 s_cselect_b32 s63, s26, 1879048192
 v_xor_b32 v46, 0x8000, v46
 s_waitcnt lgkmcnt(4)
 MP 128, 96, 112
 buffer_load_dwordx4 v[8:11], v39, s[8:11], s62 offen sc1
 MP 192, 96, 116
 RA 96, 47, 8192
 MP 196, 100, 116
 buffer_load_dwordx4 a[128:131], v39, s[8:11], s63 offen offset:0 sc1
 MP 132, 100, 112
 RA 100, 47, 9216
 MP 136, 104, 112
 v_cmp_gt_i32 s[32:33], 0, v44
 v_cmp_gt_i32 s[34:35], 1, v44
 buffer_load_dwordx4 a[132:135], v39, s[8:11], s63 offen offset:1024 sc1
 MP 200, 104, 116
 RA 104, 47, 10240
 v_cmp_gt_i32 s[36:37], 2, v44
 MP 204, 108, 116
 v_cndmask_b32 v80, v80, v45, s[32:33]
 v_cmp_gt_i32 s[38:39], 3, v44
 buffer_load_dwordx4 a[136:139], v39, s[8:11], s63 offen offset:2048 sc1
 MP 140, 108, 112
 RA 108, 47, 11264
 s_waitcnt lgkmcnt(4)
 v_cndmask_b32 v81, v81, v45, s[34:35]
 MP 144, 112, 112
 v_exp_f32 v48, v80
 buffer_load_dwordx4 a[140:143], v39, s[8:11], s63 offen offset:3072 sc1
 s_add_u32 s63, s63, 4096
 MP 208, 112, 116
 RA 112, 47, 12288
 v_cmp_gt_i32 s[32:33], 16, v44
 v_cndmask_b32 v82, v82, v45, s[36:37]
 MP 212, 116, 116
 v_exp_f32 v49, v81
 buffer_load_dwordx4 a[144:147], v39, s[8:11], s63 offen offset:0 sc1
 MP 148, 116, 112
 RA 116, 47, 13312
 v_add_f32 v34, v32, v48
 MP 152, 120, 112
 v_cmp_gt_i32 s[34:35], 17, v44
 v_cndmask_b32 v83, v83, v45, s[38:39]
 buffer_load_dwordx4 a[148:151], v39, s[8:11], s63 offen offset:1024 sc1
 MP 216, 120, 116
 RA 120, 47, 14336
 v_exp_f32 v50, v82
 MP 220, 124, 116
 v_add_f32 v34, v34, v49
 buffer_load_dwordx4 a[152:155], v39, s[8:11], s63 offen offset:2048 sc1
 MP 156, 124, 112
 RA 124, 47, 15360
 s_waitcnt lgkmcnt(4)
 CV 120, 48, 49
 v_cmp_gt_i32 s[36:37], 18, v44
 MP 160, 96, 112
 v_cndmask_b32 v84, v84, v45, s[32:33]
 buffer_load_dwordx4 a[156:159], v39, s[8:11], s63 offen offset:3072 sc1
 s_add_u32 s63, s63, 4096
 MP 224, 96, 116
 RA 96, 46, 0
 v_exp_f32 v51, v83
 MP 228, 100, 116
 v_add_f32 v34, v34, v50
 v_cmp_gt_i32 s[38:39], 19, v44
 buffer_load_dwordx4 a[160:163], v39, s[8:11], s63 offen offset:0 sc1
 MP 164, 100, 112
 RA 100, 46, 2048
 v_cndmask_b32 v85, v85, v45, s[34:35]
 MP 168, 104, 112
 v_exp_f32 v52, v84
 buffer_load_dwordx4 a[164:167], v39, s[8:11], s63 offen offset:1024 sc1
 MP 232, 104, 116
 RA 104, 46, 4096
 v_add_f32 v34, v34, v51
 CV 121, 50, 51
 MP 236, 108, 116
 v_cndmask_b32 v86, v86, v45, s[36:37]
 buffer_load_dwordx4 a[168:171], v39, s[8:11], s63 offen offset:2048 sc1
 MP 172, 108, 112
 RA 108, 46, 6144
 s_waitcnt lgkmcnt(4)
 v_exp_f32 v53, v85
 MP 176, 112, 112
 v_add_f32 v34, v34, v52
 v_cndmask_b32 v87, v87, v45, s[38:39]
 buffer_load_dwordx4 a[172:175], v39, s[8:11], s63 offen offset:3072 sc1
 s_add_u32 s63, s63, 4096
 MP 240, 112, 116
 RA 112, 46, 8192
 v_exp_f32 v54, v86
 MP 244, 116, 116
 v_add_f32 v34, v34, v53
 CV 122, 52, 53
 buffer_load_dwordx4 a[176:179], v39, s[8:11], s63 offen offset:0 sc1
 MP 180, 116, 112
 RA 116, 46, 10240
 v_exp_f32 v55, v87
 MP 184, 120, 112
 v_add_f32 v34, v34, v54
 buffer_load_dwordx4 a[180:183], v39, s[8:11], s63 offen offset:1024 sc1
 MP 248, 120, 116
 RA 120, 46, 12288
 v_exp_f32 v56, v88
 v_add_f32 v34, v34, v55
 MP 252, 124, 116
 CV 123, 54, 55
 buffer_load_dwordx4 a[184:187], v39, s[8:11], s63 offen offset:2048 sc1
 MP 188, 124, 112
 RA 124, 46, 14336
 s_waitcnt lgkmcnt(4)
 v_exp_f32 v57, v89
 MQ 72, 96, 196, 100
 RA 96, 46, 1024
 v_add_f32 v35, v33, v56
 v_exp_f32 v58, v90
 buffer_load_dwordx4 a[188:191], v39, s[8:11], s63 offen offset:3072 sc1
 s_add_u32 s63, s63, 4096
 MQ 72, 100, 204, 72
 RA 100, 46, 3072
 v_add_f32 v35, v35, v57
 MQ 72, 104, 212, 72
 RA 104, 46, 5120
 CV 124, 56, 57
 s_add_u32 m0, s21, s52
 s_nop 0
 MQ 72, 108, 220, 72
 RA 108, 46, 7168
 s_waitcnt lgkmcnt(4)
 v_exp_f32 v59, v91
 v_add_f32 v35, v35, v58
 MQ 72, 112, 228, 72
 RA 112, 46, 9216
 v_exp_f32 v60, v92
 DMA 16, 48, 60, 0
 MQ 72, 116, 236, 72
 RA 116, 46, 11264
 v_add_f32 v35, v35, v59
 MQ 72, 120, 244, 72
 RA 120, 46, 13312
 CV 125, 58, 59
 v_exp_f32 v61, v93
 DMA 17, 48, 60, 1024
 MQ 72, 124, 252, 72
 RA 124, 46, 15360
 s_waitcnt lgkmcnt(4)
 v_add_f32 v35, v35, v60
 MQ 76, 96, 196, 100
 RA 96, 47, 16384
 v_exp_f32 v62, v94
 DMA 18, 48, 60, 2048
 MQ 76, 100, 204, 76
 RA 100, 47, 17408
 v_add_f32 v35, v35, v61
 CV 126, 60, 61
 MQ 76, 104, 212, 76
 RA 104, 47, 18432
 v_exp_f32 v63, v95
 DMA 19, 48, 60, 3072
 MQ 76, 108, 220, 76
 RA 108, 47, 19456
 s_waitcnt lgkmcnt(4)
 v_add_f32 v35, v35, v62
 MQ 76, 112, 228, 76
 RA 112, 47, 20480
 v_add_f32 v35, v35, v63
 CV 127, 62, 63
 s_add_u32 m0, m0, 16384
 s_add_u32 s60, s60, 512
 MQ 76, 116, 236, 76
 RA 116, 47, 21504
 v_max_f32 v2, v34, v35
 MQ 76, 120, 244, 76
 RA 120, 47, 22528
 v_cmp_lt_f32 vcc, s23, v2
 MQ 76, 124, 252, 76
 RA 124, 47, 23552
 s_cbranch_vccnz P2_RS9
P2_RB9:
 s_add_u32 s19, s19, 32768
 s_cmp_eq_u32 s19, 163840
 s_cselect_b32 s19, 65536, s19
 s_waitcnt lgkmcnt(4)
 MP 128, 96, 120
 DMA 16, 48, 60, 0
 MP 192, 96, 124
 RA 96, 47, 24576
 DMA 17, 48, 60, 1024
 MP 196, 100, 124
 MP 132, 100, 120
 RA 100, 47, 25600
 DMA 18, 48, 60, 2048
 MP 136, 104, 120
 v_mov_b32 v64, v45
 v_mov_b32 v65, v45
 MP 200, 104, 124
 RA 104, 47, 26624
 v_mov_b32 v66, v45
 v_mov_b32 v67, v45
 DMA 19, 48, 60, 3072
 MP 204, 108, 124
 v_mov_b32 v68, v45
 v_mov_b32 v69, v45
 MP 140, 108, 120
 RA 108, 47, 27648
 s_waitcnt lgkmcnt(4)
 v_mov_b32 v70, v45
 s_add_u32 s24, s58, 0
 s_lshl_b32 s3, s21, 1
 MP 144, 112, 120
 v_mov_b32 v71, v45
 v_mov_b32 v32, v34
 MP 208, 112, 124
 RA 112, 47, 28672
 v_cmp_gt_i32 s[32:33], 0, v104
 v_cmp_gt_i32 s[34:35], 1, v104
 s_add_u32 s3, s3, 0
 s_add_u32 m0, s3, s53
 s_nop 0
 MP 212, 116, 124
 v_cmp_gt_i32 s[36:37], 2, v104
 v_cndmask_b32 v72, v72, v45, s[32:33]
 DMA 16, 44, 24, 0
 MP 148, 116, 120
 RA 116, 47, 29696
 v_cmp_gt_i32 s[38:39], 3, v104
 MP 152, 120, 120
 v_cndmask_b32 v73, v73, v45, s[34:35]
 v_exp_f32 v56, v72
 DMA 17, 44, 24, 1024
 MP 216, 120, 124
 RA 120, 47, 30720
 v_cmp_gt_i32 s[32:33], 16, v104
 v_cndmask_b32 v74, v74, v45, s[36:37]
 MP 220, 124, 124
 v_exp_f32 v57, v73
 v_add_f32 v33, v35, v56
 DMA 18, 44, 24, 2048
 MP 156, 124, 120
 RA 124, 47, 31744
 s_waitcnt lgkmcnt(4)
 v_cmp_gt_i32 s[34:35], 17, v104
 MP 160, 96, 120
 v_cndmask_b32 v75, v75, v45, s[38:39]
 v_exp_f32 v58, v74
 DMA 19, 44, 24, 3072
 MP 224, 96, 124
 v_add_u32 v47, s19, v39
 RA 96, 47, 0
 v_add_f32 v33, v33, v57
 CV 116, 56, 57
 MP 228, 100, 124
 v_cmp_gt_i32 s[36:37], 18, v104
 v_cndmask_b32 v76, v76, v45, s[32:33]
 s_add_u32 s24, s58, 28672
 s_lshl_b32 s3, s21, 1
 MP 164, 100, 120
 RA 100, 47, 1024
 v_exp_f32 v59, v75
 MP 168, 104, 120
 v_add_f32 v33, v33, v58
 v_cmp_gt_i32 s[38:39], 19, v104
 s_add_u32 s3, s3, 4096
 s_add_u32 m0, s3, s53
 s_nop 0
 MP 232, 104, 124
 RA 104, 47, 2048
 v_cndmask_b32 v77, v77, v45, s[34:35]
 v_exp_f32 v60, v76
 DMA 16, 44, 24, 0
 MP 236, 108, 124
 v_add_f32 v33, v33, v59
 CV 117, 58, 59
 MP 172, 108, 120
 RA 108, 47, 3072
 s_waitcnt lgkmcnt(4)
 v_cndmask_b32 v78, v78, v45, s[36:37]
 DMA 17, 44, 24, 1024
 MP 176, 112, 120
 v_exp_f32 v61, v77
 v_add_f32 v33, v33, v60
 MP 240, 112, 124
 RA 112, 47, 4096
 v_cndmask_b32 v79, v79, v45, s[38:39]
 v_exp_f32 v62, v78
 DMA 18, 44, 24, 2048
 MP 244, 116, 124
 v_add_f32 v33, v33, v61
 CV 118, 60, 61
 MP 180, 116, 120
 RA 116, 47, 5120
 v_exp_f32 v63, v79
 DMA 19, 44, 24, 3072
 MP 184, 120, 120
 v_add_f32 v33, v33, v62
 v_add_f32 v33, v33, v63
 MP 248, 120, 124
 RA 120, 47, 6144
 CV 119, 62, 63
 v_max_f32 v2, v32, v33
 s_cmp_lg_u32 s64, 0
 s_cselect_b32 s3, s61, 1879048192
 buffer_load_dwordx4 a[80:83], v39, s[8:11], s3 offen offset:0 sc1
 buffer_load_dwordx4 a[84:87], v39, s[8:11], s3 offen offset:1024 sc1
 buffer_load_dwordx4 a[88:91], v39, s[8:11], s3 offen offset:2048 sc1
 MP 252, 124, 124
 v_cmp_lt_f32 vcc, s23, v2
 MP 188, 124, 120
 RA 124, 47, 7168
 s_cbranch_vccnz P2_RS10
P2_RB10:
 s_waitcnt lgkmcnt(4)
 MP 192, 96, 116
 RA 96, 47, 8192
 v_mov_b32 v2, v32
 MP 196, 100, 116
 RA 100, 47, 9216
 v_mov_b32 v3, v33
 MP 200, 104, 116
 RA 104, 47, 10240
 s_nop 0
 MP 204, 108, 116
 RA 108, 47, 11264
 v_permlane32_swap_b32 v2, v32
 s_waitcnt lgkmcnt(4)
 MP 208, 112, 116
 RA 112, 47, 12288
 v_permlane32_swap_b32 v3, v33
 MP 212, 116, 116
 RA 116, 47, 13312
 s_nop 0
 MP 216, 120, 116
 RA 120, 47, 14336
 v_add_f32 v32, v32, v2
 MP 220, 124, 116
 RA 124, 47, 15360
 v_add_f32 v33, v33, v3
 s_waitcnt lgkmcnt(4)
 MP 224, 96, 116
 v_mov_b32 v2, v32
 MP 228, 100, 116
 v_mov_b32 v3, v33
 MP 232, 104, 116
 s_nop 0
 MP 236, 108, 116
 v_permlane16_swap_b32 v2, v32
 s_waitcnt lgkmcnt(0)
 MP 240, 112, 116
 v_permlane16_swap_b32 v3, v33
 MP 244, 116, 116
 s_nop 0
 MP 248, 120, 116
 v_add_f32 v32, v32, v2
 MP 252, 124, 116
 v_add_f32 v33, v33, v3
 s_nop 0
P2_EPI:
 s_cmp_eq_u32 s12, 2
 s_cbranch_scc1 P2_MERGE
 v_rcp_f32 v2, v32
 v_rcp_f32 v4, v33
 s_nop 0
 v_mul_f32 v2, v2, v40
 v_mul_f32 v4, v4, v41
 PKM 128, 2
 PKM 130, 2
 PKM 132, 2
 PKM 134, 2
 CV 128, 128, 129
 CV 129, 130, 131
 CV 130, 132, 133
 CV 131, 134, 135
 PKM 136, 2
 PKM 138, 2
 PKM 140, 2
 PKM 142, 2
 CV 136, 136, 137
 CV 137, 138, 139
 CV 138, 140, 141
 CV 139, 142, 143
 PKM 144, 2
 PKM 146, 2
 PKM 148, 2
 PKM 150, 2
 CV 144, 144, 145
 CV 145, 146, 147
 CV 146, 148, 149
 CV 147, 150, 151
 PKM 152, 2
 PKM 154, 2
 PKM 156, 2
 PKM 158, 2
 CV 152, 152, 153
 CV 153, 154, 155
 CV 154, 156, 157
 CV 155, 158, 159
 PKM 160, 2
 PKM 162, 2
 PKM 164, 2
 PKM 166, 2
 CV 160, 160, 161
 CV 161, 162, 163
 CV 162, 164, 165
 CV 163, 166, 167
 PKM 168, 2
 PKM 170, 2
 PKM 172, 2
 PKM 174, 2
 CV 168, 168, 169
 CV 169, 170, 171
 CV 170, 172, 173
 CV 171, 174, 175
 PKM 176, 2
 PKM 178, 2
 PKM 180, 2
 PKM 182, 2
 CV 176, 176, 177
 CV 177, 178, 179
 CV 178, 180, 181
 CV 179, 182, 183
 PKM 184, 2
 PKM 186, 2
 PKM 188, 2
 PKM 190, 2
 CV 184, 184, 185
 CV 185, 186, 187
 CV 186, 188, 189
 CV 187, 190, 191
 PKM 192, 4
 PKM 194, 4
 PKM 196, 4
 PKM 198, 4
 CV 192, 192, 193
 CV 193, 194, 195
 CV 194, 196, 197
 CV 195, 198, 199
 PKM 200, 4
 PKM 202, 4
 PKM 204, 4
 PKM 206, 4
 CV 200, 200, 201
 CV 201, 202, 203
 CV 202, 204, 205
 CV 203, 206, 207
 PKM 208, 4
 PKM 210, 4
 PKM 212, 4
 PKM 214, 4
 CV 208, 208, 209
 CV 209, 210, 211
 CV 210, 212, 213
 CV 211, 214, 215
 PKM 216, 4
 PKM 218, 4
 PKM 220, 4
 PKM 222, 4
 CV 216, 216, 217
 CV 217, 218, 219
 CV 218, 220, 221
 CV 219, 222, 223
 PKM 224, 4
 PKM 226, 4
 PKM 228, 4
 PKM 230, 4
 CV 224, 224, 225
 CV 225, 226, 227
 CV 226, 228, 229
 CV 227, 230, 231
 PKM 232, 4
 PKM 234, 4
 PKM 236, 4
 PKM 238, 4
 CV 232, 232, 233
 CV 233, 234, 235
 CV 234, 236, 237
 CV 235, 238, 239
 PKM 240, 4
 PKM 242, 4
 PKM 244, 4
 PKM 246, 4
 CV 240, 240, 241
 CV 241, 242, 243
 CV 242, 244, 245
 CV 243, 246, 247
 PKM 248, 4
 PKM 250, 4
 PKM 252, 4
 PKM 254, 4
 CV 248, 248, 249
 CV 249, 250, 251
 CV 250, 252, 253
 CV 251, 254, 255
 s_branch P2_OPJ
P2_MERGE:
 s_cmp_lg_u32 s57, 0
 s_cbranch_scc1 P2_GOT
 s_lshl_b32 s26, s28, 7
 s_add_u32 s26, s26, 78774272
 v_mov_b32 v3, 0
P2_POLL:
 buffer_load_dword v2, v3, s[8:11], s26 offen sc1
 s_waitcnt vmcnt(0)
 v_readfirstlane_b32 s3, v2
 s_cmp_lg_u32 s3, 0
 s_cbranch_scc1 P2_GOT0
 s_sleep 4
 s_branch P2_POLL
P2_GOT0:
 s_mul_i32 s26, s28, 66560
 s_lshl_b32 s3, s4, 14
 s_add_u32 s26, s26, s3
 s_add_u32 s26, s26, 79691776
 s_lshl_b32 s25, s28, 12
 s_lshl_b32 s3, s4, 10
 s_add_u32 s25, s25, s3
 s_add_u32 s25, s25, 78905344
 buffer_load_dwordx4 v[8:11], v39, s[8:11], s25 offen sc1
 buffer_load_dwordx4 a[128:131], v39, s[8:11], s26 offen offset:0 sc1
 buffer_load_dwordx4 a[132:135], v39, s[8:11], s26 offen offset:1024 sc1
 buffer_load_dwordx4 a[136:139], v39, s[8:11], s26 offen offset:2048 sc1
 buffer_load_dwordx4 a[140:143], v39, s[8:11], s26 offen offset:3072 sc1
 s_add_u32 s26, s26, 4096
 buffer_load_dwordx4 a[144:147], v39, s[8:11], s26 offen offset:0 sc1
 buffer_load_dwordx4 a[148:151], v39, s[8:11], s26 offen offset:1024 sc1
 buffer_load_dwordx4 a[152:155], v39, s[8:11], s26 offen offset:2048 sc1
 buffer_load_dwordx4 a[156:159], v39, s[8:11], s26 offen offset:3072 sc1
 s_add_u32 s26, s26, 4096
 buffer_load_dwordx4 a[160:163], v39, s[8:11], s26 offen offset:0 sc1
 buffer_load_dwordx4 a[164:167], v39, s[8:11], s26 offen offset:1024 sc1
 buffer_load_dwordx4 a[168:171], v39, s[8:11], s26 offen offset:2048 sc1
 buffer_load_dwordx4 a[172:175], v39, s[8:11], s26 offen offset:3072 sc1
 s_add_u32 s26, s26, 4096
 buffer_load_dwordx4 a[176:179], v39, s[8:11], s26 offen offset:0 sc1
 buffer_load_dwordx4 a[180:183], v39, s[8:11], s26 offen offset:1024 sc1
 buffer_load_dwordx4 a[184:187], v39, s[8:11], s26 offen offset:2048 sc1
 buffer_load_dwordx4 a[188:191], v39, s[8:11], s26 offen offset:3072 sc1
 s_waitcnt vmcnt(0)
P2_GOT:
 s_waitcnt vmcnt(19)
 v_max_f32 v64, v8, v36
 v_max_f32 v65, v9, v37
 v_sub_f32 v8, v8, v64
 v_sub_f32 v9, v9, v65
 v_sub_f32 v66, v36, v64
 v_sub_f32 v67, v37, v65
 v_exp_f32 v8, v8
 v_exp_f32 v9, v9
 v_exp_f32 v66, v66
 v_exp_f32 v67, v67
 v_mul_f32 v8, v8, v10
 v_mul_f32 v9, v9, v11
 v_fma_f32 v64, v66, v32, v8
 v_fma_f32 v65, v67, v33, v9
 v_rcp_f32 v64, v64
 v_rcp_f32 v65, v65
 s_mov_b32 s26, 0xffff0000
 v_mul_f32 v64, v64, v40
 v_mul_f32 v65, v65, v41
 v_mul_f32 v12, v8, v64
 v_mul_f32 v14, v9, v65
 v_mul_f32 v2, v66, v64
 v_mul_f32 v4, v67, v65
 v_accvgpr_read_b32 v49, a128
 v_accvgpr_read_b32 v51, a129
 v_accvgpr_read_b32 v53, a130
 v_accvgpr_read_b32 v55, a131
 PKM 128, 2
 PKM 130, 2
 PKM 132, 2
 PKM 134, 2
 v_lshlrev_b32 v48, 16, v49
 v_lshlrev_b32 v50, 16, v51
 v_lshlrev_b32 v52, 16, v53
 v_lshlrev_b32 v54, 16, v55
 v_and_b32 v49, s26, v49
 v_and_b32 v51, s26, v51
 v_and_b32 v53, s26, v53
 v_and_b32 v55, s26, v55
 v_pk_fma_f32 v[128:129], v[48:49], v[12:13], v[128:129] op_sel_hi:[1,0,1]
 v_pk_fma_f32 v[130:131], v[50:51], v[12:13], v[130:131] op_sel_hi:[1,0,1]
 v_pk_fma_f32 v[132:133], v[52:53], v[12:13], v[132:133] op_sel_hi:[1,0,1]
 v_pk_fma_f32 v[134:135], v[54:55], v[12:13], v[134:135] op_sel_hi:[1,0,1]
 CV 128, 128, 129
 CV 129, 130, 131
 CV 130, 132, 133
 CV 131, 134, 135
 v_accvgpr_read_b32 v49, a132
 v_accvgpr_read_b32 v51, a133
 v_accvgpr_read_b32 v53, a134
 v_accvgpr_read_b32 v55, a135
 PKM 136, 2
 PKM 138, 2
 PKM 140, 2
 PKM 142, 2
 v_lshlrev_b32 v48, 16, v49
 v_lshlrev_b32 v50, 16, v51
 v_lshlrev_b32 v52, 16, v53
 v_lshlrev_b32 v54, 16, v55
 v_and_b32 v49, s26, v49
 v_and_b32 v51, s26, v51
 v_and_b32 v53, s26, v53
 v_and_b32 v55, s26, v55
 v_pk_fma_f32 v[136:137], v[48:49], v[12:13], v[136:137] op_sel_hi:[1,0,1]
 v_pk_fma_f32 v[138:139], v[50:51], v[12:13], v[138:139] op_sel_hi:[1,0,1]
 v_pk_fma_f32 v[140:141], v[52:53], v[12:13], v[140:141] op_sel_hi:[1,0,1]
 v_pk_fma_f32 v[142:143], v[54:55], v[12:13], v[142:143] op_sel_hi:[1,0,1]
 CV 136, 136, 137
 CV 137, 138, 139
 CV 138, 140, 141
 CV 139, 142, 143
 v_accvgpr_read_b32 v49, a136
 v_accvgpr_read_b32 v51, a137
 v_accvgpr_read_b32 v53, a138
 v_accvgpr_read_b32 v55, a139
 PKM 144, 2
 PKM 146, 2
 PKM 148, 2
 PKM 150, 2
 v_lshlrev_b32 v48, 16, v49
 v_lshlrev_b32 v50, 16, v51
 v_lshlrev_b32 v52, 16, v53
 v_lshlrev_b32 v54, 16, v55
 v_and_b32 v49, s26, v49
 v_and_b32 v51, s26, v51
 v_and_b32 v53, s26, v53
 v_and_b32 v55, s26, v55
 v_pk_fma_f32 v[144:145], v[48:49], v[12:13], v[144:145] op_sel_hi:[1,0,1]
 v_pk_fma_f32 v[146:147], v[50:51], v[12:13], v[146:147] op_sel_hi:[1,0,1]
 v_pk_fma_f32 v[148:149], v[52:53], v[12:13], v[148:149] op_sel_hi:[1,0,1]
 v_pk_fma_f32 v[150:151], v[54:55], v[12:13], v[150:151] op_sel_hi:[1,0,1]
 CV 144, 144, 145
 CV 145, 146, 147
 CV 146, 148, 149
 CV 147, 150, 151
 v_accvgpr_read_b32 v49, a140
 v_accvgpr_read_b32 v51, a141
 v_accvgpr_read_b32 v53, a142
 v_accvgpr_read_b32 v55, a143
 PKM 152, 2
 PKM 154, 2
 PKM 156, 2
 PKM 158, 2
 v_lshlrev_b32 v48, 16, v49
 v_lshlrev_b32 v50, 16, v51
 v_lshlrev_b32 v52, 16, v53
 v_lshlrev_b32 v54, 16, v55
 v_and_b32 v49, s26, v49
 v_and_b32 v51, s26, v51
 v_and_b32 v53, s26, v53
 v_and_b32 v55, s26, v55
 v_pk_fma_f32 v[152:153], v[48:49], v[12:13], v[152:153] op_sel_hi:[1,0,1]
 v_pk_fma_f32 v[154:155], v[50:51], v[12:13], v[154:155] op_sel_hi:[1,0,1]
 v_pk_fma_f32 v[156:157], v[52:53], v[12:13], v[156:157] op_sel_hi:[1,0,1]
 v_pk_fma_f32 v[158:159], v[54:55], v[12:13], v[158:159] op_sel_hi:[1,0,1]
 CV 152, 152, 153
 CV 153, 154, 155
 CV 154, 156, 157
 CV 155, 158, 159
 v_accvgpr_read_b32 v49, a144
 v_accvgpr_read_b32 v51, a145
 v_accvgpr_read_b32 v53, a146
 v_accvgpr_read_b32 v55, a147
 PKM 160, 2
 PKM 162, 2
 PKM 164, 2
 PKM 166, 2
 v_lshlrev_b32 v48, 16, v49
 v_lshlrev_b32 v50, 16, v51
 v_lshlrev_b32 v52, 16, v53
 v_lshlrev_b32 v54, 16, v55
 v_and_b32 v49, s26, v49
 v_and_b32 v51, s26, v51
 v_and_b32 v53, s26, v53
 v_and_b32 v55, s26, v55
 v_pk_fma_f32 v[160:161], v[48:49], v[12:13], v[160:161] op_sel_hi:[1,0,1]
 v_pk_fma_f32 v[162:163], v[50:51], v[12:13], v[162:163] op_sel_hi:[1,0,1]
 v_pk_fma_f32 v[164:165], v[52:53], v[12:13], v[164:165] op_sel_hi:[1,0,1]
 v_pk_fma_f32 v[166:167], v[54:55], v[12:13], v[166:167] op_sel_hi:[1,0,1]
 CV 160, 160, 161
 CV 161, 162, 163
 CV 162, 164, 165
 CV 163, 166, 167
 v_accvgpr_read_b32 v49, a148
 v_accvgpr_read_b32 v51, a149
 v_accvgpr_read_b32 v53, a150
 v_accvgpr_read_b32 v55, a151
 PKM 168, 2
 PKM 170, 2
 PKM 172, 2
 PKM 174, 2
 v_lshlrev_b32 v48, 16, v49
 v_lshlrev_b32 v50, 16, v51
 v_lshlrev_b32 v52, 16, v53
 v_lshlrev_b32 v54, 16, v55
 v_and_b32 v49, s26, v49
 v_and_b32 v51, s26, v51
 v_and_b32 v53, s26, v53
 v_and_b32 v55, s26, v55
 v_pk_fma_f32 v[168:169], v[48:49], v[12:13], v[168:169] op_sel_hi:[1,0,1]
 v_pk_fma_f32 v[170:171], v[50:51], v[12:13], v[170:171] op_sel_hi:[1,0,1]
 v_pk_fma_f32 v[172:173], v[52:53], v[12:13], v[172:173] op_sel_hi:[1,0,1]
 v_pk_fma_f32 v[174:175], v[54:55], v[12:13], v[174:175] op_sel_hi:[1,0,1]
 CV 168, 168, 169
 CV 169, 170, 171
 CV 170, 172, 173
 CV 171, 174, 175
 v_accvgpr_read_b32 v49, a152
 v_accvgpr_read_b32 v51, a153
 v_accvgpr_read_b32 v53, a154
 v_accvgpr_read_b32 v55, a155
 PKM 176, 2
 PKM 178, 2
 PKM 180, 2
 PKM 182, 2
 v_lshlrev_b32 v48, 16, v49
 v_lshlrev_b32 v50, 16, v51
 v_lshlrev_b32 v52, 16, v53
 v_lshlrev_b32 v54, 16, v55
 v_and_b32 v49, s26, v49
 v_and_b32 v51, s26, v51
 v_and_b32 v53, s26, v53
 v_and_b32 v55, s26, v55
 v_pk_fma_f32 v[176:177], v[48:49], v[12:13], v[176:177] op_sel_hi:[1,0,1]
 v_pk_fma_f32 v[178:179], v[50:51], v[12:13], v[178:179] op_sel_hi:[1,0,1]
 v_pk_fma_f32 v[180:181], v[52:53], v[12:13], v[180:181] op_sel_hi:[1,0,1]
 v_pk_fma_f32 v[182:183], v[54:55], v[12:13], v[182:183] op_sel_hi:[1,0,1]
 CV 176, 176, 177
 CV 177, 178, 179
 CV 178, 180, 181
 CV 179, 182, 183
 v_accvgpr_read_b32 v49, a156
 v_accvgpr_read_b32 v51, a157
 v_accvgpr_read_b32 v53, a158
 v_accvgpr_read_b32 v55, a159
 PKM 184, 2
 PKM 186, 2
 PKM 188, 2
 PKM 190, 2
 v_lshlrev_b32 v48, 16, v49
 v_lshlrev_b32 v50, 16, v51
 v_lshlrev_b32 v52, 16, v53
 v_lshlrev_b32 v54, 16, v55
 v_and_b32 v49, s26, v49
 v_and_b32 v51, s26, v51
 v_and_b32 v53, s26, v53
 v_and_b32 v55, s26, v55
 v_pk_fma_f32 v[184:185], v[48:49], v[12:13], v[184:185] op_sel_hi:[1,0,1]
 v_pk_fma_f32 v[186:187], v[50:51], v[12:13], v[186:187] op_sel_hi:[1,0,1]
 v_pk_fma_f32 v[188:189], v[52:53], v[12:13], v[188:189] op_sel_hi:[1,0,1]
 v_pk_fma_f32 v[190:191], v[54:55], v[12:13], v[190:191] op_sel_hi:[1,0,1]
 CV 184, 184, 185
 CV 185, 186, 187
 CV 186, 188, 189
 CV 187, 190, 191
 v_accvgpr_read_b32 v49, a160
 v_accvgpr_read_b32 v51, a161
 v_accvgpr_read_b32 v53, a162
 v_accvgpr_read_b32 v55, a163
 PKM 192, 4
 PKM 194, 4
 PKM 196, 4
 PKM 198, 4
 v_lshlrev_b32 v48, 16, v49
 v_lshlrev_b32 v50, 16, v51
 v_lshlrev_b32 v52, 16, v53
 v_lshlrev_b32 v54, 16, v55
 v_and_b32 v49, s26, v49
 v_and_b32 v51, s26, v51
 v_and_b32 v53, s26, v53
 v_and_b32 v55, s26, v55
 v_pk_fma_f32 v[192:193], v[48:49], v[14:15], v[192:193] op_sel_hi:[1,0,1]
 v_pk_fma_f32 v[194:195], v[50:51], v[14:15], v[194:195] op_sel_hi:[1,0,1]
 v_pk_fma_f32 v[196:197], v[52:53], v[14:15], v[196:197] op_sel_hi:[1,0,1]
 v_pk_fma_f32 v[198:199], v[54:55], v[14:15], v[198:199] op_sel_hi:[1,0,1]
 CV 192, 192, 193
 CV 193, 194, 195
 CV 194, 196, 197
 CV 195, 198, 199
 v_accvgpr_read_b32 v49, a164
 v_accvgpr_read_b32 v51, a165
 v_accvgpr_read_b32 v53, a166
 v_accvgpr_read_b32 v55, a167
 PKM 200, 4
 PKM 202, 4
 PKM 204, 4
 PKM 206, 4
 v_lshlrev_b32 v48, 16, v49
 v_lshlrev_b32 v50, 16, v51
 v_lshlrev_b32 v52, 16, v53
 v_lshlrev_b32 v54, 16, v55
 v_and_b32 v49, s26, v49
 v_and_b32 v51, s26, v51
 v_and_b32 v53, s26, v53
 v_and_b32 v55, s26, v55
 v_pk_fma_f32 v[200:201], v[48:49], v[14:15], v[200:201] op_sel_hi:[1,0,1]
 v_pk_fma_f32 v[202:203], v[50:51], v[14:15], v[202:203] op_sel_hi:[1,0,1]
 v_pk_fma_f32 v[204:205], v[52:53], v[14:15], v[204:205] op_sel_hi:[1,0,1]
 v_pk_fma_f32 v[206:207], v[54:55], v[14:15], v[206:207] op_sel_hi:[1,0,1]
 CV 200, 200, 201
 CV 201, 202, 203
 CV 202, 204, 205
 CV 203, 206, 207
 v_accvgpr_read_b32 v49, a168
 v_accvgpr_read_b32 v51, a169
 v_accvgpr_read_b32 v53, a170
 v_accvgpr_read_b32 v55, a171
 PKM 208, 4
 PKM 210, 4
 PKM 212, 4
 PKM 214, 4
 v_lshlrev_b32 v48, 16, v49
 v_lshlrev_b32 v50, 16, v51
 v_lshlrev_b32 v52, 16, v53
 v_lshlrev_b32 v54, 16, v55
 v_and_b32 v49, s26, v49
 v_and_b32 v51, s26, v51
 v_and_b32 v53, s26, v53
 v_and_b32 v55, s26, v55
 v_pk_fma_f32 v[208:209], v[48:49], v[14:15], v[208:209] op_sel_hi:[1,0,1]
 v_pk_fma_f32 v[210:211], v[50:51], v[14:15], v[210:211] op_sel_hi:[1,0,1]
 v_pk_fma_f32 v[212:213], v[52:53], v[14:15], v[212:213] op_sel_hi:[1,0,1]
 v_pk_fma_f32 v[214:215], v[54:55], v[14:15], v[214:215] op_sel_hi:[1,0,1]
 CV 208, 208, 209
 CV 209, 210, 211
 CV 210, 212, 213
 CV 211, 214, 215
 v_accvgpr_read_b32 v49, a172
 v_accvgpr_read_b32 v51, a173
 v_accvgpr_read_b32 v53, a174
 v_accvgpr_read_b32 v55, a175
 PKM 216, 4
 PKM 218, 4
 PKM 220, 4
 PKM 222, 4
 v_lshlrev_b32 v48, 16, v49
 v_lshlrev_b32 v50, 16, v51
 v_lshlrev_b32 v52, 16, v53
 v_lshlrev_b32 v54, 16, v55
 v_and_b32 v49, s26, v49
 v_and_b32 v51, s26, v51
 v_and_b32 v53, s26, v53
 v_and_b32 v55, s26, v55
 v_pk_fma_f32 v[216:217], v[48:49], v[14:15], v[216:217] op_sel_hi:[1,0,1]
 v_pk_fma_f32 v[218:219], v[50:51], v[14:15], v[218:219] op_sel_hi:[1,0,1]
 v_pk_fma_f32 v[220:221], v[52:53], v[14:15], v[220:221] op_sel_hi:[1,0,1]
 v_pk_fma_f32 v[222:223], v[54:55], v[14:15], v[222:223] op_sel_hi:[1,0,1]
 CV 216, 216, 217
 CV 217, 218, 219
 CV 218, 220, 221
 CV 219, 222, 223
 v_accvgpr_read_b32 v49, a176
 v_accvgpr_read_b32 v51, a177
 v_accvgpr_read_b32 v53, a178
 v_accvgpr_read_b32 v55, a179
 PKM 224, 4
 PKM 226, 4
 PKM 228, 4
 PKM 230, 4
 v_lshlrev_b32 v48, 16, v49
 v_lshlrev_b32 v50, 16, v51
 v_lshlrev_b32 v52, 16, v53
 v_lshlrev_b32 v54, 16, v55
 v_and_b32 v49, s26, v49
 v_and_b32 v51, s26, v51
 v_and_b32 v53, s26, v53
 v_and_b32 v55, s26, v55
 v_pk_fma_f32 v[224:225], v[48:49], v[14:15], v[224:225] op_sel_hi:[1,0,1]
 v_pk_fma_f32 v[226:227], v[50:51], v[14:15], v[226:227] op_sel_hi:[1,0,1]
 v_pk_fma_f32 v[228:229], v[52:53], v[14:15], v[228:229] op_sel_hi:[1,0,1]
 v_pk_fma_f32 v[230:231], v[54:55], v[14:15], v[230:231] op_sel_hi:[1,0,1]
 CV 224, 224, 225
 CV 225, 226, 227
 CV 226, 228, 229
 CV 227, 230, 231
 v_accvgpr_read_b32 v49, a180
 v_accvgpr_read_b32 v51, a181
 v_accvgpr_read_b32 v53, a182
 v_accvgpr_read_b32 v55, a183
 PKM 232, 4
 PKM 234, 4
 PKM 236, 4
 PKM 238, 4
 v_lshlrev_b32 v48, 16, v49
 v_lshlrev_b32 v50, 16, v51
 v_lshlrev_b32 v52, 16, v53
 v_lshlrev_b32 v54, 16, v55
 v_and_b32 v49, s26, v49
 v_and_b32 v51, s26, v51
 v_and_b32 v53, s26, v53
 v_and_b32 v55, s26, v55
 v_pk_fma_f32 v[232:233], v[48:49], v[14:15], v[232:233] op_sel_hi:[1,0,1]
 v_pk_fma_f32 v[234:235], v[50:51], v[14:15], v[234:235] op_sel_hi:[1,0,1]
 v_pk_fma_f32 v[236:237], v[52:53], v[14:15], v[236:237] op_sel_hi:[1,0,1]
 v_pk_fma_f32 v[238:239], v[54:55], v[14:15], v[238:239] op_sel_hi:[1,0,1]
 CV 232, 232, 233
 CV 233, 234, 235
 CV 234, 236, 237
 CV 235, 238, 239
 v_accvgpr_read_b32 v49, a184
 v_accvgpr_read_b32 v51, a185
 v_accvgpr_read_b32 v53, a186
 v_accvgpr_read_b32 v55, a187
 PKM 240, 4
 PKM 242, 4
 PKM 244, 4
 PKM 246, 4
 v_lshlrev_b32 v48, 16, v49
 v_lshlrev_b32 v50, 16, v51
 v_lshlrev_b32 v52, 16, v53
 v_lshlrev_b32 v54, 16, v55
 v_and_b32 v49, s26, v49
 v_and_b32 v51, s26, v51
 v_and_b32 v53, s26, v53
 v_and_b32 v55, s26, v55
 v_pk_fma_f32 v[240:241], v[48:49], v[14:15], v[240:241] op_sel_hi:[1,0,1]
 v_pk_fma_f32 v[242:243], v[50:51], v[14:15], v[242:243] op_sel_hi:[1,0,1]
 v_pk_fma_f32 v[244:245], v[52:53], v[14:15], v[244:245] op_sel_hi:[1,0,1]
 v_pk_fma_f32 v[246:247], v[54:55], v[14:15], v[246:247] op_sel_hi:[1,0,1]
 CV 240, 240, 241
 CV 241, 242, 243
 CV 242, 244, 245
 CV 243, 246, 247
 v_accvgpr_read_b32 v49, a188
 v_accvgpr_read_b32 v51, a189
 v_accvgpr_read_b32 v53, a190
 v_accvgpr_read_b32 v55, a191
 PKM 248, 4
 PKM 250, 4
 PKM 252, 4
 PKM 254, 4
 v_lshlrev_b32 v48, 16, v49
 v_lshlrev_b32 v50, 16, v51
 v_lshlrev_b32 v52, 16, v53
 v_lshlrev_b32 v54, 16, v55
 v_and_b32 v49, s26, v49
 v_and_b32 v51, s26, v51
 v_and_b32 v53, s26, v53
 v_and_b32 v55, s26, v55
 v_pk_fma_f32 v[248:249], v[48:49], v[14:15], v[248:249] op_sel_hi:[1,0,1]
 v_pk_fma_f32 v[250:251], v[50:51], v[14:15], v[250:251] op_sel_hi:[1,0,1]
 v_pk_fma_f32 v[252:253], v[52:53], v[14:15], v[252:253] op_sel_hi:[1,0,1]
 v_pk_fma_f32 v[254:255], v[54:55], v[14:15], v[254:255] op_sel_hi:[1,0,1]
 CV 248, 248, 249
 CV 249, 250, 251
 CV 250, 252, 253
 CV 251, 254, 255
P2_OPJ:
 s_cmp_lg_u32 s64, 0
 s_cbranch_scc1 P2_KOK
 v_mov_b32 v3, 0
 s_lshl_b32 s24, s5, 7
 s_add_u32 s24, s24, 78790656
P2_PL3:
 buffer_load_dword v9, v3, s[8:11], s24 offen sc1
 s_waitcnt vmcnt(0)
 v_cmp_eq_u32 vcc, 0, v9
 s_nop 1
 s_cbranch_vccz P2_PK3
 s_sleep 1
 s_branch P2_PL3
P2_PK3:
 buffer_load_dwordx4 a[80:83], v39, s[8:11], s61 offen offset:0 sc1
 buffer_load_dwordx4 a[84:87], v39, s[8:11], s61 offen offset:1024 sc1
 buffer_load_dwordx4 a[88:91], v39, s[8:11], s61 offen offset:2048 sc1
P2_KOK:
 s_waitcnt vmcnt(0)
 MVZ 64, 80, 48
 MVZ 68, 84, 48
 MVZ 72, 88, 48
 MVZ 76, 80, 52
 MVZ 80, 84, 52
 MVZ 84, 88, 52
 v_add_u32 v24, s53, v20
 v_add_u32 v28, s52, v20
 v_add_u32 v25, s53, v21
 v_add_u32 v29, s52, v21
 v_add_u32 v26, s53, v22
 v_add_u32 v30, s52, v22
 v_add_u32 v27, s53, v23
 v_add_u32 v31, s52, v23
 s_mov_b32 s26, 0x358637bd
 v_sub_f32 v40, 1.0, v40
 v_sub_f32 v41, 1.0, v41
 v_add_f32 v72, s26, v72
 v_add_f32 v84, s26, v84
 v_rcp_f32 v72, v72
 v_rcp_f32 v84, v84
 s_nop 0
 v_mul_f32 v72, v72, v40
 v_mul_f32 v84, v84, v41
 PKM 64, 72
 PKM 66, 72
 PKM 68, 72
 PKM 70, 72
 CV 132, 64, 65
 CV 133, 66, 67
 CV 134, 68, 69
 CV 135, 70, 71
 PKM 76, 84
 PKM 78, 84
 PKM 80, 84
 PKM 82, 84
 CV 196, 76, 77
 CV 197, 78, 79
 CV 198, 80, 81
 CV 199, 82, 83
 s_mul_i32 s40, s5, 1115136
 s_mul_i32 s3, s13, 69632
 s_add_u32 s40, s40, s3
 s_mul_i32 s3, s4, 17408
 s_add_u32 s40, s40, s3
 s_add_u32 s40, s40, 35651584
 s_mov_b32 s59, s40
 s_sub_u32 s3, 15, s13
 s_add_u32 s42, s13, 128
 s_cmp_ge_u32 s13, 8
 s_cselect_b32 s42, s3, s42
 s_lshl_b32 s3, s5, 3
 s_add_u32 s3, s3, s42
 s_mul_i32 s57, s3, 66560
 s_lshl_b32 s3, s4, 14
 s_add_u32 s57, s57, s3
 s_add_u32 s57, s57, 79691776
 v_add_u32 v38, 8192, v39
 s_mov_b32 s68, s66
 s_mov_b32 s69, s67
 s_mov_b32 s70, 1835008
 s_mov_b32 s71, 0x20000
 s_lshl_b32 s20, s13, 11
 s_add_u32 s20, s20, 78807040
 s_lshl_b32 s3, s5, 7
 s_add_u32 s3, s3, s20
 s_add_u32 s24, s3, 4
 s_cmp_eq_u32 s4, 0
 s_cselect_b32 s27, s3, 0
 s_cselect_b32 s73, s24, 0
 s_lshl_b32 s24, s13, 3
 s_lshr_b32 s3, s5, 1
 s_add_u32 s24, s24, s3
 s_and_b32 s3, s5, 1
 s_lshl_b32 s16, s3, 2
 s_add_u32 s16, s16, s4
 s_mul_i32 s3, s3, 3
 s_add_u32 s14, s3, s4
 s_lshr_b32 s41, s24, 1
 s_mul_i32 s15, s41, 17408
 s_and_b32 s43, s24, 1
 s_lshl_b32 s43, s43, 13
 s_add_u32 s15, s15, s43
 s_lshl_b32 s3, s16, 10
 s_add_u32 s15, s15, s3
 s_add_u32 s15, s15, 35651584
 s_mul_i32 s17, s42, 66560
 s_and_b32 s41, s41, 3
 s_lshl_b32 s41, s41, 14
 s_add_u32 s17, s17, s41
 s_add_u32 s17, s17, s43
 s_lshl_b32 s3, s14, 10
 s_add_u32 s17, s17, s3
 s_add_u32 s17, s17, 79691776
 s_lshr_b32 s3, s5, 2
 s_sub_u32 s24, 7, s3
 s_bitcmp1_b32 s5, 1
 s_cselect_b32 s3, s24, s3
 s_lshl_b32 s24, s13, 3
 s_add_u32 s24, s24, s3
 s_mul_i32 s24, s24, 14336
 s_lshl_b32 s3, s16, 6
 s_add_u32 s18, s24, s3
 s_lshl_b32 s3, s14, 6
 s_add_u32 s19, s24, s3
 s_add_u32 s19, s19, 512
 v_and_b32 v4, 15, v1
 v_lshrrev_b32 v5, 4, v1
 v_mul_u32_u24 v4, 896, v4
 v_lshl_add_u32 v4, v5, 3, v4
 s_mov_b32 s26, 0xffff0000
 s_barrier
 RT 96, 28, 0
 RT 98, 28, 512
 RT 100, 29, 0
 RT 102, 29, 512
 RT 104, 30, 0
 RT 106, 30, 512
 RT 108, 31, 0
 RT 110, 31, 512
 RT 112, 24, 0
 RT 114, 24, 512
 RT 116, 24, 4096
 RT 118, 24, 4608
 s_waitcnt lgkmcnt(8)
 MPZ 64, 96, 132
 RT 120, 24, 8192
 s_add_u32 s24, s58, 128
 s_lshl_b32 s3, s21, 1
 MPZ 80, 96, 196
 RT 122, 24, 8704
 s_add_u32 s3, s3, 0
 s_add_u32 m0, s3, s54
 MPZ 84, 100, 196
 RT 124, 24, 12288
 DMA 16, 44, 24, 0
 MPZ 68, 100, 132
 RT 126, 24, 12800
 DMA 17, 44, 24, 1024
 s_waitcnt lgkmcnt(8)
 MPZ 72, 104, 132
 RT 96, 24, 16384
 DMA 18, 44, 24, 2048
 MPZ 88, 104, 196
 RT 98, 24, 16896
 DMA 19, 44, 24, 3072
 MPZ 92, 108, 196
 RT 100, 24, 20480
 s_add_u32 s24, s58, 28800
 s_lshl_b32 s3, s21, 1
 MPZ 76, 108, 132
 RT 102, 24, 20992
 s_add_u32 s3, s3, 4096
 s_add_u32 m0, s3, s54
 s_waitcnt lgkmcnt(8)
 MP 64, 112, 128
 RT 104, 24, 24576
 DMA 16, 44, 24, 0
 MP 64, 116, 136
 RT 106, 24, 25088
 DMA 17, 44, 24, 1024
 MP 80, 112, 192
 RT 108, 24, 28672
 DMA 18, 44, 24, 2048
 MP 80, 116, 200
 RT 110, 24, 29184
 DMA 19, 44, 24, 3072
 s_waitcnt lgkmcnt(8)
 MP 80, 120, 208
 RT 112, 25, 0
 s_add_u32 s24, s58, 256
 s_lshl_b32 s3, s21, 1
 MP 80, 124, 216
 RT 114, 25, 512
 s_add_u32 s3, s3, 0
 s_add_u32 m0, s3, s55
 MP 64, 120, 144
 RT 116, 25, 4096
 DMA 16, 44, 24, 0
 MP 64, 124, 152
 RT 118, 25, 4608
 DMA 17, 44, 24, 1024
 s_waitcnt lgkmcnt(8)
 MP 64, 96, 160
 RT 120, 25, 8192
 DMA 18, 44, 24, 2048
 MP 64, 100, 168
 RT 122, 25, 8704
 DMA 19, 44, 24, 3072
 MP 80, 96, 224
 RT 124, 25, 12288
 s_add_u32 s24, s58, 28928
 s_lshl_b32 s3, s21, 1
 MP 80, 100, 232
 RT 126, 25, 12800
 s_add_u32 s3, s3, 4096
 s_add_u32 m0, s3, s55
 s_waitcnt lgkmcnt(8)
 MP 80, 104, 240
 RT 96, 25, 16384
 DMA 16, 44, 24, 0
 MP 80, 108, 248
 RT 98, 25, 16896
 DMA 17, 44, 24, 1024
 MP 64, 104, 176
 RT 100, 25, 20480
 DMA 18, 44, 24, 2048
 MP 64, 108, 184
 RT 102, 25, 20992
 DMA 19, 44, 24, 3072
 s_waitcnt lgkmcnt(8)
 MP 68, 112, 128
 RT 104, 25, 24576
 s_add_u32 s24, s58, 384
 s_lshl_b32 s3, s21, 1
 MP 68, 116, 136
 RT 106, 25, 25088
 s_add_u32 s3, s3, 0
 s_add_u32 m0, s3, s56
 MP 84, 112, 192
 RT 108, 25, 28672
 DMA 16, 44, 24, 0
 MP 84, 116, 200
 RT 110, 25, 29184
 DMA 17, 44, 24, 1024
 s_waitcnt lgkmcnt(8)
 MP 84, 120, 208
 RT 112, 26, 0
 DMA 18, 44, 24, 2048
 MP 84, 124, 216
 RT 114, 26, 512
 DMA 19, 44, 24, 3072
 MP 68, 120, 144
 RT 116, 26, 4096
 s_add_u32 s24, s58, 29056
 s_lshl_b32 s3, s21, 1
 MP 68, 124, 152
 RT 118, 26, 4608
 s_add_u32 s3, s3, 4096
 s_add_u32 m0, s3, s56
 s_waitcnt lgkmcnt(8)
 MP 68, 96, 160
 RT 120, 26, 8192
 DMA 16, 44, 24, 0
 MP 68, 100, 168
 RT 122, 26, 8704
 DMA 17, 44, 24, 1024
 MP 84, 96, 224
 RT 124, 26, 12288
 DMA 18, 44, 24, 2048
 MP 84, 100, 232
 RT 126, 26, 12800
 DMA 19, 44, 24, 3072
 s_waitcnt lgkmcnt(8)
 MP 84, 104, 240
 RT 96, 26, 16384
 MP 84, 108, 248
 RT 98, 26, 16896
 MP 68, 104, 176
 RT 100, 26, 20480
 MP 68, 108, 184
 RT 102, 26, 20992
 s_waitcnt lgkmcnt(8)
 MP 72, 112, 128
 RT 104, 26, 24576
 MP 72, 116, 136
 RT 106, 26, 25088
 MP 88, 112, 192
 RT 108, 26, 28672
 MP 88, 116, 200
 RT 110, 26, 29184
 s_waitcnt lgkmcnt(8)
 MP 88, 120, 208
 RT 112, 27, 0
 MP 88, 124, 216
 RT 114, 27, 512
 MP 72, 120, 144
 RT 116, 27, 4096
 MP 72, 124, 152
 RT 118, 27, 4608
 s_waitcnt lgkmcnt(8)
 MP 72, 96, 160
 RT 120, 27, 8192
 MP 72, 100, 168
 RT 122, 27, 8704
 MP 88, 96, 224
 RT 124, 27, 12288
 MP 88, 100, 232
 RT 126, 27, 12800
 s_waitcnt lgkmcnt(8)
 MP 88, 104, 240
 RT 96, 27, 16384
 MP 88, 108, 248
 RT 98, 27, 16896
 MP 72, 104, 176
 RT 100, 27, 20480
 MP 72, 108, 184
 RT 102, 27, 20992
 s_waitcnt lgkmcnt(8)
 MP 76, 112, 128
 RT 104, 27, 24576
 MP 76, 116, 136
 RT 106, 27, 25088
 MP 92, 112, 192
 RT 108, 27, 28672
 MP 92, 116, 200
 RT 110, 27, 29184
 s_waitcnt lgkmcnt(8)
 MP 92, 120, 208
 RT 112, 28, 4096
 v_add_u32 v24, s54, v20
 MP 92, 124, 216
 RT 114, 28, 4608
 v_add_u32 v25, s54, v21
 MP 76, 120, 144
 RT 116, 29, 4096
 v_add_u32 v26, s54, v22
 MP 76, 124, 152
 RT 118, 29, 4608
 v_add_u32 v27, s54, v23
 s_waitcnt lgkmcnt(8)
 MP 76, 96, 160
 RT 120, 30, 4096
 MP 76, 100, 168
 RT 122, 30, 4608
 s_waitcnt vmcnt(16)
 s_barrier
 MP 92, 96, 224
 RT 124, 31, 4096
 MP 92, 100, 232
 RT 126, 31, 4608
 s_waitcnt lgkmcnt(8)
 MP 92, 104, 240
 RT 96, 24, 0
 MP 92, 108, 248
 RT 98, 24, 512
 MP 76, 104, 176
 RT 100, 24, 4096
 MP 76, 108, 184
 RT 102, 24, 4608
 s_waitcnt lgkmcnt(8)
 MPZ 96, 112, 132
 RT 104, 24, 8192
 MPZ 112, 112, 196
 RT 106, 24, 8704
 MPZ 116, 116, 196
 RT 108, 24, 12288
 MPZ 100, 116, 132
 RT 110, 24, 12800
 s_waitcnt lgkmcnt(8)
 MPZ 104, 120, 132
 RT 112, 24, 16384
 MPZ 120, 120, 196
 RT 114, 24, 16896
 MPZ 124, 124, 196
 RT 116, 24, 20480
 MPZ 108, 124, 132
 RT 118, 24, 20992
 s_waitcnt lgkmcnt(8)
 MP 96, 96, 128
 RT 120, 24, 24576
 CV 64, 64, 65
 MP 96, 100, 136
 RT 122, 24, 25088
 CV 65, 66, 67
 MP 112, 96, 192
 RT 124, 24, 28672
 CV 66, 68, 69
 MP 112, 100, 200
 RT 126, 24, 29184
 CV 67, 70, 71
 s_waitcnt lgkmcnt(8)
 MP 112, 104, 208
 RT 96, 25, 0
 buffer_store_dwordx4 v[64:67], v39, s[8:11], s59 offen offset:0 sc1
 MP 112, 108, 216
 RT 98, 25, 512
 CV 72, 72, 73
 MP 96, 104, 144
 RT 100, 25, 4096
 CV 73, 74, 75
 MP 96, 108, 152
 RT 102, 25, 4608
 CV 74, 76, 77
 s_waitcnt lgkmcnt(8)
 MP 96, 112, 160
 RT 104, 25, 8192
 CV 75, 78, 79
 MP 96, 116, 168
 RT 106, 25, 8704
 buffer_store_dwordx4 v[72:75], v39, s[8:11], s59 offen offset:1024 sc1
 MP 112, 112, 224
 RT 108, 25, 12288
 CV 80, 80, 81
 MP 112, 116, 232
 RT 110, 25, 12800
 CV 81, 82, 83
 s_waitcnt lgkmcnt(8)
 MP 112, 120, 240
 RT 112, 25, 16384
 CV 82, 84, 85
 MP 112, 124, 248
 RT 114, 25, 16896
 CV 83, 86, 87
 MP 96, 120, 176
 RT 116, 25, 20480
 buffer_store_dwordx4 v[80:83], v38, s[8:11], s59 offen offset:0 sc1
 MP 96, 124, 184
 RT 118, 25, 20992
 CV 88, 88, 89
 s_waitcnt lgkmcnt(8)
 MP 100, 96, 128
 RT 120, 25, 24576
 CV 89, 90, 91
 MP 100, 100, 136
 RT 122, 25, 25088
 CV 90, 92, 93
 MP 116, 96, 192
 RT 124, 25, 28672
 CV 91, 94, 95
 MP 116, 100, 200
 RT 126, 25, 29184
 buffer_store_dwordx4 v[88:91], v38, s[8:11], s59 offen offset:1024 sc1
 s_waitcnt lgkmcnt(8)
 MP 116, 104, 208
 RT 96, 26, 0
 s_add_u32 s59, s59, 2048
 MP 116, 108, 216
 RT 98, 26, 512
 MP 100, 104, 144
 RT 100, 26, 4096
 MP 100, 108, 152
 RT 102, 26, 4608
 s_waitcnt lgkmcnt(8)
 MP 100, 112, 160
 RT 104, 26, 8192
 MP 100, 116, 168
 RT 106, 26, 8704
 MP 116, 112, 224
 RT 108, 26, 12288
 MP 116, 116, 232
 RT 110, 26, 12800
 s_waitcnt lgkmcnt(8)
 MP 116, 120, 240
 RT 112, 26, 16384
 MP 116, 124, 248
 RT 114, 26, 16896
 MP 100, 120, 176
 RT 116, 26, 20480
 MP 100, 124, 184
 RT 118, 26, 20992
 s_waitcnt lgkmcnt(8)
 MP 104, 96, 128
 RT 120, 26, 24576
 MP 104, 100, 136
 RT 122, 26, 25088
 MP 120, 96, 192
 RT 124, 26, 28672
 MP 120, 100, 200
 RT 126, 26, 29184
 s_waitcnt lgkmcnt(8)
 MP 120, 104, 208
 RT 96, 27, 0
 MP 120, 108, 216
 RT 98, 27, 512
 MP 104, 104, 144
 RT 100, 27, 4096
 MP 104, 108, 152
 RT 102, 27, 4608
 s_waitcnt lgkmcnt(8)
 MP 104, 112, 160
 RT 104, 27, 8192
 MP 104, 116, 168
 RT 106, 27, 8704
 MP 120, 112, 224
 RT 108, 27, 12288
 MP 120, 116, 232
 RT 110, 27, 12800
 s_waitcnt lgkmcnt(8)
 MP 120, 120, 240
 RT 112, 27, 16384
 MP 120, 124, 248
 RT 114, 27, 16896
 MP 104, 120, 176
 RT 116, 27, 20480
 MP 104, 124, 184
 RT 118, 27, 20992
 s_waitcnt lgkmcnt(8)
 MP 108, 96, 128
 RT 120, 27, 24576
 MP 108, 100, 136
 RT 122, 27, 25088
 MP 124, 96, 192
 RT 124, 27, 28672
 MP 124, 100, 200
 RT 126, 27, 29184
 s_waitcnt lgkmcnt(8)
 MP 124, 104, 208
 RT 96, 28, 8192
 v_add_u32 v24, s55, v20
 MP 124, 108, 216
 RT 98, 28, 8704
 v_add_u32 v25, s55, v21
 MP 108, 104, 144
 RT 100, 29, 8192
 v_add_u32 v26, s55, v22
 MP 108, 108, 152
 RT 102, 29, 8704
 v_add_u32 v27, s55, v23
 s_waitcnt lgkmcnt(8)
 MP 108, 112, 160
 RT 104, 30, 8192
 MP 108, 116, 168
 RT 106, 30, 8704
 s_waitcnt vmcnt(12)
 s_barrier
 MP 124, 112, 224
 RT 108, 31, 8192
 s_add_u32 s24, s58, 512
 s_lshl_b32 s3, s21, 1
 MP 124, 116, 232
 RT 110, 31, 8704
 s_add_u32 s3, s3, 0
 s_add_u32 m0, s3, s53
 s_waitcnt lgkmcnt(8)
 MP 124, 120, 240
 RT 112, 24, 0
 DMA 16, 44, 24, 0
 MP 124, 124, 248
 RT 114, 24, 512
 DMA 17, 44, 24, 1024
 MP 108, 120, 176
 RT 116, 24, 4096
 DMA 18, 44, 24, 2048
 MP 108, 124, 184
 RT 118, 24, 4608
 DMA 19, 44, 24, 3072
 s_waitcnt lgkmcnt(8)
 MPZ 64, 96, 132
 RT 120, 24, 8192
 s_add_u32 s24, s58, 29184
 s_lshl_b32 s3, s21, 1
 MPZ 80, 96, 196
 RT 122, 24, 8704
 s_add_u32 s3, s3, 4096
 s_add_u32 m0, s3, s53
 MPZ 84, 100, 196
 RT 124, 24, 12288
 DMA 16, 44, 24, 0
 MPZ 68, 100, 132
 RT 126, 24, 12800
 DMA 17, 44, 24, 1024
 s_waitcnt lgkmcnt(8)
 MPZ 72, 104, 132
 RT 96, 24, 16384
 DMA 18, 44, 24, 2048
 MPZ 88, 104, 196
 RT 98, 24, 16896
 DMA 19, 44, 24, 3072
 MPZ 92, 108, 196
 RT 100, 24, 20480
 MPZ 76, 108, 132
 RT 102, 24, 20992
 s_waitcnt lgkmcnt(8)
 MP 64, 112, 128
 RT 104, 24, 24576
 CV 96, 96, 97
 MP 64, 116, 136
 RT 106, 24, 25088
 CV 97, 98, 99
 MP 80, 112, 192
 RT 108, 24, 28672
 CV 98, 100, 101
 MP 80, 116, 200
 RT 110, 24, 29184
 CV 99, 102, 103
 s_waitcnt lgkmcnt(8)
 MP 80, 120, 208
 RT 112, 25, 0
 buffer_store_dwordx4 v[96:99], v39, s[8:11], s59 offen offset:0 sc1
 MP 80, 124, 216
 RT 114, 25, 512
 CV 104, 104, 105
 MP 64, 120, 144
 RT 116, 25, 4096
 CV 105, 106, 107
 MP 64, 124, 152
 RT 118, 25, 4608
 CV 106, 108, 109
 s_waitcnt lgkmcnt(8)
 MP 64, 96, 160
 RT 120, 25, 8192
 CV 107, 110, 111
 MP 64, 100, 168
 RT 122, 25, 8704
 buffer_store_dwordx4 v[104:107], v39, s[8:11], s59 offen offset:1024 sc1
 MP 80, 96, 224
 RT 124, 25, 12288
 CV 112, 112, 113
 MP 80, 100, 232
 RT 126, 25, 12800
 CV 113, 114, 115
 s_waitcnt lgkmcnt(8)
 MP 80, 104, 240
 RT 96, 25, 16384
 CV 114, 116, 117
 MP 80, 108, 248
 RT 98, 25, 16896
 CV 115, 118, 119
 MP 64, 104, 176
 RT 100, 25, 20480
 buffer_store_dwordx4 v[112:115], v38, s[8:11], s59 offen offset:0 sc1
 MP 64, 108, 184
 RT 102, 25, 20992
 CV 120, 120, 121
 s_waitcnt lgkmcnt(8)
 MP 68, 112, 128
 RT 104, 25, 24576
 CV 121, 122, 123
 MP 68, 116, 136
 RT 106, 25, 25088
 CV 122, 124, 125
 MP 84, 112, 192
 RT 108, 25, 28672
 CV 123, 126, 127
 MP 84, 116, 200
 RT 110, 25, 29184
 buffer_store_dwordx4 v[120:123], v38, s[8:11], s59 offen offset:1024 sc1
 s_waitcnt lgkmcnt(8)
 MP 84, 120, 208
 RT 112, 26, 0
 s_add_u32 s59, s59, 2048
 MP 84, 124, 216
 RT 114, 26, 512
 MP 68, 120, 144
 RT 116, 26, 4096
 MP 68, 124, 152
 RT 118, 26, 4608
 s_waitcnt lgkmcnt(8)
 MP 68, 96, 160
 RT 120, 26, 8192
 MP 68, 100, 168
 RT 122, 26, 8704
 MP 84, 96, 224
 RT 124, 26, 12288
 MP 84, 100, 232
 RT 126, 26, 12800
 s_waitcnt lgkmcnt(8)
 MP 84, 104, 240
 RT 96, 26, 16384
 MP 84, 108, 248
 RT 98, 26, 16896
 MP 68, 104, 176
 RT 100, 26, 20480
 MP 68, 108, 184
 RT 102, 26, 20992
 s_waitcnt lgkmcnt(8)
 MP 72, 112, 128
 RT 104, 26, 24576
 MP 72, 116, 136
 RT 106, 26, 25088
 MP 88, 112, 192
 RT 108, 26, 28672
 MP 88, 116, 200
 RT 110, 26, 29184
 s_waitcnt lgkmcnt(8)
 MP 88, 120, 208
 RT 112, 27, 0
 MP 88, 124, 216
 RT 114, 27, 512
 MP 72, 120, 144
 RT 116, 27, 4096
 MP 72, 124, 152
 RT 118, 27, 4608
 s_waitcnt lgkmcnt(8)
 MP 72, 96, 160
 RT 120, 27, 8192
 MP 72, 100, 168
 RT 122, 27, 8704
 MP 88, 96, 224
 RT 124, 27, 12288
 MP 88, 100, 232
 RT 126, 27, 12800
 s_waitcnt lgkmcnt(8)
 MP 88, 104, 240
 RT 96, 27, 16384
 MP 88, 108, 248
 RT 98, 27, 16896
 MP 72, 104, 176
 RT 100, 27, 20480
 MP 72, 108, 184
 RT 102, 27, 20992
 s_waitcnt lgkmcnt(8)
 MP 76, 112, 128
 RT 104, 27, 24576
 MP 76, 116, 136
 RT 106, 27, 25088
 MP 92, 112, 192
 RT 108, 27, 28672
 MP 92, 116, 200
 RT 110, 27, 29184
 s_waitcnt lgkmcnt(8)
 MP 92, 120, 208
 RT 112, 28, 12288
 v_add_u32 v24, s56, v20
 MP 92, 124, 216
 RT 114, 28, 12800
 v_add_u32 v25, s56, v21
 MP 76, 120, 144
 RT 116, 29, 12288
 v_add_u32 v26, s56, v22
 MP 76, 124, 152
 RT 118, 29, 12800
 v_add_u32 v27, s56, v23
 s_waitcnt lgkmcnt(8)
 MP 76, 96, 160
 RT 120, 30, 12288
 MP 76, 100, 168
 RT 122, 30, 12800
 s_waitcnt vmcnt(16)
 s_barrier
 MP 92, 96, 224
 RT 124, 31, 12288
 s_add_u32 s24, s58, 640
 s_lshl_b32 s3, s21, 1
 MP 92, 100, 232
 RT 126, 31, 12800
 s_add_u32 s3, s3, 0
 s_add_u32 m0, s3, s54
 s_waitcnt lgkmcnt(8)
 MP 92, 104, 240
 RT 96, 24, 0
 DMA 16, 44, 24, 0
 MP 92, 108, 248
 RT 98, 24, 512
 DMA 17, 44, 24, 1024
 MP 76, 104, 176
 RT 100, 24, 4096
 DMA 18, 44, 24, 2048
 MP 76, 108, 184
 RT 102, 24, 4608
 DMA 19, 44, 24, 3072
 s_waitcnt lgkmcnt(8)
 MPZ 96, 112, 132
 RT 104, 24, 8192
 s_add_u32 s24, s58, 29312
 s_lshl_b32 s3, s21, 1
 MPZ 112, 112, 196
 RT 106, 24, 8704
 s_add_u32 s3, s3, 4096
 s_add_u32 m0, s3, s54
 MPZ 116, 116, 196
 RT 108, 24, 12288
 DMA 16, 44, 24, 0
 MPZ 100, 116, 132
 RT 110, 24, 12800
 DMA 17, 44, 24, 1024
 s_waitcnt lgkmcnt(8)
 MPZ 104, 120, 132
 RT 112, 24, 16384
 DMA 18, 44, 24, 2048
 MPZ 120, 120, 196
 RT 114, 24, 16896
 DMA 19, 44, 24, 3072
 MPZ 124, 124, 196
 RT 116, 24, 20480
 MPZ 108, 124, 132
 RT 118, 24, 20992
 s_waitcnt lgkmcnt(8)
 MP 96, 96, 128
 RT 120, 24, 24576
 CV 64, 64, 65
 MP 96, 100, 136
 RT 122, 24, 25088
 CV 65, 66, 67
 MP 112, 96, 192
 RT 124, 24, 28672
 CV 66, 68, 69
 MP 112, 100, 200
 RT 126, 24, 29184
 CV 67, 70, 71
 s_waitcnt lgkmcnt(8)
 MP 112, 104, 208
 RT 96, 25, 0
 buffer_store_dwordx4 v[64:67], v39, s[8:11], s59 offen offset:0 sc1
 MP 112, 108, 216
 RT 98, 25, 512
 CV 72, 72, 73
 MP 96, 104, 144
 RT 100, 25, 4096
 CV 73, 74, 75
 MP 96, 108, 152
 RT 102, 25, 4608
 CV 74, 76, 77
 s_waitcnt lgkmcnt(8)
 MP 96, 112, 160
 RT 104, 25, 8192
 CV 75, 78, 79
 MP 96, 116, 168
 RT 106, 25, 8704
 buffer_store_dwordx4 v[72:75], v39, s[8:11], s59 offen offset:1024 sc1
 MP 112, 112, 224
 RT 108, 25, 12288
 CV 80, 80, 81
 MP 112, 116, 232
 RT 110, 25, 12800
 CV 81, 82, 83
 s_waitcnt lgkmcnt(8)
 MP 112, 120, 240
 RT 112, 25, 16384
 CV 82, 84, 85
 MP 112, 124, 248
 RT 114, 25, 16896
 CV 83, 86, 87
 MP 96, 120, 176
 RT 116, 25, 20480
 buffer_store_dwordx4 v[80:83], v38, s[8:11], s59 offen offset:0 sc1
 MP 96, 124, 184
 RT 118, 25, 20992
 CV 88, 88, 89
 s_waitcnt lgkmcnt(8)
 MP 100, 96, 128
 RT 120, 25, 24576
 CV 89, 90, 91
 MP 100, 100, 136
 RT 122, 25, 25088
 CV 90, 92, 93
 MP 116, 96, 192
 RT 124, 25, 28672
 CV 91, 94, 95
 MP 116, 100, 200
 RT 126, 25, 29184
 buffer_store_dwordx4 v[88:91], v38, s[8:11], s59 offen offset:1024 sc1
 s_waitcnt lgkmcnt(8)
 MP 116, 104, 208
 RT 96, 26, 0
 s_add_u32 s59, s59, 2048
 MP 116, 108, 216
 RT 98, 26, 512
 MP 100, 104, 144
 RT 100, 26, 4096
 MP 100, 108, 152
 RT 102, 26, 4608
 s_waitcnt lgkmcnt(8)
 MP 100, 112, 160
 RT 104, 26, 8192
 MP 100, 116, 168
 RT 106, 26, 8704
 MP 116, 112, 224
 RT 108, 26, 12288
 MP 116, 116, 232
 RT 110, 26, 12800
 s_waitcnt lgkmcnt(8)
 MP 116, 120, 240
 RT 112, 26, 16384
 MP 116, 124, 248
 RT 114, 26, 16896
 MP 100, 120, 176
 RT 116, 26, 20480
 MP 100, 124, 184
 RT 118, 26, 20992
 s_waitcnt lgkmcnt(8)
 MP 104, 96, 128
 RT 120, 26, 24576
 MP 104, 100, 136
 RT 122, 26, 25088
 MP 120, 96, 192
 RT 124, 26, 28672
 MP 120, 100, 200
 RT 126, 26, 29184
 s_waitcnt lgkmcnt(8)
 MP 120, 104, 208
 RT 96, 27, 0
 MP 120, 108, 216
 RT 98, 27, 512
 MP 104, 104, 144
 RT 100, 27, 4096
 MP 104, 108, 152
 RT 102, 27, 4608
 s_waitcnt lgkmcnt(8)
 MP 104, 112, 160
 RT 104, 27, 8192
 MP 104, 116, 168
 RT 106, 27, 8704
 MP 120, 112, 224
 RT 108, 27, 12288
 MP 120, 116, 232
 RT 110, 27, 12800
 s_waitcnt lgkmcnt(8)
 MP 120, 120, 240
 RT 112, 27, 16384
 MP 120, 124, 248
 RT 114, 27, 16896
 MP 104, 120, 176
 RT 116, 27, 20480
 MP 104, 124, 184
 RT 118, 27, 20992
 s_waitcnt lgkmcnt(8)
 MP 108, 96, 128
 RT 120, 27, 24576
 MP 108, 100, 136
 RT 122, 27, 25088
 MP 124, 96, 192
 RT 124, 27, 28672
 MP 124, 100, 200
 RT 126, 27, 29184
 s_waitcnt lgkmcnt(8)
 MP 124, 104, 208
 RT 96, 28, 16384
 v_add_u32 v24, s53, v20
 MP 124, 108, 216
 RT 98, 28, 16896
 v_add_u32 v25, s53, v21
 MP 108, 104, 144
 RT 100, 29, 16384
 v_add_u32 v26, s53, v22
 MP 108, 108, 152
 RT 102, 29, 16896
 v_add_u32 v27, s53, v23
 s_waitcnt lgkmcnt(8)
 MP 108, 112, 160
 RT 104, 30, 16384
 MP 108, 116, 168
 RT 106, 30, 16896
 s_waitcnt vmcnt(16)
 s_barrier
 MP 124, 112, 224
 RT 108, 31, 16384
 s_add_u32 s24, s58, 768
 s_lshl_b32 s3, s21, 1
 MP 124, 116, 232
 RT 110, 31, 16896
 s_add_u32 s3, s3, 0
 s_add_u32 m0, s3, s55
 s_waitcnt lgkmcnt(8)
 MP 124, 120, 240
 RT 112, 24, 0
 DMA 16, 44, 24, 0
 MP 124, 124, 248
 RT 114, 24, 512
 DMA 17, 44, 24, 1024
 MP 108, 120, 176
 RT 116, 24, 4096
 DMA 18, 44, 24, 2048
 MP 108, 124, 184
 RT 118, 24, 4608
 DMA 19, 44, 24, 3072
 s_waitcnt lgkmcnt(8)
 MPZ 64, 96, 132
 RT 120, 24, 8192
 s_add_u32 s24, s58, 29440
 s_lshl_b32 s3, s21, 1
 MPZ 80, 96, 196
 RT 122, 24, 8704
 s_add_u32 s3, s3, 4096
 s_add_u32 m0, s3, s55
 MPZ 84, 100, 196
 RT 124, 24, 12288
 DMA 16, 44, 24, 0
 MPZ 68, 100, 132
 RT 126, 24, 12800
 DMA 17, 44, 24, 1024
 s_waitcnt lgkmcnt(8)
 MPZ 72, 104, 132
 RT 96, 24, 16384
 DMA 18, 44, 24, 2048
 MPZ 88, 104, 196
 RT 98, 24, 16896
 DMA 19, 44, 24, 3072
 MPZ 92, 108, 196
 RT 100, 24, 20480
 MPZ 76, 108, 132
 RT 102, 24, 20992
 s_waitcnt lgkmcnt(8)
 MP 64, 112, 128
 RT 104, 24, 24576
 CV 96, 96, 97
 MP 64, 116, 136
 RT 106, 24, 25088
 CV 97, 98, 99
 MP 80, 112, 192
 RT 108, 24, 28672
 CV 98, 100, 101
 MP 80, 116, 200
 RT 110, 24, 29184
 CV 99, 102, 103
 s_waitcnt lgkmcnt(8)
 MP 80, 120, 208
 RT 112, 25, 0
 buffer_store_dwordx4 v[96:99], v39, s[8:11], s59 offen offset:0 sc1
 MP 80, 124, 216
 RT 114, 25, 512
 CV 104, 104, 105
 MP 64, 120, 144
 RT 116, 25, 4096
 CV 105, 106, 107
 MP 64, 124, 152
 RT 118, 25, 4608
 CV 106, 108, 109
 s_waitcnt lgkmcnt(8)
 MP 64, 96, 160
 RT 120, 25, 8192
 CV 107, 110, 111
 MP 64, 100, 168
 RT 122, 25, 8704
 buffer_store_dwordx4 v[104:107], v39, s[8:11], s59 offen offset:1024 sc1
 MP 80, 96, 224
 RT 124, 25, 12288
 CV 112, 112, 113
 MP 80, 100, 232
 RT 126, 25, 12800
 CV 113, 114, 115
 s_waitcnt lgkmcnt(8)
 MP 80, 104, 240
 RT 96, 25, 16384
 CV 114, 116, 117
 MP 80, 108, 248
 RT 98, 25, 16896
 CV 115, 118, 119
 MP 64, 104, 176
 RT 100, 25, 20480
 buffer_store_dwordx4 v[112:115], v38, s[8:11], s59 offen offset:0 sc1
 MP 64, 108, 184
 RT 102, 25, 20992
 CV 120, 120, 121
 s_waitcnt lgkmcnt(8)
 MP 68, 112, 128
 RT 104, 25, 24576
 CV 121, 122, 123
 MP 68, 116, 136
 RT 106, 25, 25088
 CV 122, 124, 125
 MP 84, 112, 192
 RT 108, 25, 28672
 CV 123, 126, 127
 MP 84, 116, 200
 RT 110, 25, 29184
 buffer_store_dwordx4 v[120:123], v38, s[8:11], s59 offen offset:1024 sc1
 s_waitcnt lgkmcnt(8)
 MP 84, 120, 208
 RT 112, 26, 0
 s_mov_b32 s59, s57
 MP 84, 124, 216
 RT 114, 26, 512
 MP 68, 120, 144
 RT 116, 26, 4096
 MP 68, 124, 152
 RT 118, 26, 4608
 s_waitcnt lgkmcnt(8)
 MP 68, 96, 160
 RT 120, 26, 8192
 MP 68, 100, 168
 RT 122, 26, 8704
 MP 84, 96, 224
 RT 124, 26, 12288
 MP 84, 100, 232
 RT 126, 26, 12800
 s_waitcnt lgkmcnt(8)
 MP 84, 104, 240
 RT 96, 26, 16384
 MP 84, 108, 248
 RT 98, 26, 16896
 MP 68, 104, 176
 RT 100, 26, 20480
 MP 68, 108, 184
 RT 102, 26, 20992
 s_waitcnt lgkmcnt(8)
 MP 72, 112, 128
 RT 104, 26, 24576
 MP 72, 116, 136
 RT 106, 26, 25088
 MP 88, 112, 192
 RT 108, 26, 28672
 MP 88, 116, 200
 RT 110, 26, 29184
 s_waitcnt lgkmcnt(8)
 MP 88, 120, 208
 RT 112, 27, 0
 MP 88, 124, 216
 RT 114, 27, 512
 MP 72, 120, 144
 RT 116, 27, 4096
 MP 72, 124, 152
 RT 118, 27, 4608
 s_waitcnt lgkmcnt(8)
 MP 72, 96, 160
 RT 120, 27, 8192
 MP 72, 100, 168
 RT 122, 27, 8704
 MP 88, 96, 224
 RT 124, 27, 12288
 MP 88, 100, 232
 RT 126, 27, 12800
 s_waitcnt lgkmcnt(8)
 MP 88, 104, 240
 RT 96, 27, 16384
 MP 88, 108, 248
 RT 98, 27, 16896
 MP 72, 104, 176
 RT 100, 27, 20480
 MP 72, 108, 184
 RT 102, 27, 20992
 s_waitcnt lgkmcnt(8)
 MP 76, 112, 128
 RT 104, 27, 24576
 MP 76, 116, 136
 RT 106, 27, 25088
 MP 92, 112, 192
 RT 108, 27, 28672
 MP 92, 116, 200
 RT 110, 27, 29184
 s_waitcnt lgkmcnt(8)
 MP 92, 120, 208
 RT 112, 28, 20480
 v_add_u32 v24, s54, v20
 MP 92, 124, 216
 RT 114, 28, 20992
 v_add_u32 v25, s54, v21
 MP 76, 120, 144
 RT 116, 29, 20480
 v_add_u32 v26, s54, v22
 MP 76, 124, 152
 RT 118, 29, 20992
 v_add_u32 v27, s54, v23
 s_waitcnt lgkmcnt(8)
 MP 76, 96, 160
 RT 120, 30, 20480
 MP 76, 100, 168
 RT 122, 30, 20992
 s_waitcnt vmcnt(16)
 s_barrier
 MP 92, 96, 224
 RT 124, 31, 20480
 MP 92, 100, 232
 RT 126, 31, 20992
 s_waitcnt lgkmcnt(8)
 MP 92, 104, 240
 RT 96, 24, 0
 MP 92, 108, 248
 RT 98, 24, 512
 MP 76, 104, 176
 RT 100, 24, 4096
 MP 76, 108, 184
 RT 102, 24, 4608
 s_waitcnt lgkmcnt(8)
 MPZ 96, 112, 132
 RT 104, 24, 8192
 MPZ 112, 112, 196
 RT 106, 24, 8704
 MPZ 116, 116, 196
 RT 108, 24, 12288
 MPZ 100, 116, 132
 RT 110, 24, 12800
 s_waitcnt lgkmcnt(8)
 MPZ 104, 120, 132
 RT 112, 24, 16384
 MPZ 120, 120, 196
 RT 114, 24, 16896
 MPZ 124, 124, 196
 RT 116, 24, 20480
 MPZ 108, 124, 132
 RT 118, 24, 20992
 s_waitcnt lgkmcnt(8)
 MP 96, 96, 128
 RT 120, 24, 24576
 CV 64, 64, 65
 MP 96, 100, 136
 RT 122, 24, 25088
 CV 65, 66, 67
 MP 112, 96, 192
 RT 124, 24, 28672
 CV 66, 68, 69
 MP 112, 100, 200
 RT 126, 24, 29184
 CV 67, 70, 71
 s_waitcnt lgkmcnt(8)
 MP 112, 104, 208
 RT 96, 25, 0
 buffer_store_dwordx4 v[64:67], v39, s[8:11], s59 offen offset:0 sc1
 MP 112, 108, 216
 RT 98, 25, 512
 CV 72, 72, 73
 MP 96, 104, 144
 RT 100, 25, 4096
 CV 73, 74, 75
 MP 96, 108, 152
 RT 102, 25, 4608
 CV 74, 76, 77
 s_waitcnt lgkmcnt(8)
 MP 96, 112, 160
 RT 104, 25, 8192
 CV 75, 78, 79
 MP 96, 116, 168
 RT 106, 25, 8704
 buffer_store_dwordx4 v[72:75], v39, s[8:11], s59 offen offset:1024 sc1
 MP 112, 112, 224
 RT 108, 25, 12288
 CV 80, 80, 81
 MP 112, 116, 232
 RT 110, 25, 12800
 CV 81, 82, 83
 s_waitcnt lgkmcnt(8)
 MP 112, 120, 240
 RT 112, 25, 16384
 CV 82, 84, 85
 MP 112, 124, 248
 RT 114, 25, 16896
 CV 83, 86, 87
 MP 96, 120, 176
 RT 116, 25, 20480
 buffer_store_dwordx4 v[80:83], v38, s[8:11], s59 offen offset:0 sc1
 MP 96, 124, 184
 RT 118, 25, 20992
 CV 88, 88, 89
 s_waitcnt lgkmcnt(8)
 MP 100, 96, 128
 RT 120, 25, 24576
 CV 89, 90, 91
 MP 100, 100, 136
 RT 122, 25, 25088
 CV 90, 92, 93
 MP 116, 96, 192
 RT 124, 25, 28672
 CV 91, 94, 95
 MP 116, 100, 200
 RT 126, 25, 29184
 buffer_store_dwordx4 v[88:91], v38, s[8:11], s59 offen offset:1024 sc1
 s_waitcnt lgkmcnt(8)
 MP 116, 104, 208
 RT 96, 26, 0
 s_add_u32 s59, s59, 2048
 MP 116, 108, 216
 RT 98, 26, 512
 MP 100, 104, 144
 RT 100, 26, 4096
 MP 100, 108, 152
 RT 102, 26, 4608
 s_waitcnt lgkmcnt(8)
 MP 100, 112, 160
 RT 104, 26, 8192
 MP 100, 116, 168
 RT 106, 26, 8704
 MP 116, 112, 224
 RT 108, 26, 12288
 MP 116, 116, 232
 RT 110, 26, 12800
 s_waitcnt lgkmcnt(8)
 MP 116, 120, 240
 RT 112, 26, 16384
 MP 116, 124, 248
 RT 114, 26, 16896
 MP 100, 120, 176
 RT 116, 26, 20480
 MP 100, 124, 184
 RT 118, 26, 20992
 s_waitcnt lgkmcnt(8)
 MP 104, 96, 128
 RT 120, 26, 24576
 MP 104, 100, 136
 RT 122, 26, 25088
 MP 120, 96, 192
 RT 124, 26, 28672
 MP 120, 100, 200
 RT 126, 26, 29184
 s_waitcnt lgkmcnt(8)
 MP 120, 104, 208
 RT 96, 27, 0
 MP 120, 108, 216
 RT 98, 27, 512
 MP 104, 104, 144
 RT 100, 27, 4096
 MP 104, 108, 152
 RT 102, 27, 4608
 s_waitcnt lgkmcnt(8)
 MP 104, 112, 160
 RT 104, 27, 8192
 MP 104, 116, 168
 RT 106, 27, 8704
 MP 120, 112, 224
 RT 108, 27, 12288
 MP 120, 116, 232
 RT 110, 27, 12800
 s_waitcnt lgkmcnt(8)
 MP 120, 120, 240
 RT 112, 27, 16384
 MP 120, 124, 248
 RT 114, 27, 16896
 MP 104, 120, 176
 RT 116, 27, 20480
 MP 104, 124, 184
 RT 118, 27, 20992
 s_waitcnt lgkmcnt(8)
 MP 108, 96, 128
 RT 120, 27, 24576
 MP 108, 100, 136
 RT 122, 27, 25088
 MP 124, 96, 192
 RT 124, 27, 28672
 MP 124, 100, 200
 RT 126, 27, 29184
 s_waitcnt lgkmcnt(8)
 MP 124, 104, 208
 RT 96, 28, 24576
 v_add_u32 v24, s55, v20
 MP 124, 108, 216
 RT 98, 28, 25088
 v_add_u32 v25, s55, v21
 MP 108, 104, 144
 RT 100, 29, 24576
 v_add_u32 v26, s55, v22
 MP 108, 108, 152
 RT 102, 29, 25088
 v_add_u32 v27, s55, v23
 s_waitcnt lgkmcnt(8)
 MP 108, 112, 160
 RT 104, 30, 24576
 MP 108, 116, 168
 RT 106, 30, 25088
 s_waitcnt vmcnt(4)
 s_barrier
 s_cmp_eq_u32 s73, 0
 s_cbranch_scc1 P2_NF1
 s_mov_b64 exec, 1
 buffer_store_dword v45, v39, s[8:11], s73 offen sc1
 s_mov_b64 exec, -1
 s_mov_b32 s73, 0
P2_NF1:
 MP 124, 112, 224
 RT 108, 31, 24576
 MP 124, 116, 232
 RT 110, 31, 25088
 s_waitcnt lgkmcnt(8)
 MP 124, 120, 240
 RT 112, 24, 0
 MP 124, 124, 248
 RT 114, 24, 512
 MP 108, 120, 176
 RT 116, 24, 4096
 MP 108, 124, 184
 RT 118, 24, 4608
 s_waitcnt lgkmcnt(8)
 MPZ 64, 96, 132
 RT 120, 24, 8192
 MPZ 80, 96, 196
 RT 122, 24, 8704
 MPZ 84, 100, 196
 RT 124, 24, 12288
 MPZ 68, 100, 132
 RT 126, 24, 12800
 s_waitcnt lgkmcnt(8)
 MPZ 72, 104, 132
 RT 96, 24, 16384
 MPZ 88, 104, 196
 RT 98, 24, 16896
 MPZ 92, 108, 196
 RT 100, 24, 20480
 MPZ 76, 108, 132
 RT 102, 24, 20992
 s_waitcnt lgkmcnt(8)
 MP 64, 112, 128
 RT 104, 24, 24576
 CV 96, 96, 97
 MP 64, 116, 136
 RT 106, 24, 25088
 CV 97, 98, 99
 MP 80, 112, 192
 RT 108, 24, 28672
 CV 98, 100, 101
 MP 80, 116, 200
 RT 110, 24, 29184
 CV 99, 102, 103
 s_waitcnt lgkmcnt(8)
 MP 80, 120, 208
 RT 112, 25, 0
 buffer_store_dwordx4 v[96:99], v39, s[8:11], s59 offen offset:0 sc1
 MP 80, 124, 216
 RT 114, 25, 512
 CV 104, 104, 105
 MP 64, 120, 144
 RT 116, 25, 4096
 CV 105, 106, 107
 MP 64, 124, 152
 RT 118, 25, 4608
 CV 106, 108, 109
 s_waitcnt lgkmcnt(8)
 MP 64, 96, 160
 RT 120, 25, 8192
 CV 107, 110, 111
 MP 64, 100, 168
 RT 122, 25, 8704
 buffer_store_dwordx4 v[104:107], v39, s[8:11], s59 offen offset:1024 sc1
 MP 80, 96, 224
 RT 124, 25, 12288
 CV 112, 112, 113
 MP 80, 100, 232
 RT 126, 25, 12800
 CV 113, 114, 115
 s_waitcnt lgkmcnt(8)
 MP 80, 104, 240
 RT 96, 25, 16384
 CV 114, 116, 117
 MP 80, 108, 248
 RT 98, 25, 16896
 CV 115, 118, 119
 MP 64, 104, 176
 RT 100, 25, 20480
 buffer_store_dwordx4 v[112:115], v38, s[8:11], s59 offen offset:0 sc1
 MP 64, 108, 184
 RT 102, 25, 20992
 CV 120, 120, 121
 s_waitcnt lgkmcnt(8)
 MP 68, 112, 128
 RT 104, 25, 24576
 CV 121, 122, 123
 MP 68, 116, 136
 RT 106, 25, 25088
 CV 122, 124, 125
 MP 84, 112, 192
 RT 108, 25, 28672
 CV 123, 126, 127
 MP 84, 116, 200
 RT 110, 25, 29184
 buffer_store_dwordx4 v[120:123], v38, s[8:11], s59 offen offset:1024 sc1
 s_waitcnt lgkmcnt(8)
 MP 84, 120, 208
 RT 112, 26, 0
 s_add_u32 s59, s59, 2048
 MP 84, 124, 216
 RT 114, 26, 512
 MP 68, 120, 144
 RT 116, 26, 4096
 MP 68, 124, 152
 RT 118, 26, 4608
 s_waitcnt lgkmcnt(8)
 MP 68, 96, 160
 RT 120, 26, 8192
 MP 68, 100, 168
 RT 122, 26, 8704
 MP 84, 96, 224
 RT 124, 26, 12288
 MP 84, 100, 232
 RT 126, 26, 12800
 s_waitcnt lgkmcnt(8)
 MP 84, 104, 240
 RT 96, 26, 16384
 MP 84, 108, 248
 RT 98, 26, 16896
 MP 68, 104, 176
 RT 100, 26, 20480
 MP 68, 108, 184
 RT 102, 26, 20992
 s_waitcnt lgkmcnt(8)
 MP 72, 112, 128
 RT 104, 26, 24576
 MP 72, 116, 136
 RT 106, 26, 25088
 MP 88, 112, 192
 RT 108, 26, 28672
 MP 88, 116, 200
 RT 110, 26, 29184
 s_waitcnt lgkmcnt(8)
 MP 88, 120, 208
 RT 112, 27, 0
 MP 88, 124, 216
 RT 114, 27, 512
 MP 72, 120, 144
 RT 116, 27, 4096
 MP 72, 124, 152
 RT 118, 27, 4608
 s_waitcnt lgkmcnt(8)
 MP 72, 96, 160
 RT 120, 27, 8192
 MP 72, 100, 168
 RT 122, 27, 8704
 MP 88, 96, 224
 RT 124, 27, 12288
 MP 88, 100, 232
 RT 126, 27, 12800
 s_waitcnt lgkmcnt(8)
 MP 88, 104, 240
 RT 96, 27, 16384
 MP 88, 108, 248
 RT 98, 27, 16896
 MP 72, 104, 176
 RT 100, 27, 20480
 MP 72, 108, 184
 RT 102, 27, 20992
 s_waitcnt lgkmcnt(8)
 buffer_load_dword v2, v42, s[8:11], s20 offen offset:4 sc1
 MP 76, 112, 128
 RT 104, 27, 24576
 MP 76, 116, 136
 RT 106, 27, 25088
 MP 92, 112, 192
 RT 108, 27, 28672
 MP 92, 116, 200
 RT 110, 27, 29184
 s_waitcnt lgkmcnt(8)
 MP 92, 120, 208
 MP 92, 124, 216
 MP 76, 120, 144
 MP 76, 124, 152
 s_waitcnt lgkmcnt(4)
 MP 76, 96, 160
 MP 76, 100, 168
 MP 92, 96, 224
 MP 92, 100, 232
 s_waitcnt lgkmcnt(0)
 MP 92, 104, 240
 MP 92, 108, 248
 MP 76, 104, 176
 MP 76, 108, 184
 s_nop 7
 CV 64, 64, 65
 CV 65, 66, 67
 CV 66, 68, 69
 CV 67, 70, 71
 buffer_store_dwordx4 v[64:67], v39, s[8:11], s59 offen offset:0 sc1
 CV 72, 72, 73
 CV 73, 74, 75
 CV 74, 76, 77
 CV 75, 78, 79
 buffer_store_dwordx4 v[72:75], v39, s[8:11], s59 offen offset:1024 sc1
 CV 80, 80, 81
 CV 81, 82, 83
 CV 82, 84, 85
 CV 83, 86, 87
 buffer_store_dwordx4 v[80:83], v38, s[8:11], s59 offen offset:0 sc1
 CV 88, 88, 89
 CV 89, 90, 91
 CV 90, 92, 93
 CV 91, 94, 95
 buffer_store_dwordx4 v[88:91], v38, s[8:11], s59 offen offset:1024 sc1
 s_waitcnt vmcnt(4)
 v_cmp_eq_u32 vcc, 0, v2
 s_nop 1
 s_cbranch_vccnz P2_RL
 buffer_load_dwordx4 v[128:131], v39, s[8:11], s15 offen sc1
 s_add_u32 s15, s15, 1115136
 buffer_load_dwordx4 v[132:135], v39, s[8:11], s15 offen sc1
 s_add_u32 s15, s15, 1115136
 buffer_load_dwordx4 v[136:139], v39, s[8:11], s15 offen sc1
 s_add_u32 s15, s15, 1115136
 buffer_load_dwordx4 v[140:143], v39, s[8:11], s15 offen sc1
 s_add_u32 s15, s15, 1115136
 buffer_load_dwordx4 v[144:147], v39, s[8:11], s15 offen sc1
 s_add_u32 s15, s15, 1115136
 buffer_load_dwordx4 v[148:151], v39, s[8:11], s15 offen sc1
 s_add_u32 s15, s15, 1115136
 buffer_load_dwordx4 v[152:155], v39, s[8:11], s15 offen sc1
 s_add_u32 s15, s15, 1115136
 buffer_load_dwordx4 v[156:159], v39, s[8:11], s15 offen sc1
 s_add_u32 s15, s15, 1115136
 buffer_load_dwordx4 v[160:163], v39, s[8:11], s15 offen sc1
 s_add_u32 s15, s15, 1115136
 buffer_load_dwordx4 v[164:167], v39, s[8:11], s15 offen sc1
 s_add_u32 s15, s15, 1115136
 buffer_load_dwordx4 v[168:171], v39, s[8:11], s15 offen sc1
 s_add_u32 s15, s15, 1115136
 buffer_load_dwordx4 v[172:175], v39, s[8:11], s15 offen sc1
 s_add_u32 s15, s15, 1115136
 buffer_load_dwordx4 v[176:179], v39, s[8:11], s15 offen sc1
 s_add_u32 s15, s15, 1115136
 buffer_load_dwordx4 v[180:183], v39, s[8:11], s15 offen sc1
 s_add_u32 s15, s15, 1115136
 buffer_load_dwordx4 v[184:187], v39, s[8:11], s15 offen sc1
 s_add_u32 s15, s15, 1115136
 buffer_load_dwordx4 v[188:191], v39, s[8:11], s15 offen sc1
 s_waitcnt vmcnt(16)
 s_barrier
 s_cmp_eq_u32 s27, 0
 s_cbranch_scc1 P2_NF2
 s_mov_b64 exec, 1
 buffer_store_dword v45, v39, s[8:11], s27 offen sc1
 s_mov_b64 exec, -1
 s_mov_b32 s27, 0
P2_NF2:
 s_branch P2_RA
P2_RL:
 s_waitcnt vmcnt(0)
 s_barrier
 s_cmp_eq_u32 s27, 0
 s_cbranch_scc1 P2_NF3
 s_mov_b64 exec, 1
 buffer_store_dword v45, v39, s[8:11], s27 offen sc1
 s_mov_b64 exec, -1
 s_mov_b32 s27, 0
P2_NF3:
 s_add_u32 s25, s20, 4
P2_PL4:
 buffer_load_dword v9, v42, s[8:11], s25 offen sc1
 s_waitcnt vmcnt(0)
 v_cmp_eq_u32 vcc, 0, v9
 s_nop 1
 s_cbranch_vccz P2_PK4
 s_sleep 1
 s_branch P2_PL4
P2_PK4:
 buffer_load_dwordx4 v[128:131], v39, s[8:11], s15 offen sc1
 s_add_u32 s15, s15, 1115136
 buffer_load_dwordx4 v[132:135], v39, s[8:11], s15 offen sc1
 s_add_u32 s15, s15, 1115136
 buffer_load_dwordx4 v[136:139], v39, s[8:11], s15 offen sc1
 s_add_u32 s15, s15, 1115136
 buffer_load_dwordx4 v[140:143], v39, s[8:11], s15 offen sc1
 s_add_u32 s15, s15, 1115136
 buffer_load_dwordx4 v[144:147], v39, s[8:11], s15 offen sc1
 s_add_u32 s15, s15, 1115136
 buffer_load_dwordx4 v[148:151], v39, s[8:11], s15 offen sc1
 s_add_u32 s15, s15, 1115136
 buffer_load_dwordx4 v[152:155], v39, s[8:11], s15 offen sc1
 s_add_u32 s15, s15, 1115136
 buffer_load_dwordx4 v[156:159], v39, s[8:11], s15 offen sc1
 s_add_u32 s15, s15, 1115136
 buffer_load_dwordx4 v[160:163], v39, s[8:11], s15 offen sc1
 s_add_u32 s15, s15, 1115136
 buffer_load_dwordx4 v[164:167], v39, s[8:11], s15 offen sc1
 s_add_u32 s15, s15, 1115136
 buffer_load_dwordx4 v[168:171], v39, s[8:11], s15 offen sc1
 s_add_u32 s15, s15, 1115136
 buffer_load_dwordx4 v[172:175], v39, s[8:11], s15 offen sc1
 s_add_u32 s15, s15, 1115136
 buffer_load_dwordx4 v[176:179], v39, s[8:11], s15 offen sc1
 s_add_u32 s15, s15, 1115136
 buffer_load_dwordx4 v[180:183], v39, s[8:11], s15 offen sc1
 s_add_u32 s15, s15, 1115136
 buffer_load_dwordx4 v[184:187], v39, s[8:11], s15 offen sc1
 s_add_u32 s15, s15, 1115136
 buffer_load_dwordx4 v[188:191], v39, s[8:11], s15 offen sc1
P2_RA:
 s_waitcnt vmcnt(15)
 v_lshlrev_b32 v96, 16, v128
 v_and_b32 v97, s26, v128
 v_lshlrev_b32 v98, 16, v129
 v_and_b32 v99, s26, v129
 v_lshlrev_b32 v100, 16, v130
 v_and_b32 v101, s26, v130
 v_lshlrev_b32 v102, 16, v131
 v_and_b32 v103, s26, v131
 s_waitcnt vmcnt(14)
 v_lshlrev_b32 v6, 16, v132
 v_and_b32 v7, s26, v132
 v_pk_add_f32 v[96:97], v[96:97], v[6:7]
 v_lshlrev_b32 v6, 16, v133
 v_and_b32 v7, s26, v133
 v_pk_add_f32 v[98:99], v[98:99], v[6:7]
 v_lshlrev_b32 v6, 16, v134
 v_and_b32 v7, s26, v134
 v_pk_add_f32 v[100:101], v[100:101], v[6:7]
 v_lshlrev_b32 v6, 16, v135
 v_and_b32 v7, s26, v135
 v_pk_add_f32 v[102:103], v[102:103], v[6:7]
 s_waitcnt vmcnt(13)
 v_lshlrev_b32 v6, 16, v136
 v_and_b32 v7, s26, v136
 v_pk_add_f32 v[96:97], v[96:97], v[6:7]
 v_lshlrev_b32 v6, 16, v137
 v_and_b32 v7, s26, v137
 v_pk_add_f32 v[98:99], v[98:99], v[6:7]
 v_lshlrev_b32 v6, 16, v138
 v_and_b32 v7, s26, v138
 v_pk_add_f32 v[100:101], v[100:101], v[6:7]
 v_lshlrev_b32 v6, 16, v139
 v_and_b32 v7, s26, v139
 v_pk_add_f32 v[102:103], v[102:103], v[6:7]
 s_waitcnt vmcnt(12)
 v_lshlrev_b32 v6, 16, v140
 v_and_b32 v7, s26, v140
 v_pk_add_f32 v[96:97], v[96:97], v[6:7]
 v_lshlrev_b32 v6, 16, v141
 v_and_b32 v7, s26, v141
 v_pk_add_f32 v[98:99], v[98:99], v[6:7]
 v_lshlrev_b32 v6, 16, v142
 v_and_b32 v7, s26, v142
 v_pk_add_f32 v[100:101], v[100:101], v[6:7]
 v_lshlrev_b32 v6, 16, v143
 v_and_b32 v7, s26, v143
 v_pk_add_f32 v[102:103], v[102:103], v[6:7]
 s_waitcnt vmcnt(11)
 v_lshlrev_b32 v6, 16, v144
 v_and_b32 v7, s26, v144
 v_pk_add_f32 v[96:97], v[96:97], v[6:7]
 v_lshlrev_b32 v6, 16, v145
 v_and_b32 v7, s26, v145
 v_pk_add_f32 v[98:99], v[98:99], v[6:7]
 v_lshlrev_b32 v6, 16, v146
 v_and_b32 v7, s26, v146
 v_pk_add_f32 v[100:101], v[100:101], v[6:7]
 v_lshlrev_b32 v6, 16, v147
 v_and_b32 v7, s26, v147
 v_pk_add_f32 v[102:103], v[102:103], v[6:7]
 s_waitcnt vmcnt(10)
 v_lshlrev_b32 v6, 16, v148
 v_and_b32 v7, s26, v148
 v_pk_add_f32 v[96:97], v[96:97], v[6:7]
 v_lshlrev_b32 v6, 16, v149
 v_and_b32 v7, s26, v149
 v_pk_add_f32 v[98:99], v[98:99], v[6:7]
 v_lshlrev_b32 v6, 16, v150
 v_and_b32 v7, s26, v150
 v_pk_add_f32 v[100:101], v[100:101], v[6:7]
 v_lshlrev_b32 v6, 16, v151
 v_and_b32 v7, s26, v151
 v_pk_add_f32 v[102:103], v[102:103], v[6:7]
 s_waitcnt vmcnt(9)
 v_lshlrev_b32 v6, 16, v152
 v_and_b32 v7, s26, v152
 v_pk_add_f32 v[96:97], v[96:97], v[6:7]
 v_lshlrev_b32 v6, 16, v153
 v_and_b32 v7, s26, v153
 v_pk_add_f32 v[98:99], v[98:99], v[6:7]
 v_lshlrev_b32 v6, 16, v154
 v_and_b32 v7, s26, v154
 v_pk_add_f32 v[100:101], v[100:101], v[6:7]
 v_lshlrev_b32 v6, 16, v155
 v_and_b32 v7, s26, v155
 v_pk_add_f32 v[102:103], v[102:103], v[6:7]
 s_waitcnt vmcnt(8)
 v_lshlrev_b32 v6, 16, v156
 v_and_b32 v7, s26, v156
 v_pk_add_f32 v[96:97], v[96:97], v[6:7]
 v_lshlrev_b32 v6, 16, v157
 v_and_b32 v7, s26, v157
 v_pk_add_f32 v[98:99], v[98:99], v[6:7]
 v_lshlrev_b32 v6, 16, v158
 v_and_b32 v7, s26, v158
 v_pk_add_f32 v[100:101], v[100:101], v[6:7]
 v_lshlrev_b32 v6, 16, v159
 v_and_b32 v7, s26, v159
 v_pk_add_f32 v[102:103], v[102:103], v[6:7]
 s_waitcnt vmcnt(7)
 v_lshlrev_b32 v6, 16, v160
 v_and_b32 v7, s26, v160
 v_pk_add_f32 v[96:97], v[96:97], v[6:7]
 v_lshlrev_b32 v6, 16, v161
 v_and_b32 v7, s26, v161
 v_pk_add_f32 v[98:99], v[98:99], v[6:7]
 v_lshlrev_b32 v6, 16, v162
 v_and_b32 v7, s26, v162
 v_pk_add_f32 v[100:101], v[100:101], v[6:7]
 v_lshlrev_b32 v6, 16, v163
 v_and_b32 v7, s26, v163
 v_pk_add_f32 v[102:103], v[102:103], v[6:7]
 s_waitcnt vmcnt(6)
 v_lshlrev_b32 v6, 16, v164
 v_and_b32 v7, s26, v164
 v_pk_add_f32 v[96:97], v[96:97], v[6:7]
 v_lshlrev_b32 v6, 16, v165
 v_and_b32 v7, s26, v165
 v_pk_add_f32 v[98:99], v[98:99], v[6:7]
 v_lshlrev_b32 v6, 16, v166
 v_and_b32 v7, s26, v166
 v_pk_add_f32 v[100:101], v[100:101], v[6:7]
 v_lshlrev_b32 v6, 16, v167
 v_and_b32 v7, s26, v167
 v_pk_add_f32 v[102:103], v[102:103], v[6:7]
 s_waitcnt vmcnt(5)
 v_lshlrev_b32 v6, 16, v168
 v_and_b32 v7, s26, v168
 v_pk_add_f32 v[96:97], v[96:97], v[6:7]
 v_lshlrev_b32 v6, 16, v169
 v_and_b32 v7, s26, v169
 v_pk_add_f32 v[98:99], v[98:99], v[6:7]
 v_lshlrev_b32 v6, 16, v170
 v_and_b32 v7, s26, v170
 v_pk_add_f32 v[100:101], v[100:101], v[6:7]
 v_lshlrev_b32 v6, 16, v171
 v_and_b32 v7, s26, v171
 v_pk_add_f32 v[102:103], v[102:103], v[6:7]
 s_waitcnt vmcnt(4)
 v_lshlrev_b32 v6, 16, v172
 v_and_b32 v7, s26, v172
 v_pk_add_f32 v[96:97], v[96:97], v[6:7]
 v_lshlrev_b32 v6, 16, v173
 v_and_b32 v7, s26, v173
 v_pk_add_f32 v[98:99], v[98:99], v[6:7]
 v_lshlrev_b32 v6, 16, v174
 v_and_b32 v7, s26, v174
 v_pk_add_f32 v[100:101], v[100:101], v[6:7]
 v_lshlrev_b32 v6, 16, v175
 v_and_b32 v7, s26, v175
 v_pk_add_f32 v[102:103], v[102:103], v[6:7]
 s_waitcnt vmcnt(3)
 v_lshlrev_b32 v6, 16, v176
 v_and_b32 v7, s26, v176
 v_pk_add_f32 v[96:97], v[96:97], v[6:7]
 v_lshlrev_b32 v6, 16, v177
 v_and_b32 v7, s26, v177
 v_pk_add_f32 v[98:99], v[98:99], v[6:7]
 v_lshlrev_b32 v6, 16, v178
 v_and_b32 v7, s26, v178
 v_pk_add_f32 v[100:101], v[100:101], v[6:7]
 v_lshlrev_b32 v6, 16, v179
 v_and_b32 v7, s26, v179
 v_pk_add_f32 v[102:103], v[102:103], v[6:7]
 s_waitcnt vmcnt(2)
 v_lshlrev_b32 v6, 16, v180
 v_and_b32 v7, s26, v180
 v_pk_add_f32 v[96:97], v[96:97], v[6:7]
 v_lshlrev_b32 v6, 16, v181
 v_and_b32 v7, s26, v181
 v_pk_add_f32 v[98:99], v[98:99], v[6:7]
 v_lshlrev_b32 v6, 16, v182
 v_and_b32 v7, s26, v182
 v_pk_add_f32 v[100:101], v[100:101], v[6:7]
 v_lshlrev_b32 v6, 16, v183
 v_and_b32 v7, s26, v183
 v_pk_add_f32 v[102:103], v[102:103], v[6:7]
 s_waitcnt vmcnt(1)
 v_lshlrev_b32 v6, 16, v184
 v_and_b32 v7, s26, v184
 v_pk_add_f32 v[96:97], v[96:97], v[6:7]
 v_lshlrev_b32 v6, 16, v185
 v_and_b32 v7, s26, v185
 v_pk_add_f32 v[98:99], v[98:99], v[6:7]
 v_lshlrev_b32 v6, 16, v186
 v_and_b32 v7, s26, v186
 v_pk_add_f32 v[100:101], v[100:101], v[6:7]
 v_lshlrev_b32 v6, 16, v187
 v_and_b32 v7, s26, v187
 v_pk_add_f32 v[102:103], v[102:103], v[6:7]
 s_waitcnt vmcnt(0)
 v_lshlrev_b32 v6, 16, v188
 v_and_b32 v7, s26, v188
 v_pk_add_f32 v[96:97], v[96:97], v[6:7]
 v_lshlrev_b32 v6, 16, v189
 v_and_b32 v7, s26, v189
 v_pk_add_f32 v[98:99], v[98:99], v[6:7]
 v_lshlrev_b32 v6, 16, v190
 v_and_b32 v7, s26, v190
 v_pk_add_f32 v[100:101], v[100:101], v[6:7]
 v_lshlrev_b32 v6, 16, v191
 v_and_b32 v7, s26, v191
 v_pk_add_f32 v[102:103], v[102:103], v[6:7]
 CV 96, 96, 97
 CV 97, 98, 99
 CV 98, 100, 101
 CV 99, 102, 103
 buffer_store_dwordx2 v[96:97], v4, s[68:71], s18 offen
 buffer_store_dwordx2 v[98:99], v4, s[68:71], s18 offen offset:32
 s_cmp_eq_u32 s4, 3
 s_cbranch_scc1 P2_FIN
P2_PL5:
 buffer_load_dword v9, v42, s[8:11], s20 offen sc1
 s_waitcnt vmcnt(0)
 v_cmp_eq_u32 vcc, 0, v9
 s_nop 1
 s_cbranch_vccz P2_PK5
 s_sleep 1
 s_branch P2_PL5
P2_PK5:
 buffer_load_dwordx4 v[192:195], v39, s[8:11], s17 offen sc1
 s_add_u32 s17, s17, 532480
 buffer_load_dwordx4 v[196:199], v39, s[8:11], s17 offen sc1
 s_add_u32 s17, s17, 532480
 buffer_load_dwordx4 v[200:203], v39, s[8:11], s17 offen sc1
 s_add_u32 s17, s17, 532480
 buffer_load_dwordx4 v[204:207], v39, s[8:11], s17 offen sc1
 s_add_u32 s17, s17, 532480
 buffer_load_dwordx4 v[208:211], v39, s[8:11], s17 offen sc1
 s_add_u32 s17, s17, 532480
 buffer_load_dwordx4 v[212:215], v39, s[8:11], s17 offen sc1
 s_add_u32 s17, s17, 532480
 buffer_load_dwordx4 v[216:219], v39, s[8:11], s17 offen sc1
 s_add_u32 s17, s17, 532480
 buffer_load_dwordx4 v[220:223], v39, s[8:11], s17 offen sc1
 s_add_u32 s17, s17, 532480
 buffer_load_dwordx4 v[224:227], v39, s[8:11], s17 offen sc1
 s_add_u32 s17, s17, 532480
 buffer_load_dwordx4 v[228:231], v39, s[8:11], s17 offen sc1
 s_add_u32 s17, s17, 532480
 buffer_load_dwordx4 v[232:235], v39, s[8:11], s17 offen sc1
 s_add_u32 s17, s17, 532480
 buffer_load_dwordx4 v[236:239], v39, s[8:11], s17 offen sc1
 s_add_u32 s17, s17, 532480
 buffer_load_dwordx4 v[240:243], v39, s[8:11], s17 offen sc1
 s_add_u32 s17, s17, 532480
 buffer_load_dwordx4 v[244:247], v39, s[8:11], s17 offen sc1
 s_add_u32 s17, s17, 532480
 buffer_load_dwordx4 v[248:251], v39, s[8:11], s17 offen sc1
 s_add_u32 s17, s17, 532480
 buffer_load_dwordx4 v[252:255], v39, s[8:11], s17 offen sc1
 s_waitcnt vmcnt(15)
 v_lshlrev_b32 v104, 16, v192
 v_and_b32 v105, s26, v192
 v_lshlrev_b32 v106, 16, v193
 v_and_b32 v107, s26, v193
 v_lshlrev_b32 v108, 16, v194
 v_and_b32 v109, s26, v194
 v_lshlrev_b32 v110, 16, v195
 v_and_b32 v111, s26, v195
 s_waitcnt vmcnt(14)
 v_lshlrev_b32 v6, 16, v196
 v_and_b32 v7, s26, v196
 v_pk_add_f32 v[104:105], v[104:105], v[6:7]
 v_lshlrev_b32 v6, 16, v197
 v_and_b32 v7, s26, v197
 v_pk_add_f32 v[106:107], v[106:107], v[6:7]
 v_lshlrev_b32 v6, 16, v198
 v_and_b32 v7, s26, v198
 v_pk_add_f32 v[108:109], v[108:109], v[6:7]
 v_lshlrev_b32 v6, 16, v199
 v_and_b32 v7, s26, v199
 v_pk_add_f32 v[110:111], v[110:111], v[6:7]
 s_waitcnt vmcnt(13)
 v_lshlrev_b32 v6, 16, v200
 v_and_b32 v7, s26, v200
 v_pk_add_f32 v[104:105], v[104:105], v[6:7]
 v_lshlrev_b32 v6, 16, v201
 v_and_b32 v7, s26, v201
 v_pk_add_f32 v[106:107], v[106:107], v[6:7]
 v_lshlrev_b32 v6, 16, v202
 v_and_b32 v7, s26, v202
 v_pk_add_f32 v[108:109], v[108:109], v[6:7]
 v_lshlrev_b32 v6, 16, v203
 v_and_b32 v7, s26, v203
 v_pk_add_f32 v[110:111], v[110:111], v[6:7]
 s_waitcnt vmcnt(12)
 v_lshlrev_b32 v6, 16, v204
 v_and_b32 v7, s26, v204
 v_pk_add_f32 v[104:105], v[104:105], v[6:7]
 v_lshlrev_b32 v6, 16, v205
 v_and_b32 v7, s26, v205
 v_pk_add_f32 v[106:107], v[106:107], v[6:7]
 v_lshlrev_b32 v6, 16, v206
 v_and_b32 v7, s26, v206
 v_pk_add_f32 v[108:109], v[108:109], v[6:7]
 v_lshlrev_b32 v6, 16, v207
 v_and_b32 v7, s26, v207
 v_pk_add_f32 v[110:111], v[110:111], v[6:7]
 s_waitcnt vmcnt(11)
 v_lshlrev_b32 v6, 16, v208
 v_and_b32 v7, s26, v208
 v_pk_add_f32 v[104:105], v[104:105], v[6:7]
 v_lshlrev_b32 v6, 16, v209
 v_and_b32 v7, s26, v209
 v_pk_add_f32 v[106:107], v[106:107], v[6:7]
 v_lshlrev_b32 v6, 16, v210
 v_and_b32 v7, s26, v210
 v_pk_add_f32 v[108:109], v[108:109], v[6:7]
 v_lshlrev_b32 v6, 16, v211
 v_and_b32 v7, s26, v211
 v_pk_add_f32 v[110:111], v[110:111], v[6:7]
 s_waitcnt vmcnt(10)
 v_lshlrev_b32 v6, 16, v212
 v_and_b32 v7, s26, v212
 v_pk_add_f32 v[104:105], v[104:105], v[6:7]
 v_lshlrev_b32 v6, 16, v213
 v_and_b32 v7, s26, v213
 v_pk_add_f32 v[106:107], v[106:107], v[6:7]
 v_lshlrev_b32 v6, 16, v214
 v_and_b32 v7, s26, v214
 v_pk_add_f32 v[108:109], v[108:109], v[6:7]
 v_lshlrev_b32 v6, 16, v215
 v_and_b32 v7, s26, v215
 v_pk_add_f32 v[110:111], v[110:111], v[6:7]
 s_waitcnt vmcnt(9)
 v_lshlrev_b32 v6, 16, v216
 v_and_b32 v7, s26, v216
 v_pk_add_f32 v[104:105], v[104:105], v[6:7]
 v_lshlrev_b32 v6, 16, v217
 v_and_b32 v7, s26, v217
 v_pk_add_f32 v[106:107], v[106:107], v[6:7]
 v_lshlrev_b32 v6, 16, v218
 v_and_b32 v7, s26, v218
 v_pk_add_f32 v[108:109], v[108:109], v[6:7]
 v_lshlrev_b32 v6, 16, v219
 v_and_b32 v7, s26, v219
 v_pk_add_f32 v[110:111], v[110:111], v[6:7]
 s_waitcnt vmcnt(8)
 v_lshlrev_b32 v6, 16, v220
 v_and_b32 v7, s26, v220
 v_pk_add_f32 v[104:105], v[104:105], v[6:7]
 v_lshlrev_b32 v6, 16, v221
 v_and_b32 v7, s26, v221
 v_pk_add_f32 v[106:107], v[106:107], v[6:7]
 v_lshlrev_b32 v6, 16, v222
 v_and_b32 v7, s26, v222
 v_pk_add_f32 v[108:109], v[108:109], v[6:7]
 v_lshlrev_b32 v6, 16, v223
 v_and_b32 v7, s26, v223
 v_pk_add_f32 v[110:111], v[110:111], v[6:7]
 s_waitcnt vmcnt(7)
 v_lshlrev_b32 v6, 16, v224
 v_and_b32 v7, s26, v224
 v_pk_add_f32 v[104:105], v[104:105], v[6:7]
 v_lshlrev_b32 v6, 16, v225
 v_and_b32 v7, s26, v225
 v_pk_add_f32 v[106:107], v[106:107], v[6:7]
 v_lshlrev_b32 v6, 16, v226
 v_and_b32 v7, s26, v226
 v_pk_add_f32 v[108:109], v[108:109], v[6:7]
 v_lshlrev_b32 v6, 16, v227
 v_and_b32 v7, s26, v227
 v_pk_add_f32 v[110:111], v[110:111], v[6:7]
 s_waitcnt vmcnt(6)
 v_lshlrev_b32 v6, 16, v228
 v_and_b32 v7, s26, v228
 v_pk_add_f32 v[104:105], v[104:105], v[6:7]
 v_lshlrev_b32 v6, 16, v229
 v_and_b32 v7, s26, v229
 v_pk_add_f32 v[106:107], v[106:107], v[6:7]
 v_lshlrev_b32 v6, 16, v230
 v_and_b32 v7, s26, v230
 v_pk_add_f32 v[108:109], v[108:109], v[6:7]
 v_lshlrev_b32 v6, 16, v231
 v_and_b32 v7, s26, v231
 v_pk_add_f32 v[110:111], v[110:111], v[6:7]
 s_waitcnt vmcnt(5)
 v_lshlrev_b32 v6, 16, v232
 v_and_b32 v7, s26, v232
 v_pk_add_f32 v[104:105], v[104:105], v[6:7]
 v_lshlrev_b32 v6, 16, v233
 v_and_b32 v7, s26, v233
 v_pk_add_f32 v[106:107], v[106:107], v[6:7]
 v_lshlrev_b32 v6, 16, v234
 v_and_b32 v7, s26, v234
 v_pk_add_f32 v[108:109], v[108:109], v[6:7]
 v_lshlrev_b32 v6, 16, v235
 v_and_b32 v7, s26, v235
 v_pk_add_f32 v[110:111], v[110:111], v[6:7]
 s_waitcnt vmcnt(4)
 v_lshlrev_b32 v6, 16, v236
 v_and_b32 v7, s26, v236
 v_pk_add_f32 v[104:105], v[104:105], v[6:7]
 v_lshlrev_b32 v6, 16, v237
 v_and_b32 v7, s26, v237
 v_pk_add_f32 v[106:107], v[106:107], v[6:7]
 v_lshlrev_b32 v6, 16, v238
 v_and_b32 v7, s26, v238
 v_pk_add_f32 v[108:109], v[108:109], v[6:7]
 v_lshlrev_b32 v6, 16, v239
 v_and_b32 v7, s26, v239
 v_pk_add_f32 v[110:111], v[110:111], v[6:7]
 s_waitcnt vmcnt(3)
 v_lshlrev_b32 v6, 16, v240
 v_and_b32 v7, s26, v240
 v_pk_add_f32 v[104:105], v[104:105], v[6:7]
 v_lshlrev_b32 v6, 16, v241
 v_and_b32 v7, s26, v241
 v_pk_add_f32 v[106:107], v[106:107], v[6:7]
 v_lshlrev_b32 v6, 16, v242
 v_and_b32 v7, s26, v242
 v_pk_add_f32 v[108:109], v[108:109], v[6:7]
 v_lshlrev_b32 v6, 16, v243
 v_and_b32 v7, s26, v243
 v_pk_add_f32 v[110:111], v[110:111], v[6:7]
 s_waitcnt vmcnt(2)
 v_lshlrev_b32 v6, 16, v244
 v_and_b32 v7, s26, v244
 v_pk_add_f32 v[104:105], v[104:105], v[6:7]
 v_lshlrev_b32 v6, 16, v245
 v_and_b32 v7, s26, v245
 v_pk_add_f32 v[106:107], v[106:107], v[6:7]
 v_lshlrev_b32 v6, 16, v246
 v_and_b32 v7, s26, v246
 v_pk_add_f32 v[108:109], v[108:109], v[6:7]
 v_lshlrev_b32 v6, 16, v247
 v_and_b32 v7, s26, v247
 v_pk_add_f32 v[110:111], v[110:111], v[6:7]
 s_waitcnt vmcnt(1)
 v_lshlrev_b32 v6, 16, v248
 v_and_b32 v7, s26, v248
 v_pk_add_f32 v[104:105], v[104:105], v[6:7]
 v_lshlrev_b32 v6, 16, v249
 v_and_b32 v7, s26, v249
 v_pk_add_f32 v[106:107], v[106:107], v[6:7]
 v_lshlrev_b32 v6, 16, v250
 v_and_b32 v7, s26, v250
 v_pk_add_f32 v[108:109], v[108:109], v[6:7]
 v_lshlrev_b32 v6, 16, v251
 v_and_b32 v7, s26, v251
 v_pk_add_f32 v[110:111], v[110:111], v[6:7]
 s_waitcnt vmcnt(0)
 v_lshlrev_b32 v6, 16, v252
 v_and_b32 v7, s26, v252
 v_pk_add_f32 v[104:105], v[104:105], v[6:7]
 v_lshlrev_b32 v6, 16, v253
 v_and_b32 v7, s26, v253
 v_pk_add_f32 v[106:107], v[106:107], v[6:7]
 v_lshlrev_b32 v6, 16, v254
 v_and_b32 v7, s26, v254
 v_pk_add_f32 v[108:109], v[108:109], v[6:7]
 v_lshlrev_b32 v6, 16, v255
 v_and_b32 v7, s26, v255
 v_pk_add_f32 v[110:111], v[110:111], v[6:7]
 CV 104, 104, 105
 CV 105, 106, 107
 CV 106, 108, 109
 CV 107, 110, 111
 buffer_store_dwordx2 v[104:105], v4, s[68:71], s19 offen
 buffer_store_dwordx2 v[106:107], v4, s[68:71], s19 offen offset:32
P2_FIN:
P2_END:
 s_endpgm
P2_TS:
 s_waitcnt vmcnt(20) lgkmcnt(4)
 MP 128, 96, 120
 s_barrier
 s_add_u32 s15, s15, 33792
 MP 192, 96, 124
 RA 96, 47, 24576
 MP 196, 100, 124
 s_add_u32 s75, s75, s75
 s_cbranch_scc1 P2_DS2
P2_DB2:
 MP 132, 100, 120
 RA 100, 47, 25600
 s_mov_b32 m0, s18
 MP 136, 104, 120
 s_cmp_eq_u32 s14, s16
 s_cselect_b32 s15, s17, s15
 MP 200, 104, 124
 RA 104, 47, 26624
 s_cmp_eq_u32 s14, s41
 s_cselect_b32 s15, s43, s15
 MP 204, 108, 124
 v_exp_f32 v48, v64
 MP 140, 108, 120
 RA 108, 47, 27648
 s_waitcnt lgkmcnt(4)
 MP 144, 112, 120
 v_exp_f32 v49, v65
 MP 208, 112, 124
 RA 112, 47, 28672
 v_add_f32 v32, v34, v48
 MP 212, 116, 124
 DMAS 39, 8, 15, 0
 MP 148, 116, 120
 RA 116, 47, 29696
 s_add_u32 s20, s19, s21
 MP 152, 120, 120
 v_exp_f32 v50, v66
 MP 216, 120, 124
 RA 120, 47, 30720
 s_add_u32 s19, s19, 32768
 MP 220, 124, 124
 v_exp_f32 v51, v67
 MP 156, 124, 120
 RA 124, 47, 31744
 s_waitcnt lgkmcnt(4)
 MP 160, 96, 120
 v_exp_f32 v52, v68
 MP 224, 96, 124
 RA 96, 46, 16384
 v_add_f32 v32, v32, v49
 MP 228, 100, 124
 DMAS 39, 8, 15, 1024
 MP 164, 100, 120
 RA 100, 46, 18432
 CV 112, 48, 49
 MP 168, 104, 120
 v_exp_f32 v53, v69
 MP 232, 104, 124
 RA 104, 46, 20480
 v_add_f32 v32, v32, v50
 MP 236, 108, 124
 v_exp_f32 v54, v70
 MP 172, 108, 120
 RA 108, 46, 22528
 s_waitcnt lgkmcnt(4)
 MP 176, 112, 120
 s_cmp_eq_u32 s19, 163840
 s_cselect_b32 s19, 65536, s19
 MP 240, 112, 124
 RA 112, 46, 24576
 v_add_f32 v32, v32, v51
 MP 244, 116, 124
 DMAS 39, 8, 15, 2048
 MP 180, 116, 120
 RA 116, 46, 26624
 CV 113, 50, 51
 MP 184, 120, 120
 v_exp_f32 v55, v71
 MP 248, 120, 124
 RA 120, 46, 28672
 v_add_f32 v32, v32, v52
 MP 252, 124, 124
 v_exp_f32 v56, v72
 MP 188, 124, 120
 RA 124, 46, 30720
 s_waitcnt lgkmcnt(4)
 MQ 80, 96, 192, 96
 v_exp_f32 v57, v73
 MQ 80, 100, 200, 80
 v_add_u32 v47, s19, v39
 v_add_f32 v32, v32, v53
 MQ 88, 96, 196, 100
 DMAS 39, 8, 15, 3072
 MQ 88, 100, 204, 88
 RA 96, 46, 17408
 s_mov_b32 m0, s20
 MQ 88, 104, 212, 88
 v_exp_f32 v58, v74
 MQ 88, 108, 220, 88
 RA 100, 46, 19456
 CV 114, 52, 53
 MQ 80, 104, 208, 80
 v_exp_f32 v59, v75
 MQ 80, 108, 216, 80
 RA 104, 46, 21504
 s_waitcnt lgkmcnt(3)
 MQ 80, 112, 224, 80
 v_add_f32 v32, v32, v54
 v_add_f32 v32, v32, v55
 MQ 80, 116, 232, 80
 RA 108, 46, 23552
 CV 115, 54, 55
 MQ 88, 112, 228, 88
 DMAS 38, 8, 15, 0
 MQ 88, 116, 236, 88
 RA 112, 46, 25600
 v_add_f32 v33, v35, v56
 MQ 88, 120, 244, 88
 v_exp_f32 v60, v76
 MQ 88, 124, 252, 88
 RA 116, 46, 27648
 v_add_f32 v33, v33, v57
 MQ 80, 120, 240, 80
 v_exp_f32 v61, v77
 MQ 80, 124, 248, 80
 RA 120, 46, 29696
 s_waitcnt lgkmcnt(3)
 MQ 84, 96, 192, 96
 CV 116, 56, 57
 v_add_f32 v33, v33, v58
 MQ 84, 100, 200, 84
 RA 124, 46, 31744
 v_add_f32 v33, v33, v59
 MQ 92, 96, 196, 100
 DMAS 38, 8, 15, 1024
 MQ 92, 100, 204, 92
 RA 96, 47, 0
 CV 117, 58, 59
 MQ 92, 104, 212, 92
 v_exp_f32 v62, v78
 MQ 92, 108, 220, 92
 RA 100, 47, 1024
 v_add_f32 v33, v33, v60
 MQ 84, 104, 208, 84
 v_exp_f32 v63, v79
 MQ 84, 108, 216, 84
 RA 104, 47, 2048
 s_waitcnt lgkmcnt(3)
 MQ 84, 112, 224, 84
 v_add_f32 v33, v33, v61
 CV 118, 60, 61
 MQ 84, 116, 232, 84
 RA 108, 47, 3072
 v_add_f32 v33, v33, v62
 MQ 92, 112, 228, 92
 DMAS 38, 8, 15, 2048
 MQ 92, 116, 236, 92
 RA 112, 47, 4096
 v_add_f32 v33, v33, v63
 MQ 92, 120, 244, 92
 CV 119, 62, 63
 v_max_f32 v2, v32, v33
 MQ 92, 124, 252, 92
 RA 116, 47, 5120
 v_cmp_lt_f32 vcc, s23, v2
 MQ 84, 120, 240, 84
 DMAS 38, 8, 15, 3072
 MQ 84, 124, 248, 84
 RA 120, 47, 6144
 RA 124, 47, 7168
 s_cbranch_vccnz P2_RS11
P2_RB11:
 s_waitcnt vmcnt(20)
 s_barrier
 s_cmp_eq_u32 s27, 0
 s_cbranch_scc1 P2_NF4
 s_mov_b64 exec, 1
 buffer_store_dword v45, v39, s[8:11], s27 offen sc1
 s_mov_b64 exec, -1
 s_mov_b32 s27, 0
P2_NF4:
 s_waitcnt lgkmcnt(4)
 MP 128, 96, 112
 s_add_u32 s15, s15, 33792
 s_add_u32 m0, s18, 16384
 MP 192, 96, 116
 RA 96, 47, 8192
 MP 196, 100, 116
 s_xor_b32 s18, s18, 32768
 MP 132, 100, 112
 RA 100, 47, 9216
 v_exp_f32 v48, v80
 v_exp_f32 v49, v81
 MP 136, 104, 112
 DMAS 39, 8, 15, 0
 v_add_f32 v34, v32, v48
 MP 200, 104, 116
 RA 104, 47, 10240
 v_exp_f32 v50, v82
 v_add_f32 v34, v34, v49
 MP 204, 108, 116
 DMAS 39, 8, 15, 1024
 CV 120, 48, 49
 MP 140, 108, 112
 RA 108, 47, 11264
 s_waitcnt lgkmcnt(4)
 v_exp_f32 v51, v83
 v_add_f32 v34, v34, v50
 MP 144, 112, 112
 DMAS 39, 8, 15, 2048
 v_exp_f32 v52, v84
 MP 208, 112, 116
 RA 112, 47, 12288
 v_add_f32 v34, v34, v51
 CV 121, 50, 51
 MP 212, 116, 116
 DMAS 39, 8, 15, 3072
 v_exp_f32 v53, v85
 MP 148, 116, 112
 RA 116, 47, 13312
 v_add_f32 v34, v34, v52
 v_exp_f32 v54, v86
 MP 152, 120, 112
 s_add_u32 m0, s20, 16384
 v_add_f32 v34, v34, v53
 MP 216, 120, 116
 RA 120, 47, 14336
 CV 122, 52, 53
 v_exp_f32 v55, v87
 MP 220, 124, 116
 s_sub_u32 s14, s14, 2
 v_xor_b32 v46, 0x8000, v46
 v_add_f32 v34, v34, v54
 MP 156, 124, 112
 RA 124, 47, 15360
 s_waitcnt lgkmcnt(4)
 v_exp_f32 v56, v88
 v_add_f32 v34, v34, v55
 MP 160, 96, 112
 DMAS 38, 8, 15, 0
 CV 123, 54, 55
 MP 224, 96, 116
 RA 96, 47, 16384
 v_exp_f32 v57, v89
 v_add_f32 v35, v33, v56
 MP 228, 100, 116
 DMAS 38, 8, 15, 1024
 v_exp_f32 v58, v90
 MP 164, 100, 112
 RA 100, 47, 17408
 v_add_f32 v35, v35, v57
 CV 124, 56, 57
 MP 168, 104, 112
 DMAS 38, 8, 15, 2048
 v_exp_f32 v59, v91
 MP 232, 104, 116
 RA 104, 47, 18432
 v_add_f32 v35, v35, v58
 v_exp_f32 v60, v92
 MP 236, 108, 116
 DMAS 38, 8, 15, 3072
 v_add_f32 v35, v35, v59
 MP 172, 108, 112
 RA 108, 47, 19456
 s_waitcnt lgkmcnt(4)
 CV 125, 58, 59
 v_exp_f32 v61, v93
 MP 176, 112, 112
 v_add_f32 v35, v35, v60
 MP 240, 112, 116
 RA 112, 47, 20480
 v_exp_f32 v62, v94
 v_add_f32 v35, v35, v61
 MP 244, 116, 116
 CV 126, 60, 61
 MP 180, 116, 112
 RA 116, 47, 21504
 v_exp_f32 v63, v95
 v_add_f32 v35, v35, v62
 MP 184, 120, 112
 v_add_f32 v35, v35, v63
 MP 248, 120, 116
 RA 120, 47, 22528
 CV 127, 62, 63
 v_max_f32 v2, v34, v35
 MP 252, 124, 116
 v_cmp_lt_f32 vcc, s23, v2
 MP 188, 124, 112
 RA 124, 47, 23552
 s_cbranch_vccnz P2_RS12
P2_RB12:
 s_waitcnt lgkmcnt(4)
 MP 128, 96, 120
 v_accvgpr_mov_b32 a192, a128
 v_accvgpr_mov_b32 a193, a129
 MP 192, 96, 124
 RA 96, 47, 24576
 v_accvgpr_mov_b32 a194, a130
 v_accvgpr_mov_b32 a195, a131
 MP 196, 100, 124
 v_accvgpr_mov_b32 a196, a132
 v_accvgpr_mov_b32 a197, a133
 MP 132, 100, 120
 RA 100, 47, 25600
 v_accvgpr_mov_b32 a198, a134
 v_accvgpr_mov_b32 a199, a135
 MP 136, 104, 120
 v_accvgpr_mov_b32 a200, a136
 v_accvgpr_mov_b32 a201, a137
 MP 200, 104, 124
 RA 104, 47, 26624
 v_accvgpr_mov_b32 a202, a138
 v_accvgpr_mov_b32 a203, a139
 MP 204, 108, 124
 v_accvgpr_mov_b32 a204, a140
 v_accvgpr_mov_b32 a205, a141
 MP 140, 108, 120
 RA 108, 47, 27648
 s_waitcnt lgkmcnt(4)
 v_accvgpr_mov_b32 a206, a142
 v_accvgpr_mov_b32 a207, a143
 MP 144, 112, 120
 v_accvgpr_mov_b32 a208, a144
 v_accvgpr_mov_b32 a209, a145
 MP 208, 112, 124
 RA 112, 47, 28672
 v_accvgpr_mov_b32 a210, a146
 v_accvgpr_mov_b32 a211, a147
 MP 212, 116, 124
 v_accvgpr_mov_b32 a212, a148
 v_accvgpr_mov_b32 a213, a149
 MP 148, 116, 120
 RA 116, 47, 29696
 v_accvgpr_mov_b32 a214, a150
 v_accvgpr_mov_b32 a215, a151
 MP 152, 120, 120
 v_accvgpr_mov_b32 a216, a152
 v_accvgpr_mov_b32 a217, a153
 MP 216, 120, 124
 RA 120, 47, 30720
 v_accvgpr_mov_b32 a218, a154
 v_accvgpr_mov_b32 a219, a155
 MP 220, 124, 124
 v_accvgpr_mov_b32 a220, a156
 v_accvgpr_mov_b32 a221, a157
 MP 156, 124, 120
 RA 124, 47, 31744
 s_waitcnt lgkmcnt(4)
 v_accvgpr_mov_b32 a222, a158
 v_accvgpr_mov_b32 a223, a159
 MP 160, 96, 120
 v_mov_b32 v2, v34
 v_accvgpr_mov_b32 a224, a160
 v_accvgpr_mov_b32 a225, a161
 MP 224, 96, 124
 RA 96, 46, 0
 v_mov_b32 v3, v35
 v_accvgpr_mov_b32 a226, a162
 v_accvgpr_mov_b32 a227, a163
 MP 228, 100, 124
 s_nop 0
 v_accvgpr_mov_b32 a228, a164
 v_accvgpr_mov_b32 a229, a165
 MP 164, 100, 120
 RA 100, 46, 2048
 v_permlane32_swap_b32 v2, v34
 v_accvgpr_mov_b32 a230, a166
 v_accvgpr_mov_b32 a231, a167
 MP 168, 104, 120
 v_permlane32_swap_b32 v3, v35
 v_accvgpr_mov_b32 a232, a168
 v_accvgpr_mov_b32 a233, a169
 MP 232, 104, 124
 RA 104, 46, 4096
 s_nop 0
 v_accvgpr_mov_b32 a234, a170
 v_accvgpr_mov_b32 a235, a171
 MP 236, 108, 124
 v_add_f32 v34, v34, v2
 v_accvgpr_mov_b32 a236, a172
 v_accvgpr_mov_b32 a237, a173
 MP 172, 108, 120
 RA 108, 46, 6144
 s_waitcnt lgkmcnt(4)
 v_add_f32 v35, v35, v3
 v_accvgpr_mov_b32 a238, a174
 v_accvgpr_mov_b32 a239, a175
 MP 176, 112, 120
 v_mov_b32 v2, v34
 v_accvgpr_mov_b32 a240, a176
 v_accvgpr_mov_b32 a241, a177
 MP 240, 112, 124
 RA 112, 46, 8192
 v_mov_b32 v3, v35
 v_accvgpr_mov_b32 a242, a178
 v_accvgpr_mov_b32 a243, a179
 MP 244, 116, 124
 s_nop 0
 v_accvgpr_mov_b32 a244, a180
 v_accvgpr_mov_b32 a245, a181
 MP 180, 116, 120
 RA 116, 46, 10240
 v_permlane16_swap_b32 v2, v34
 v_accvgpr_mov_b32 a246, a182
 v_accvgpr_mov_b32 a247, a183
 MP 184, 120, 120
 v_permlane16_swap_b32 v3, v35
 v_accvgpr_mov_b32 a248, a184
 v_accvgpr_mov_b32 a249, a185
 MP 248, 120, 124
 RA 120, 46, 12288
 s_nop 0
 v_accvgpr_mov_b32 a250, a186
 v_accvgpr_mov_b32 a251, a187
 MP 252, 124, 124
 v_add_f32 v32, v34, v2
 v_accvgpr_mov_b32 a252, a188
 v_accvgpr_mov_b32 a253, a189
 MP 188, 124, 120
 RA 124, 46, 14336
 v_add_f32 v33, v35, v3
 v_accvgpr_mov_b32 a254, a190
 v_accvgpr_mov_b32 a255, a191
P2_PART:
 s_mul_i32 s26, s28, 66560
 s_lshl_b32 s3, s4, 14
 s_add_u32 s26, s26, s3
 s_add_u32 s26, s26, 79691776
 s_lshl_b32 s25, s28, 12
 s_lshl_b32 s3, s4, 10
 s_add_u32 s25, s25, s3
 s_add_u32 s25, s25, 78905344
 s_add_u32 s53, s26, 0
 s_add_u32 s54, s26, 4096
 s_add_u32 s55, s26, 8192
 s_add_u32 s56, s26, 12288
 v_mov_b32 v8, v36
 v_mov_b32 v9, v37
 v_mov_b32 v10, v32
 v_mov_b32 v11, v33
 buffer_store_dwordx4 v[8:11], v39, s[8:11], s25 offen sc1
 s_mov_b32 s12, 1
 s_mov_b32 s13, s7
 s_mov_b32 s14, s42
 s_mov_b32 s29, 4
 s_mov_b32 s17, 0x70000000
 v_rcp_f32 v8, v32
 v_rcp_f32 v10, v33
 s_lshl_b32 s3, s28, 7
 s_add_u32 s3, s3, 78774272
 s_cmp_eq_u32 s4, 0
 s_cselect_b32 s27, s3, s27
 s_cmp_eq_u32 s14, 4
 s_cbranch_scc1 P2_PJ4
P2_SEG2:
 s_waitcnt lgkmcnt(4)
 MVZ 64, 96, 192
 PKM 128, 8
 PKM 130, 8
 MQ 64, 100, 200, 64
 PKM 132, 8
 PKM 134, 8
 MVZ 72, 96, 196
 CV 128, 128, 129
 CV 129, 130, 131
 MQ 72, 100, 204, 72
 RA 96, 46, 1024
 CV 130, 132, 133
 CV 131, 134, 135
 MQ 72, 104, 212, 72
 buffer_store_dwordx4 v[128:131], v39, s[8:11], s53 offen offset:0 sc1
 MQ 72, 108, 220, 72
 RA 100, 46, 3072
 PKM 136, 8
 PKM 138, 8
 MQ 64, 104, 208, 64
 PKM 140, 8
 PKM 142, 8
 MQ 64, 108, 216, 64
 RA 104, 46, 5120
 s_waitcnt lgkmcnt(3)
 CV 136, 136, 137
 CV 137, 138, 139
 MQ 64, 112, 224, 64
 CV 138, 140, 141
 CV 139, 142, 143
 MQ 64, 116, 232, 64
 RA 108, 46, 7168
 buffer_store_dwordx4 v[136:139], v39, s[8:11], s53 offen offset:1024 sc1
 MQ 72, 112, 228, 72
 PKM 144, 8
 PKM 146, 8
 MQ 72, 116, 236, 72
 RA 112, 46, 9216
 PKM 148, 8
 PKM 150, 8
 MQ 72, 120, 244, 72
 CV 144, 144, 145
 CV 145, 146, 147
 MQ 72, 124, 252, 72
 RA 116, 46, 11264
 CV 146, 148, 149
 CV 147, 150, 151
 MQ 64, 120, 240, 64
 buffer_store_dwordx4 v[144:147], v39, s[8:11], s53 offen offset:2048 sc1
 MQ 64, 124, 248, 64
 RA 120, 46, 13312
 s_waitcnt lgkmcnt(3)
 MVZ 68, 96, 192
 PKM 152, 8
 PKM 154, 8
 MQ 68, 100, 200, 68
 RA 124, 46, 15360
 PKM 156, 8
 PKM 158, 8
 MVZ 76, 96, 196
 CV 152, 152, 153
 CV 153, 154, 155
 MQ 76, 100, 204, 76
 CV 154, 156, 157
 CV 155, 158, 159
 MQ 76, 104, 212, 76
 buffer_store_dwordx4 v[152:155], v39, s[8:11], s53 offen offset:3072 sc1
 MQ 76, 108, 220, 76
 PKM 160, 8
 PKM 162, 8
 MQ 68, 104, 208, 68
 PKM 164, 8
 PKM 166, 8
 MQ 68, 108, 216, 68
 s_waitcnt lgkmcnt(0)
 CV 160, 160, 161
 CV 161, 162, 163
 MQ 68, 112, 224, 68
 CV 162, 164, 165
 CV 163, 166, 167
 MQ 68, 116, 232, 68
 buffer_store_dwordx4 v[160:163], v39, s[8:11], s54 offen offset:0 sc1
 MQ 76, 112, 228, 76
 PKM 168, 8
 PKM 170, 8
 MQ 76, 116, 236, 76
 PKM 172, 8
 PKM 174, 8
 MQ 76, 120, 244, 76
 CV 168, 168, 169
 CV 169, 170, 171
 MQ 76, 124, 252, 76
 CV 170, 172, 173
 CV 171, 174, 175
 MQ 68, 120, 240, 68
 buffer_store_dwordx4 v[168:171], v39, s[8:11], s54 offen offset:1024 sc1
 MQ 68, 124, 248, 68
 s_waitcnt vmcnt(20)
 s_barrier
 s_add_u32 s75, s75, s75
 s_cbranch_scc1 P2_DS3
P2_DB3:
 RA 96, 46, 16384
 RA 100, 46, 18432
 RA 104, 46, 20480
 RA 108, 46, 22528
 RA 112, 46, 24576
 RA 116, 46, 26624
 RA 120, 46, 28672
 RA 124, 46, 30720
 PKM 176, 8
 PKM 178, 8
 s_add_u32 s15, s15, 33792
 s_cmp_eq_u32 s14, s16
 s_cselect_b32 s15, s17, s15
 PKM 180, 8
 PKM 182, 8
 s_cmp_eq_u32 s14, s41
 s_cselect_b32 s15, s43, s15
 s_mov_b32 m0, s18
 v_max3_f32 v36, v64, v65, v65
 CV 176, 176, 177
 CV 177, 178, 179
 v_max3_f32 v37, v72, v73, v73
 v_max3_f32 v36, v36, v66, v67
 v_max3_f32 v37, v37, v74, v75
 v_max3_f32 v36, v36, v68, v69
 CV 178, 180, 181
 CV 179, 182, 183
 v_max3_f32 v37, v37, v76, v77
 v_max3_f32 v36, v36, v70, v71
 DMAS 39, 8, 15, 0
 v_max3_f32 v37, v37, v78, v79
 buffer_store_dwordx4 v[176:179], v39, s[8:11], s54 offen offset:2048 sc1
 v_mov_b32 v6, v36
 v_mov_b32 v7, v37
 s_nop 1
 v_permlane32_swap_b32 v6, v36
 PKM 184, 8
 PKM 186, 8
 v_permlane32_swap_b32 v7, v37
 s_nop 1
 s_add_u32 s20, s19, s21
 v_max_f32 v36, v36, v6
 PKM 188, 8
 PKM 190, 8
 v_max_f32 v37, v37, v7
 v_mov_b32 v6, v36
 v_mov_b32 v7, v37
 s_nop 1
 CV 184, 184, 185
 CV 185, 186, 187
 v_permlane16_swap_b32 v6, v36
 v_permlane16_swap_b32 v7, v37
 s_add_u32 s19, s19, 32768
 s_nop 1
 CV 186, 188, 189
 CV 187, 190, 191
 v_max_f32 v36, v36, v6
 v_max_f32 v37, v37, v7
 v_sub_f32 v96, 0, v36
 v_sub_f32 v97, 0, v36
 buffer_store_dwordx4 v[184:187], v39, s[8:11], s54 offen offset:3072 sc1
 v_sub_f32 v98, 0, v36
 v_sub_f32 v99, 0, v36
 DMAS 39, 8, 15, 1024
 v_sub_f32 v100, 0, v37
 PKM 192, 10
 PKM 194, 10
 v_sub_f32 v101, 0, v37
 v_sub_f32 v102, 0, v37
 v_sub_f32 v103, 0, v37
 v_sub_f32 v64, v64, v36
 PKM 196, 10
 PKM 198, 10
 v_sub_f32 v65, v65, v36
 v_sub_f32 v66, v66, v36
 s_cmp_eq_u32 s19, 163840
 s_cselect_b32 s19, 65536, s19
 CV 192, 192, 193
 CV 193, 194, 195
 v_sub_f32 v67, v67, v36
 v_sub_f32 v68, v68, v36
 v_sub_f32 v69, v69, v36
 v_sub_f32 v70, v70, v36
 CV 194, 196, 197
 CV 195, 198, 199
 v_sub_f32 v71, v71, v36
 v_sub_f32 v72, v72, v37
 v_sub_f32 v73, v73, v37
 DMAS 39, 8, 15, 2048
 buffer_store_dwordx4 v[192:195], v39, s[8:11], s55 offen offset:0 sc1
 v_sub_f32 v74, v74, v37
 v_sub_f32 v75, v75, v37
 v_sub_f32 v76, v76, v37
 v_sub_f32 v77, v77, v37
 PKM 200, 10
 PKM 202, 10
 v_sub_f32 v78, v78, v37
 v_sub_f32 v79, v79, v37
 v_mov_b32 v34, 0
 v_mov_b32 v35, 0
 s_waitcnt lgkmcnt(4)
 MQ 80, 96, 192, 96
 PKM 204, 10
 PKM 206, 10
 CV 200, 200, 201
 CV 201, 202, 203
 CV 202, 204, 205
 CV 203, 206, 207
 v_exp_f32 v48, v64
 v_exp_f32 v49, v65
 MQ 80, 100, 200, 80
 buffer_store_dwordx4 v[200:203], v39, s[8:11], s55 offen offset:1024 sc1
 PKM 208, 10
 PKM 210, 10
 v_add_f32 v32, v34, v48
 MQ 88, 96, 196, 100
 PKM 212, 10
 PKM 214, 10
 CV 208, 208, 209
 CV 209, 210, 211
 CV 210, 212, 213
 CV 211, 214, 215
 DMAS 39, 8, 15, 3072
 v_exp_f32 v50, v66
 v_add_f32 v32, v32, v49
 MQ 88, 100, 204, 88
 RA 96, 46, 17408
 buffer_store_dwordx4 v[208:211], v39, s[8:11], s55 offen offset:2048 sc1
 PKM 216, 10
 PKM 218, 10
 CV 112, 48, 49
 MQ 88, 104, 212, 88
 PKM 220, 10
 PKM 222, 10
 CV 216, 216, 217
 CV 217, 218, 219
 CV 218, 220, 221
 CV 219, 222, 223
 v_exp_f32 v51, v67
 MQ 88, 108, 220, 88
 RA 100, 46, 19456
 buffer_store_dwordx4 v[216:219], v39, s[8:11], s55 offen offset:3072 sc1
 PKM 224, 10
 PKM 226, 10
 v_add_f32 v32, v32, v50
 v_exp_f32 v52, v68
 MQ 80, 104, 208, 80
 PKM 228, 10
 PKM 230, 10
 CV 224, 224, 225
 CV 225, 226, 227
 s_mov_b32 m0, s20
 v_add_f32 v32, v32, v51
 MQ 80, 108, 216, 80
 RA 104, 46, 21504
 s_waitcnt lgkmcnt(3)
 CV 226, 228, 229
 CV 227, 230, 231
 buffer_store_dwordx4 v[224:227], v39, s[8:11], s56 offen offset:0 sc1
 PKM 232, 10
 PKM 234, 10
 CV 113, 50, 51
 MQ 80, 112, 224, 80
 PKM 236, 10
 PKM 238, 10
 CV 232, 232, 233
 CV 233, 234, 235
 v_exp_f32 v53, v69
 v_add_f32 v32, v32, v52
 MQ 80, 116, 232, 80
 RA 108, 46, 23552
 CV 234, 236, 237
 CV 235, 238, 239
 buffer_store_dwordx4 v[232:235], v39, s[8:11], s56 offen offset:1024 sc1
 PKM 240, 10
 PKM 242, 10
 v_exp_f32 v54, v70
 MQ 88, 112, 228, 88
 PKM 244, 10
 PKM 246, 10
 CV 240, 240, 241
 CV 241, 242, 243
 v_add_f32 v32, v32, v53
 MQ 88, 116, 236, 88
 RA 112, 46, 25600
 CV 242, 244, 245
 CV 243, 246, 247
 buffer_store_dwordx4 v[240:243], v39, s[8:11], s56 offen offset:2048 sc1
 PKM 248, 10
 PKM 250, 10
 CV 114, 52, 53
 v_exp_f32 v55, v71
 MQ 88, 120, 244, 88
 PKM 252, 10
 PKM 254, 10
 CV 248, 248, 249
 CV 249, 250, 251
 v_add_f32 v32, v32, v54
 MQ 88, 124, 252, 88
 RA 116, 46, 27648
 CV 250, 252, 253
 CV 251, 254, 255
 buffer_store_dwordx4 v[248:251], v39, s[8:11], s56 offen offset:3072 sc1
 v_exp_f32 v56, v72
 MQ 80, 120, 240, 80
 v_add_f32 v32, v32, v55
 CV 115, 54, 55
 MQ 80, 124, 248, 80
 RA 120, 46, 29696
 s_waitcnt lgkmcnt(3)
 v_exp_f32 v57, v73
 MQ 84, 96, 192, 96
 DMAS 38, 8, 15, 0
 v_add_u32 v47, s19, v39
 v_add_f32 v33, v35, v56
 v_exp_f32 v58, v74
 MQ 84, 100, 200, 84
 RA 124, 46, 31744
 v_add_f32 v33, v33, v57
 MQ 92, 96, 196, 100
 CV 116, 56, 57
 MQ 92, 100, 204, 92
 RA 96, 47, 0
 v_exp_f32 v59, v75
 v_add_f32 v33, v33, v58
 MQ 92, 104, 212, 92
 DMAS 38, 8, 15, 1024
 v_exp_f32 v60, v76
 MQ 92, 108, 220, 92
 RA 100, 47, 1024
 v_add_f32 v33, v33, v59
 MQ 84, 104, 208, 84
 CV 117, 58, 59
 v_exp_f32 v61, v77
 MQ 84, 108, 216, 84
 RA 104, 47, 2048
 s_waitcnt lgkmcnt(3)
 v_add_f32 v33, v33, v60
 MQ 84, 112, 224, 84
 DMAS 38, 8, 15, 2048
 v_exp_f32 v62, v78
 MQ 84, 116, 232, 84
 RA 108, 47, 3072
 v_add_f32 v33, v33, v61
 CV 118, 60, 61
 MQ 92, 112, 228, 92
 v_exp_f32 v63, v79
 MQ 92, 116, 236, 92
 RA 112, 47, 4096
 v_add_f32 v33, v33, v62
 MQ 92, 120, 244, 92
 DMAS 38, 8, 15, 3072
 v_add_f32 v33, v33, v63
 CV 119, 62, 63
 MQ 92, 124, 252, 92
 RA 116, 47, 5120
 v_max_f32 v2, v32, v33
 MQ 84, 120, 240, 84
 v_cmp_lt_f32 vcc, s23, v2
 MQ 84, 124, 248, 84
 RA 120, 47, 6144
 RA 124, 47, 7168
 s_cbranch_vccnz P2_RS13
P2_RB13:
 s_branch P2_L1Z
P2_PJ4:
 PKM 128, 8
 PKM 130, 8
 PKM 132, 8
 PKM 134, 8
 CV 128, 128, 129
 CV 129, 130, 131
 CV 130, 132, 133
 CV 131, 134, 135
 buffer_store_dwordx4 v[128:131], v39, s[8:11], s53 offen offset:0 sc1
 PKM 136, 8
 PKM 138, 8
 PKM 140, 8
 PKM 142, 8
 CV 136, 136, 137
 CV 137, 138, 139
 CV 138, 140, 141
 CV 139, 142, 143
 buffer_store_dwordx4 v[136:139], v39, s[8:11], s53 offen offset:1024 sc1
 PKM 144, 8
 PKM 146, 8
 PKM 148, 8
 PKM 150, 8
 CV 144, 144, 145
 CV 145, 146, 147
 CV 146, 148, 149
 CV 147, 150, 151
 buffer_store_dwordx4 v[144:147], v39, s[8:11], s53 offen offset:2048 sc1
 PKM 152, 8
 PKM 154, 8
 PKM 156, 8
 PKM 158, 8
 CV 152, 152, 153
 CV 153, 154, 155
 CV 154, 156, 157
 CV 155, 158, 159
 buffer_store_dwordx4 v[152:155], v39, s[8:11], s53 offen offset:3072 sc1
 PKM 160, 8
 PKM 162, 8
 PKM 164, 8
 PKM 166, 8
 CV 160, 160, 161
 CV 161, 162, 163
 CV 162, 164, 165
 CV 163, 166, 167
 buffer_store_dwordx4 v[160:163], v39, s[8:11], s54 offen offset:0 sc1
 PKM 168, 8
 PKM 170, 8
 PKM 172, 8
 PKM 174, 8
 CV 168, 168, 169
 CV 169, 170, 171
 CV 170, 172, 173
 CV 171, 174, 175
 buffer_store_dwordx4 v[168:171], v39, s[8:11], s54 offen offset:1024 sc1
 PKM 176, 8
 PKM 178, 8
 PKM 180, 8
 PKM 182, 8
 CV 176, 176, 177
 CV 177, 178, 179
 CV 178, 180, 181
 CV 179, 182, 183
 buffer_store_dwordx4 v[176:179], v39, s[8:11], s54 offen offset:2048 sc1
 PKM 184, 8
 PKM 186, 8
 PKM 188, 8
 PKM 190, 8
 CV 184, 184, 185
 CV 185, 186, 187
 CV 186, 188, 189
 CV 187, 190, 191
 buffer_store_dwordx4 v[184:187], v39, s[8:11], s54 offen offset:3072 sc1
 PKM 192, 10
 PKM 194, 10
 PKM 196, 10
 PKM 198, 10
 CV 192, 192, 193
 CV 193, 194, 195
 CV 194, 196, 197
 CV 195, 198, 199
 buffer_store_dwordx4 v[192:195], v39, s[8:11], s55 offen offset:0 sc1
 PKM 200, 10
 PKM 202, 10
 PKM 204, 10
 PKM 206, 10
 CV 200, 200, 201
 CV 201, 202, 203
 CV 202, 204, 205
 CV 203, 206, 207
 buffer_store_dwordx4 v[200:203], v39, s[8:11], s55 offen offset:1024 sc1
 PKM 208, 10
 PKM 210, 10
 PKM 212, 10
 PKM 214, 10
 CV 208, 208, 209
 CV 209, 210, 211
 CV 210, 212, 213
 CV 211, 214, 215
 buffer_store_dwordx4 v[208:211], v39, s[8:11], s55 offen offset:2048 sc1
 PKM 216, 10
 PKM 218, 10
 PKM 220, 10
 PKM 222, 10
 CV 216, 216, 217
 CV 217, 218, 219
 CV 218, 220, 221
 CV 219, 222, 223
 buffer_store_dwordx4 v[216:219], v39, s[8:11], s55 offen offset:3072 sc1
 PKM 224, 10
 PKM 226, 10
 PKM 228, 10
 PKM 230, 10
 CV 224, 224, 225
 CV 225, 226, 227
 CV 226, 228, 229
 CV 227, 230, 231
 buffer_store_dwordx4 v[224:227], v39, s[8:11], s56 offen offset:0 sc1
 PKM 232, 10
 PKM 234, 10
 PKM 236, 10
 PKM 238, 10
 CV 232, 232, 233
 CV 233, 234, 235
 CV 234, 236, 237
 CV 235, 238, 239
 buffer_store_dwordx4 v[232:235], v39, s[8:11], s56 offen offset:1024 sc1
 PKM 240, 10
 PKM 242, 10
 PKM 244, 10
 PKM 246, 10
 CV 240, 240, 241
 CV 241, 242, 243
 CV 242, 244, 245
 CV 243, 246, 247
 buffer_store_dwordx4 v[240:243], v39, s[8:11], s56 offen offset:2048 sc1
 PKM 248, 10
 PKM 250, 10
 PKM 252, 10
 PKM 254, 10
 CV 248, 248, 249
 CV 249, 250, 251
 CV 250, 252, 253
 CV 251, 254, 255
 buffer_store_dwordx4 v[248:251], v39, s[8:11], s56 offen offset:3072 sc1
P2_SEG:
 s_waitcnt lgkmcnt(4)
 MVZ 64, 96, 192
 MQ 64, 100, 200, 64
 MVZ 72, 96, 196
 MQ 72, 100, 204, 72
 RA 96, 46, 1024
 MQ 72, 104, 212, 72
 MQ 72, 108, 220, 72
 RA 100, 46, 3072
 MQ 64, 104, 208, 64
 MQ 64, 108, 216, 64
 RA 104, 46, 5120
 s_waitcnt lgkmcnt(3)
 MQ 64, 112, 224, 64
 MQ 64, 116, 232, 64
 RA 108, 46, 7168
 MQ 72, 112, 228, 72
 MQ 72, 116, 236, 72
 RA 112, 46, 9216
 MQ 72, 120, 244, 72
 MQ 72, 124, 252, 72
 RA 116, 46, 11264
 MQ 64, 120, 240, 64
 MQ 64, 124, 248, 64
 RA 120, 46, 13312
 s_waitcnt lgkmcnt(3)
 MVZ 68, 96, 192
 MQ 68, 100, 200, 68
 RA 124, 46, 15360
 MVZ 76, 96, 196
 MQ 76, 100, 204, 76
 MQ 76, 104, 212, 76
 MQ 76, 108, 220, 76
 MQ 68, 104, 208, 68
 MQ 68, 108, 216, 68
 s_waitcnt lgkmcnt(0)
 MQ 68, 112, 224, 68
 MQ 68, 116, 232, 68
 MQ 76, 112, 228, 76
 MQ 76, 116, 236, 76
 MQ 76, 120, 244, 76
 MQ 76, 124, 252, 76
 MQ 68, 120, 240, 68
 MQ 68, 124, 248, 68
 s_cmp_lg_u32 s14, 4
 s_cbranch_scc1 P2_F0
P2_J4:
 RA 96, 47, 16384
 RA 100, 47, 17408
 RA 104, 47, 18432
 RA 108, 47, 19456
 RA 112, 47, 20480
 RA 116, 47, 21504
 RA 120, 47, 22528
 RA 124, 47, 23552
 v_pk_mov_b32 v[128:129], 0, 0
 v_pk_mov_b32 v[130:131], 0, 0
 v_pk_mov_b32 v[132:133], 0, 0
 v_pk_mov_b32 v[134:135], 0, 0
 v_pk_mov_b32 v[136:137], 0, 0
 v_pk_mov_b32 v[138:139], 0, 0
 v_pk_mov_b32 v[140:141], 0, 0
 v_pk_mov_b32 v[142:143], 0, 0
 v_pk_mov_b32 v[144:145], 0, 0
 v_pk_mov_b32 v[146:147], 0, 0
 v_pk_mov_b32 v[148:149], 0, 0
 v_pk_mov_b32 v[150:151], 0, 0
 v_pk_mov_b32 v[152:153], 0, 0
 v_pk_mov_b32 v[154:155], 0, 0
 v_pk_mov_b32 v[156:157], 0, 0
 v_pk_mov_b32 v[158:159], 0, 0
 v_pk_mov_b32 v[160:161], 0, 0
 v_pk_mov_b32 v[162:163], 0, 0
 v_pk_mov_b32 v[164:165], 0, 0
 v_pk_mov_b32 v[166:167], 0, 0
 v_pk_mov_b32 v[168:169], 0, 0
 v_pk_mov_b32 v[170:171], 0, 0
 v_pk_mov_b32 v[172:173], 0, 0
 v_pk_mov_b32 v[174:175], 0, 0
 v_pk_mov_b32 v[176:177], 0, 0
 v_pk_mov_b32 v[178:179], 0, 0
 v_pk_mov_b32 v[180:181], 0, 0
 v_pk_mov_b32 v[182:183], 0, 0
 v_pk_mov_b32 v[184:185], 0, 0
 v_pk_mov_b32 v[186:187], 0, 0
 v_pk_mov_b32 v[188:189], 0, 0
 v_pk_mov_b32 v[190:191], 0, 0
 v_pk_mov_b32 v[192:193], 0, 0
 v_pk_mov_b32 v[194:195], 0, 0
 v_pk_mov_b32 v[196:197], 0, 0
 v_pk_mov_b32 v[198:199], 0, 0
 v_pk_mov_b32 v[200:201], 0, 0
 v_pk_mov_b32 v[202:203], 0, 0
 v_pk_mov_b32 v[204:205], 0, 0
 v_pk_mov_b32 v[206:207], 0, 0
 v_pk_mov_b32 v[208:209], 0, 0
 v_pk_mov_b32 v[210:211], 0, 0
 v_pk_mov_b32 v[212:213], 0, 0
 v_pk_mov_b32 v[214:215], 0, 0
 v_pk_mov_b32 v[216:217], 0, 0
 v_pk_mov_b32 v[218:219], 0, 0
 v_pk_mov_b32 v[220:221], 0, 0
 v_pk_mov_b32 v[222:223], 0, 0
 v_pk_mov_b32 v[224:225], 0, 0
 v_pk_mov_b32 v[226:227], 0, 0
 v_pk_mov_b32 v[228:229], 0, 0
 v_pk_mov_b32 v[230:231], 0, 0
 v_pk_mov_b32 v[232:233], 0, 0
 v_pk_mov_b32 v[234:235], 0, 0
 v_pk_mov_b32 v[236:237], 0, 0
 v_pk_mov_b32 v[238:239], 0, 0
 v_pk_mov_b32 v[240:241], 0, 0
 v_pk_mov_b32 v[242:243], 0, 0
 v_pk_mov_b32 v[244:245], 0, 0
 v_pk_mov_b32 v[246:247], 0, 0
 v_pk_mov_b32 v[248:249], 0, 0
 v_pk_mov_b32 v[250:251], 0, 0
 v_pk_mov_b32 v[252:253], 0, 0
 v_pk_mov_b32 v[254:255], 0, 0
 v_mov_b32 v120, 0
 v_mov_b32 v121, 0
 v_mov_b32 v122, 0
 v_mov_b32 v123, 0
 v_mov_b32 v124, 0
 v_mov_b32 v125, 0
 v_mov_b32 v126, 0
 v_mov_b32 v127, 0
 s_lshl_b32 s3, s4, 4
 v_add_u32 v44, s3, v43
 s_sub_u32 s3, 112, s3
 v_add_u32 v104, s3, v43
 v_cmp_gt_i32 s[32:33], 0, v44
 v_cmp_gt_i32 s[34:35], 1, v44
 v_cmp_gt_i32 s[36:37], 2, v44
 v_cmp_gt_i32 s[38:39], 3, v44
 s_nop 0
 v_cndmask_b32 v64, v64, v45, s[32:33]
 v_cndmask_b32 v65, v65, v45, s[34:35]
 v_cndmask_b32 v66, v66, v45, s[36:37]
 v_cndmask_b32 v67, v67, v45, s[38:39]
 v_cmp_gt_i32 s[32:33], 16, v44
 v_cmp_gt_i32 s[34:35], 17, v44
 v_cmp_gt_i32 s[36:37], 18, v44
 v_cmp_gt_i32 s[38:39], 19, v44
 s_nop 0
 v_cndmask_b32 v68, v68, v45, s[32:33]
 v_cndmask_b32 v69, v69, v45, s[34:35]
 v_cndmask_b32 v70, v70, v45, s[36:37]
 v_cndmask_b32 v71, v71, v45, s[38:39]
 v_cmp_gt_i32 s[32:33], 0, v104
 v_cmp_gt_i32 s[34:35], 1, v104
 v_cmp_gt_i32 s[36:37], 2, v104
 v_cmp_gt_i32 s[38:39], 3, v104
 s_nop 0
 v_cndmask_b32 v72, v72, v45, s[32:33]
 v_cndmask_b32 v73, v73, v45, s[34:35]
 v_cndmask_b32 v74, v74, v45, s[36:37]
 v_cndmask_b32 v75, v75, v45, s[38:39]
 v_cmp_gt_i32 s[32:33], 16, v104
 v_cmp_gt_i32 s[34:35], 17, v104
 v_cmp_gt_i32 s[36:37], 18, v104
 v_cmp_gt_i32 s[38:39], 19, v104
 s_nop 0
 v_cndmask_b32 v76, v76, v45, s[32:33]
 v_cndmask_b32 v77, v77, v45, s[34:35]
 v_cndmask_b32 v78, v78, v45, s[36:37]
 v_cndmask_b32 v79, v79, v45, s[38:39]
 s_lshl_b32 s3, s4, 4
 s_and_b32 s3, s3, 16
 v_add_u32 v44, s3, v43
 s_sub_u32 s3, 16, s3
 v_add_u32 v104, s3, v43
 v_max3_f32 v36, v64, v65, v65
 v_max3_f32 v37, v72, v73, v73
 v_max3_f32 v36, v36, v66, v67
 v_max3_f32 v37, v37, v74, v75
 v_max3_f32 v36, v36, v68, v69
 v_max3_f32 v37, v37, v76, v77
 v_max3_f32 v36, v36, v70, v71
 v_max3_f32 v37, v37, v78, v79
 v_mov_b32 v6, v36
 v_mov_b32 v7, v37
 s_nop 1
 v_permlane32_swap_b32 v6, v36
 v_permlane32_swap_b32 v7, v37
 s_nop 1
 v_max_f32 v36, v36, v6
 v_max_f32 v37, v37, v7
 v_mov_b32 v6, v36
 v_mov_b32 v7, v37
 s_nop 1
 v_permlane16_swap_b32 v6, v36
 v_permlane16_swap_b32 v7, v37
 s_nop 1
 v_max_f32 v36, v36, v6
 v_max_f32 v37, v37, v7
 v_sub_f32 v96, 0, v36
 v_sub_f32 v97, 0, v36
 v_sub_f32 v98, 0, v36
 v_sub_f32 v99, 0, v36
 v_sub_f32 v100, 0, v37
 v_sub_f32 v101, 0, v37
 v_sub_f32 v102, 0, v37
 v_sub_f32 v103, 0, v37
 v_sub_f32 v64, v64, v36
 v_sub_f32 v65, v65, v36
 v_sub_f32 v66, v66, v36
 v_sub_f32 v67, v67, v36
 v_sub_f32 v68, v68, v36
 v_sub_f32 v69, v69, v36
 v_sub_f32 v70, v70, v36
 v_sub_f32 v71, v71, v36
 v_sub_f32 v72, v72, v37
 v_sub_f32 v73, v73, v37
 v_sub_f32 v74, v74, v37
 v_sub_f32 v75, v75, v37
 v_sub_f32 v76, v76, v37
 v_sub_f32 v77, v77, v37
 v_sub_f32 v78, v78, v37
 v_sub_f32 v79, v79, v37
 v_mov_b32 v34, 0
 v_mov_b32 v35, 0
 s_branch P2_TAILS
P2_DS0:
 s_call_b64 s[30:31], P2_DRAIN
 s_branch P2_DB0
P2_DS1:
 s_call_b64 s[30:31], P2_DRAIN
 s_branch P2_DB1
P2_DS2:
 s_call_b64 s[30:31], P2_DRAIN
 s_branch P2_DB2
P2_DS3:
 s_call_b64 s[30:31], P2_DRAIN
 s_branch P2_DB3
P2_LFS:
 s_cmp_eq_u32 s27, 0
 s_cbranch_scc1 P2_NF5
 s_mov_b64 exec, 1
 buffer_store_dword v45, v39, s[8:11], s27 offen sc1
 s_mov_b64 exec, -1
 s_mov_b32 s27, 0
P2_NF5:
 s_branch P2_LFB
P2_DRAIN:
 s_cmp_lg_u32 s76, 0
 s_cbranch_scc1 P2_VF0
 s_mov_b32 s76, 1
 buffer_load_dword v12, v13, s[8:11], s78 offen sc1
 s_setpc_b64 s[30:31]
P2_VF0:
 s_waitcnt vmcnt(48)
P2_VF:
 v_cmp_eq_u32 vcc, 0, v12
 s_nop 1
 s_cbranch_vccz P2_VG
 buffer_load_dword v12, v13, s[8:11], s78 offen sc1
 s_waitcnt vmcnt(0)
 s_branch P2_VF
P2_VG:
 s_setpc_b64 s[30:31]
P2_RS0:
 s_cselect_b32 s26, 1, 0
 s_call_b64 s[30:31], P2_RARE0
 s_cmp_eq_u32 s26, 1
 s_branch P2_RB0
P2_RS1:
 s_cselect_b32 s26, 1, 0
 s_call_b64 s[30:31], P2_RARE1
 s_cmp_eq_u32 s26, 1
 s_branch P2_RB1
P2_RS2:
 s_cselect_b32 s26, 1, 0
 s_call_b64 s[30:31], P2_RARE0
 s_cmp_eq_u32 s26, 1
 s_branch P2_RB2
P2_RS3:
 s_cselect_b32 s26, 1, 0
 s_call_b64 s[30:31], P2_RARE1
 s_cmp_eq_u32 s26, 1
 s_branch P2_RB3
P2_RS4:
 s_cselect_b32 s26, 1, 0
 s_call_b64 s[30:31], P2_RARE0
 s_cmp_eq_u32 s26, 1
 s_branch P2_RB4
P2_RS5:
 s_cselect_b32 s26, 1, 0
 s_call_b64 s[30:31], P2_RARE1
 s_cmp_eq_u32 s26, 1
 s_branch P2_RB5
P2_RS6:
 s_cselect_b32 s26, 1, 0
 s_call_b64 s[30:31], P2_RARE0
 s_cmp_eq_u32 s26, 1
 s_branch P2_RB6
P2_RS7:
 s_cselect_b32 s26, 1, 0
 s_call_b64 s[30:31], P2_RARE1
 s_cmp_eq_u32 s26, 1
 s_branch P2_RB7
P2_RS8:
 s_cselect_b32 s26, 1, 0
 s_call_b64 s[30:31], P2_RARE0
 s_cmp_eq_u32 s26, 1
 s_branch P2_RB8
P2_RS9:
 s_cselect_b32 s26, 1, 0
 s_call_b64 s[30:31], P2_RARE1
 s_cmp_eq_u32 s26, 1
 s_branch P2_RB9
P2_RS10:
 s_cselect_b32 s26, 1, 0
 s_call_b64 s[30:31], P2_RARE0
 s_cmp_eq_u32 s26, 1
 s_branch P2_RB10
P2_RS11:
 s_cselect_b32 s26, 1, 0
 s_call_b64 s[30:31], P2_RARE0
 s_cmp_eq_u32 s26, 1
 s_branch P2_RB11
P2_RS12:
 s_cselect_b32 s26, 1, 0
 s_call_b64 s[30:31], P2_RARE1
 s_cmp_eq_u32 s26, 1
 s_branch P2_RB12
P2_RS13:
 s_cselect_b32 s26, 1, 0
 s_call_b64 s[30:31], P2_RARE0
 s_cmp_eq_u32 s26, 1
 s_branch P2_RB13
P2_RARE0:
 s_nop 15
 v_log_f32 v6, v34
 v_log_f32 v7, v35
 v_max3_f32 v2, v64, v65, 0
 v_max3_f32 v3, v72, v73, 0
 v_max_f32 v2, v2, v6
 v_max_f32 v3, v3, v7
 v_max3_f32 v2, v2, v66, v67
 v_max3_f32 v3, v3, v74, v75
 v_max3_f32 v2, v2, v68, v69
 v_max3_f32 v3, v3, v76, v77
 v_max3_f32 v2, v2, v70, v71
 v_max3_f32 v3, v3, v78, v79
 v_mov_b32 v6, v2
 v_mov_b32 v7, v3
 s_nop 1
 v_permlane32_swap_b32 v6, v2
 v_permlane32_swap_b32 v7, v3
 s_nop 1
 v_max_f32 v2, v2, v6
 v_max_f32 v3, v3, v7
 v_mov_b32 v6, v2
 v_mov_b32 v7, v3
 s_nop 1
 v_permlane16_swap_b32 v6, v2
 v_permlane16_swap_b32 v7, v3
 s_nop 1
 v_max_f32 v2, v2, v6
 v_max_f32 v3, v3, v7
 v_exp_f32 v4, -v2
 v_exp_f32 v6, -v3
 v_add_f32 v36, v36, v2
 v_add_f32 v37, v37, v3
 v_sub_f32 v64, v64, v2
 v_sub_f32 v80, v80, v2
 v_sub_f32 v65, v65, v2
 v_sub_f32 v81, v81, v2
 v_sub_f32 v66, v66, v2
 v_sub_f32 v82, v82, v2
 v_sub_f32 v67, v67, v2
 v_sub_f32 v83, v83, v2
 v_sub_f32 v68, v68, v2
 v_sub_f32 v84, v84, v2
 v_sub_f32 v69, v69, v2
 v_sub_f32 v85, v85, v2
 v_sub_f32 v70, v70, v2
 v_sub_f32 v86, v86, v2
 v_sub_f32 v71, v71, v2
 v_sub_f32 v87, v87, v2
 v_sub_f32 v72, v72, v3
 v_sub_f32 v88, v88, v3
 v_sub_f32 v73, v73, v3
 v_sub_f32 v89, v89, v3
 v_sub_f32 v74, v74, v3
 v_sub_f32 v90, v90, v3
 v_sub_f32 v75, v75, v3
 v_sub_f32 v91, v91, v3
 v_sub_f32 v76, v76, v3
 v_sub_f32 v92, v92, v3
 v_sub_f32 v77, v77, v3
 v_sub_f32 v93, v93, v3
 v_sub_f32 v78, v78, v3
 v_sub_f32 v94, v94, v3
 v_sub_f32 v79, v79, v3
 v_sub_f32 v95, v95, v3
 v_sub_f32 v96, 0, v36
 v_sub_f32 v97, 0, v36
 v_sub_f32 v98, 0, v36
 v_sub_f32 v99, 0, v36
 v_sub_f32 v100, 0, v37
 v_sub_f32 v101, 0, v37
 v_sub_f32 v102, 0, v37
 v_sub_f32 v103, 0, v37
 v_mul_f32 v34, v34, v4
 v_mul_f32 v35, v35, v6
 PKM 128, 4
 PKM 130, 4
 PKM 132, 4
 PKM 134, 4
 PKM 136, 4
 PKM 138, 4
 PKM 140, 4
 PKM 142, 4
 PKM 144, 4
 PKM 146, 4
 PKM 148, 4
 PKM 150, 4
 PKM 152, 4
 PKM 154, 4
 PKM 156, 4
 PKM 158, 4
 PKM 160, 4
 PKM 162, 4
 PKM 164, 4
 PKM 166, 4
 PKM 168, 4
 PKM 170, 4
 PKM 172, 4
 PKM 174, 4
 PKM 176, 4
 PKM 178, 4
 PKM 180, 4
 PKM 182, 4
 PKM 184, 4
 PKM 186, 4
 PKM 188, 4
 PKM 190, 4
 PKM 192, 6
 PKM 194, 6
 PKM 196, 6
 PKM 198, 6
 PKM 200, 6
 PKM 202, 6
 PKM 204, 6
 PKM 206, 6
 PKM 208, 6
 PKM 210, 6
 PKM 212, 6
 PKM 214, 6
 PKM 216, 6
 PKM 218, 6
 PKM 220, 6
 PKM 222, 6
 PKM 224, 6
 PKM 226, 6
 PKM 228, 6
 PKM 230, 6
 PKM 232, 6
 PKM 234, 6
 PKM 236, 6
 PKM 238, 6
 PKM 240, 6
 PKM 242, 6
 PKM 244, 6
 PKM 246, 6
 PKM 248, 6
 PKM 250, 6
 PKM 252, 6
 PKM 254, 6
 v_exp_f32 v48, v64
 v_exp_f32 v49, v65
 v_add_f32 v32, v34, v48
 v_exp_f32 v50, v66
 v_add_f32 v32, v32, v49
 CV 112, 48, 49
 v_exp_f32 v51, v67
 v_add_f32 v32, v32, v50
 v_exp_f32 v52, v68
 v_add_f32 v32, v32, v51
 CV 113, 50, 51
 v_exp_f32 v53, v69
 v_add_f32 v32, v32, v52
 v_exp_f32 v54, v70
 v_add_f32 v32, v32, v53
 CV 114, 52, 53
 v_exp_f32 v55, v71
 v_add_f32 v32, v32, v54
 v_exp_f32 v56, v72
 v_add_f32 v32, v32, v55
 CV 115, 54, 55
 v_exp_f32 v57, v73
 v_add_f32 v33, v35, v56
 v_exp_f32 v58, v74
 v_add_f32 v33, v33, v57
 CV 116, 56, 57
 v_exp_f32 v59, v75
 v_add_f32 v33, v33, v58
 v_exp_f32 v60, v76
 v_add_f32 v33, v33, v59
 CV 117, 58, 59
 v_exp_f32 v61, v77
 v_add_f32 v33, v33, v60
 v_exp_f32 v62, v78
 v_add_f32 v33, v33, v61
 CV 118, 60, 61
 v_exp_f32 v63, v79
 v_add_f32 v33, v33, v62
 v_add_f32 v33, v33, v63
 CV 119, 62, 63
 s_nop 1
 s_setpc_b64 s[30:31]
P2_RARE1:
 s_nop 15
 v_log_f32 v6, v32
 v_log_f32 v7, v33
 v_max3_f32 v2, v80, v81, 0
 v_max3_f32 v3, v88, v89, 0
 v_max_f32 v2, v2, v6
 v_max_f32 v3, v3, v7
 v_max3_f32 v2, v2, v82, v83
 v_max3_f32 v3, v3, v90, v91
 v_max3_f32 v2, v2, v84, v85
 v_max3_f32 v3, v3, v92, v93
 v_max3_f32 v2, v2, v86, v87
 v_max3_f32 v3, v3, v94, v95
 v_mov_b32 v6, v2
 v_mov_b32 v7, v3
 s_nop 1
 v_permlane32_swap_b32 v6, v2
 v_permlane32_swap_b32 v7, v3
 s_nop 1
 v_max_f32 v2, v2, v6
 v_max_f32 v3, v3, v7
 v_mov_b32 v6, v2
 v_mov_b32 v7, v3
 s_nop 1
 v_permlane16_swap_b32 v6, v2
 v_permlane16_swap_b32 v7, v3
 s_nop 1
 v_max_f32 v2, v2, v6
 v_max_f32 v3, v3, v7
 v_exp_f32 v4, -v2
 v_exp_f32 v6, -v3
 v_add_f32 v36, v36, v2
 v_add_f32 v37, v37, v3
 v_sub_f32 v80, v80, v2
 v_sub_f32 v64, v64, v2
 v_sub_f32 v81, v81, v2
 v_sub_f32 v65, v65, v2
 v_sub_f32 v82, v82, v2
 v_sub_f32 v66, v66, v2
 v_sub_f32 v83, v83, v2
 v_sub_f32 v67, v67, v2
 v_sub_f32 v84, v84, v2
 v_sub_f32 v68, v68, v2
 v_sub_f32 v85, v85, v2
 v_sub_f32 v69, v69, v2
 v_sub_f32 v86, v86, v2
 v_sub_f32 v70, v70, v2
 v_sub_f32 v87, v87, v2
 v_sub_f32 v71, v71, v2
 v_sub_f32 v88, v88, v3
 v_sub_f32 v72, v72, v3
 v_sub_f32 v89, v89, v3
 v_sub_f32 v73, v73, v3
 v_sub_f32 v90, v90, v3
 v_sub_f32 v74, v74, v3
 v_sub_f32 v91, v91, v3
 v_sub_f32 v75, v75, v3
 v_sub_f32 v92, v92, v3
 v_sub_f32 v76, v76, v3
 v_sub_f32 v93, v93, v3
 v_sub_f32 v77, v77, v3
 v_sub_f32 v94, v94, v3
 v_sub_f32 v78, v78, v3
 v_sub_f32 v95, v95, v3
 v_sub_f32 v79, v79, v3
 v_sub_f32 v96, 0, v36
 v_sub_f32 v97, 0, v36
 v_sub_f32 v98, 0, v36
 v_sub_f32 v99, 0, v36
 v_sub_f32 v100, 0, v37
 v_sub_f32 v101, 0, v37
 v_sub_f32 v102, 0, v37
 v_sub_f32 v103, 0, v37
 v_mul_f32 v32, v32, v4
 v_mul_f32 v33, v33, v6
 PKM 128, 4
 PKM 130, 4
 PKM 132, 4
 PKM 134, 4
 PKM 136, 4
 PKM 138, 4
 PKM 140, 4
 PKM 142, 4
 PKM 144, 4
 PKM 146, 4
 PKM 148, 4
 PKM 150, 4
 PKM 152, 4
 PKM 154, 4
 PKM 156, 4
 PKM 158, 4
 PKM 160, 4
 PKM 162, 4
 PKM 164, 4
 PKM 166, 4
 PKM 168, 4
 PKM 170, 4
 PKM 172, 4
 PKM 174, 4
 PKM 176, 4
 PKM 178, 4
 PKM 180, 4
 PKM 182, 4
 PKM 184, 4
 PKM 186, 4
 PKM 188, 4
 PKM 190, 4
 PKM 192, 6
 PKM 194, 6
 PKM 196, 6
 PKM 198, 6
 PKM 200, 6
 PKM 202, 6
 PKM 204, 6
 PKM 206, 6
 PKM 208, 6
 PKM 210, 6
 PKM 212, 6
 PKM 214, 6
 PKM 216, 6
 PKM 218, 6
 PKM 220, 6
 PKM 222, 6
 PKM 224, 6
 PKM 226, 6
 PKM 228, 6
 PKM 230, 6
 PKM 232, 6
 PKM 234, 6
 PKM 236, 6
 PKM 238, 6
 PKM 240, 6
 PKM 242, 6
 PKM 244, 6
 PKM 246, 6
 PKM 248, 6
 PKM 250, 6
 PKM 252, 6
 PKM 254, 6
 v_exp_f32 v48, v80
 v_exp_f32 v49, v81
 v_add_f32 v34, v32, v48
 v_exp_f32 v50, v82
 v_add_f32 v34, v34, v49
 CV 120, 48, 49
 v_exp_f32 v51, v83
 v_add_f32 v34, v34, v50
 v_exp_f32 v52, v84
 v_add_f32 v34, v34, v51
 CV 121, 50, 51
 v_exp_f32 v53, v85
 v_add_f32 v34, v34, v52
 v_exp_f32 v54, v86
 v_add_f32 v34, v34, v53
 CV 122, 52, 53
 v_exp_f32 v55, v87
 v_add_f32 v34, v34, v54
 v_exp_f32 v56, v88
 v_add_f32 v34, v34, v55
 CV 123, 54, 55
 v_exp_f32 v57, v89
 v_add_f32 v35, v33, v56
 v_exp_f32 v58, v90
 v_add_f32 v35, v35, v57
 CV 124, 56, 57
 v_exp_f32 v59, v91
 v_add_f32 v35, v35, v58
 v_exp_f32 v60, v92
 v_add_f32 v35, v35, v59
 CV 125, 58, 59
 v_exp_f32 v61, v93
 v_add_f32 v35, v35, v60
 v_exp_f32 v62, v94
 v_add_f32 v35, v35, v61
 CV 126, 60, 61
 v_exp_f32 v63, v95
 v_add_f32 v35, v35, v62
 v_add_f32 v35, v35, v63
 CV 127, 62, 63
 s_nop 1
 s_setpc_b64 s[30:31]
P2_CODE_END:
 s_endpgm
.section .rodata,"a"
.p2align 6
.amdhsa_kernel gated_mix__compressed_kv_cla__linear_attn_block__prompt_kernel
  .amdhsa_next_free_vgpr 512
  .amdhsa_next_free_sgpr 102
  .amdhsa_accum_offset 256
  .amdhsa_group_segment_fixed_size 0
  .amdhsa_kernarg_size 104
  .amdhsa_user_sgpr_count 2
  .amdhsa_user_sgpr_kernarg_segment_ptr 1
  .amdhsa_system_sgpr_workgroup_id_x 1
.end_amdhsa_kernel
```
